```python
import torch

def _softmax(x, axis=-1):
    return torch.softmax(x, dim=axis)
def _gelu(x):
    return torch.nn.functional.gelu(x, approximate="tanh")
def _silu(x):
    return torch.nn.functional.silu(x)
def _sigmoid(x):
    return torch.sigmoid(x)
def _layernorm(x, axis=-1, eps=1e-5):
    m = x.mean(dim=axis, keepdim=True)
    v = x.var(dim=axis, keepdim=True, unbiased=False)
    return (x - m) / torch.sqrt(v + eps)
def _scatter_add(tgt, idx, src, axis=0):
    return tgt.clone().index_add_(axis, idx, src)
def _segment_sum(src, seg, n):
    out = torch.zeros((n,) + src.shape[1:], dtype=src.dtype)
    return out.index_add_(0, seg, src)
def _pad(x, pw):
    flat = tuple(v for pair in reversed(pw) for v in pair)
    return torch.nn.functional.pad(x, flat)

kernel_name = 'interleave_layers__linear_attn_block__mixer_channel_mlp__prompt'

def setup_inputs():

    _w = (lambda a: (lambda t: t.to(torch.bfloat16) if t.is_floating_point() else t)(torch.as_tensor(a)))
    def _A_setup():
        B, S, D = 1, 2048, 1024
        return {
            "x": _w((lambda *s: torch.randn(*s, dtype=torch.bfloat16) * 0.05)(B, S, D)),
            "wqkv": _w((lambda *s: torch.randn(*s, dtype=torch.bfloat16) * 0.05)(D, 3 * D)),
            "wo": _w((lambda *s: torch.randn(*s, dtype=torch.bfloat16) * 0.05)(D, D)),
        }
    _A_in = _A_setup()

    def _B_setup():
        B, S, D, F = 1, 2048, 1024, 3584
        return {
            "x": _w((lambda *s: torch.randn(*s, dtype=torch.bfloat16) * 0.05)(B, S, D)),
            "w1": _w((lambda *s: torch.randn(*s, dtype=torch.bfloat16) * 3.2)(D, F) * (D ** -0.5)),
            "b1": _w((lambda *s: torch.randn(*s, dtype=torch.bfloat16) * 0.4)(F)),
            "w2": _w((lambda *s: torch.randn(*s, dtype=torch.bfloat16) * 0.4)(F, D) * (F ** -0.5)),
            "b2": _w((lambda *s: torch.randn(*s, dtype=torch.bfloat16) * 0.4)(D)),
        }
    _B_in = _B_setup()

    return {
        "A_x": _A_in["x"],
        "A_wqkv": _A_in["wqkv"],
        "A_wo": _A_in["wo"],
        "B_x": _B_in["x"],
        "B_w1": _B_in["w1"],
        "B_b1": _B_in["b1"],
        "B_w2": _B_in["w2"],
        "B_b2": _B_in["b2"],
    }

def reference(A_x, A_wqkv, A_wo, B_x, B_w1, B_b1, B_w2, B_b2):
    def _A_ref(x, wqkv, wo):
        B, S, D = x.shape
        H = 32; Dh = D // H
        qkv = (lambda x, *d: x.permute(*d))((x @ wqkv).reshape(B, S, 3, H, Dh), 2, 0, 3, 1, 4)
        q, k, v = qkv[0], qkv[1], qkv[2]
        phi = lambda t: torch.where(t > 0, t + 1, torch.exp(t)) + 1e-6
        pq, pk = phi(q), phi(k)
        kv = torch.einsum("bhsd,bhse->bhde", pk, v)
        z = torch.einsum("bhsd->bhd", pk)
        num = torch.einsum("bhqd,bhde->bhqe", pq, kv)
        den = torch.einsum("bhqd,bhd->bhq", pq, z)[..., None] + 1e-6
        o = num / den
        return (lambda x, *d: x.permute(*d))(o, 0, 2, 1, 3).reshape(B, S, D) @ wo

    def _B_ref(x, w1, b1, w2, b2):
        y = _layernorm(x, axis=-1)
        h = _gelu(torch.einsum("bsd,df->bsf", y, w1) + b1)
        return torch.einsum("bsf,fd->bsd", h, w2) + b2

    x = A_x
    x = x + _A_ref(_layernorm(x, axis=-1), A_wqkv, A_wo)
    x = x + _B_ref(_layernorm(x, axis=-1), B_w1, B_b1, B_w2, B_b2)
    x = x + _A_ref(_layernorm(x, axis=-1), A_wqkv, A_wo)
    x = x + _B_ref(_layernorm(x, axis=-1), B_w1, B_b1, B_w2, B_b2)
    return x
```

```asm
; @launch kernel=ln1_0_kernel grid=(512,1,1) block=(256,1,1) lds=0
; @launch kernel=qkv_0_kernel grid=(256,1,1) block=(512,1,1) lds=122880
; @launch kernel=o_0_kernel grid=(256,1,1) block=(256,1,1) lds=0
; @launch kernel=proj_0_kernel grid=(256,1,1) block=(512,1,1) lds=147456
; @launch kernel=ln2_0_kernel grid=(512,1,1) block=(256,1,1) lds=0
; @launch kernel=mlp1_0_kernel grid=(224,1,1) block=(512,1,1) lds=147456
; @launch kernel=mlp2_0_kernel grid=(256,1,1) block=(512,1,1) lds=147456
; @launch kernel=ln1_1_kernel grid=(512,1,1) block=(256,1,1) lds=0
; @launch kernel=qkv_1_kernel grid=(256,1,1) block=(512,1,1) lds=122880
; @launch kernel=o_1_kernel grid=(256,1,1) block=(256,1,1) lds=0
; @launch kernel=proj_1_kernel grid=(256,1,1) block=(512,1,1) lds=147456
; @launch kernel=ln2_1_kernel grid=(512,1,1) block=(256,1,1) lds=0
; @launch kernel=mlp1_1_kernel grid=(224,1,1) block=(512,1,1) lds=147456
; @launch kernel=mlp2_1_kernel grid=(256,1,1) block=(512,1,1) lds=147456
.amdgcn_target "amdgcn-amd-amdhsa--gfx950"
.text
.globl ln1_0_kernel
.p2align 8
.type ln1_0_kernel,@function
ln1_0_kernel:
    s_cmp_ge_u32 s2, 512
    s_cbranch_scc1 L_end_ln1_0_kernel
    s_load_dwordx2 s[4:5], s[0:1], 0
    s_load_dwordx2 s[6:7], s[0:1], 80
    v_lshrrev_b32 v2, 6, v0
    v_and_b32 v1, 63, v0
    s_lshl_b32 s3, s2, 2
    v_add_u32 v2, s3, v2
    v_lshlrev_b32 v2, 11, v2
    v_lshlrev_b32 v3, 4, v1
    v_add_u32 v2, v2, v3
    s_waitcnt lgkmcnt(0)
    s_mov_b32 s8, s4
    s_mov_b32 s9, s5
    s_mov_b32 s10, 4194304
    s_mov_b32 s11, 0x00020000
    s_add_u32 s12, s6, 0
    s_addc_u32 s13, s7, 0
    s_mov_b32 s14, 4194304
    s_mov_b32 s15, 0x00020000
    buffer_load_dwordx4 v[4:7], v2, s[8:11], 0 offen
    buffer_load_dwordx4 v[8:11], v2, s[8:11], 0 offen offset:1024
    s_cmp_ge_u32 s2, 66
    s_cbranch_scc1 L_nz_ln1_0_kernel
    s_add_u32 s16, s6, 41943040
    s_addc_u32 s17, s7, 0
    s_mov_b32 s18, 270336
    s_mov_b32 s19, 0x00020000
    s_lshl_b32 s3, s2, 12
    v_lshlrev_b32 v12, 4, v0
    v_add_u32 v12, s3, v12
    v_mov_b32 v14, 0
    v_mov_b32 v15, 0
    v_mov_b32 v16, 0
    v_mov_b32 v17, 0
    buffer_store_dwordx4 v[14:17], v12, s[16:19], 0 offen
L_nz_ln1_0_kernel:
    s_waitcnt vmcnt(0)
    v_lshlrev_b32 v20, 16, v4
    v_and_b32 v21, 0xffff0000, v4
    v_lshlrev_b32 v22, 16, v5
    v_and_b32 v23, 0xffff0000, v5
    v_lshlrev_b32 v24, 16, v6
    v_and_b32 v25, 0xffff0000, v6
    v_lshlrev_b32 v26, 16, v7
    v_and_b32 v27, 0xffff0000, v7
    v_lshlrev_b32 v28, 16, v8
    v_and_b32 v29, 0xffff0000, v8
    v_lshlrev_b32 v30, 16, v9
    v_and_b32 v31, 0xffff0000, v9
    v_lshlrev_b32 v32, 16, v10
    v_and_b32 v33, 0xffff0000, v10
    v_lshlrev_b32 v34, 16, v11
    v_and_b32 v35, 0xffff0000, v11
    v_add_f32 v40, v20, v21
    v_add_f32 v40, v40, v22
    v_add_f32 v40, v40, v23
    v_add_f32 v40, v40, v24
    v_add_f32 v40, v40, v25
    v_add_f32 v40, v40, v26
    v_add_f32 v40, v40, v27
    v_add_f32 v40, v40, v28
    v_add_f32 v40, v40, v29
    v_add_f32 v40, v40, v30
    v_add_f32 v40, v40, v31
    v_add_f32 v40, v40, v32
    v_add_f32 v40, v40, v33
    v_add_f32 v40, v40, v34
    v_add_f32 v40, v40, v35
    s_nop 1
    v_add_f32_dpp v40, v40, v40 quad_perm:[1,0,3,2] row_mask:0xf bank_mask:0xf
    s_nop 1
    v_add_f32_dpp v40, v40, v40 quad_perm:[2,3,0,1] row_mask:0xf bank_mask:0xf
    s_nop 1
    v_add_f32_dpp v40, v40, v40 row_ror:4 row_mask:0xf bank_mask:0xf
    s_nop 1
    v_add_f32_dpp v40, v40, v40 row_ror:8 row_mask:0xf bank_mask:0xf
    v_mov_b32 v41, v40
    s_nop 1
    v_permlane16_swap_b32 v40, v41
    s_nop 1
    v_add_f32 v40, v40, v41
    v_mov_b32 v41, v40
    s_nop 1
    v_permlane32_swap_b32 v40, v41
    s_nop 1
    v_add_f32 v40, v40, v41
    v_mul_f32 v40, 0x3a800000, v40
    v_sub_f32 v42, v20, v40
    v_mul_f32 v43, v42, v42
    v_sub_f32 v42, v21, v40
    v_fmac_f32 v43, v42, v42
    v_sub_f32 v42, v22, v40
    v_fmac_f32 v43, v42, v42
    v_sub_f32 v42, v23, v40
    v_fmac_f32 v43, v42, v42
    v_sub_f32 v42, v24, v40
    v_fmac_f32 v43, v42, v42
    v_sub_f32 v42, v25, v40
    v_fmac_f32 v43, v42, v42
    v_sub_f32 v42, v26, v40
    v_fmac_f32 v43, v42, v42
    v_sub_f32 v42, v27, v40
    v_fmac_f32 v43, v42, v42
    v_sub_f32 v42, v28, v40
    v_fmac_f32 v43, v42, v42
    v_sub_f32 v42, v29, v40
    v_fmac_f32 v43, v42, v42
    v_sub_f32 v42, v30, v40
    v_fmac_f32 v43, v42, v42
    v_sub_f32 v42, v31, v40
    v_fmac_f32 v43, v42, v42
    v_sub_f32 v42, v32, v40
    v_fmac_f32 v43, v42, v42
    v_sub_f32 v42, v33, v40
    v_fmac_f32 v43, v42, v42
    v_sub_f32 v42, v34, v40
    v_fmac_f32 v43, v42, v42
    v_sub_f32 v42, v35, v40
    v_fmac_f32 v43, v42, v42
    s_nop 1
    v_add_f32_dpp v43, v43, v43 quad_perm:[1,0,3,2] row_mask:0xf bank_mask:0xf
    s_nop 1
    v_add_f32_dpp v43, v43, v43 quad_perm:[2,3,0,1] row_mask:0xf bank_mask:0xf
    s_nop 1
    v_add_f32_dpp v43, v43, v43 row_ror:4 row_mask:0xf bank_mask:0xf
    s_nop 1
    v_add_f32_dpp v43, v43, v43 row_ror:8 row_mask:0xf bank_mask:0xf
    v_mov_b32 v41, v43
    s_nop 1
    v_permlane16_swap_b32 v43, v41
    s_nop 1
    v_add_f32 v43, v43, v41
    v_mov_b32 v41, v43
    s_nop 1
    v_permlane32_swap_b32 v43, v41
    s_nop 1
    v_add_f32 v43, v43, v41
    v_mul_f32 v43, 0x3a800000, v43
    v_cvt_pk_bf16_f32 v41, v40, v43
    v_lshlrev_b32 v40, 16, v41
    v_and_b32 v43, 0xffff0000, v41
    v_add_f32 v43, 0x3727c5ac, v43
    v_mov_b32 v44, v43
    v_cvt_pk_bf16_f32 v41, v43, v44
    v_lshlrev_b32 v43, 16, v41
    v_and_b32 v44, 0xffff0000, v41
    v_sqrt_f32 v43, v43
    s_nop 0
    v_mov_b32 v44, v43
    v_cvt_pk_bf16_f32 v41, v43, v44
    v_lshlrev_b32 v43, 16, v41
    v_and_b32 v44, 0xffff0000, v41
    v_rcp_f32 v43, v43
    s_nop 0
    v_sub_f32 v20, v20, v40
    v_sub_f32 v21, v21, v40
    v_cvt_pk_bf16_f32 v41, v20, v21
    v_lshlrev_b32 v20, 16, v41
    v_and_b32 v21, 0xffff0000, v41
    v_mul_f32 v20, v20, v43
    v_mul_f32 v21, v21, v43
    v_sub_f32 v22, v22, v40
    v_sub_f32 v23, v23, v40
    v_cvt_pk_bf16_f32 v41, v22, v23
    v_lshlrev_b32 v22, 16, v41
    v_and_b32 v23, 0xffff0000, v41
    v_mul_f32 v22, v22, v43
    v_mul_f32 v23, v23, v43
    v_sub_f32 v24, v24, v40
    v_sub_f32 v25, v25, v40
    v_cvt_pk_bf16_f32 v41, v24, v25
    v_lshlrev_b32 v24, 16, v41
    v_and_b32 v25, 0xffff0000, v41
    v_mul_f32 v24, v24, v43
    v_mul_f32 v25, v25, v43
    v_sub_f32 v26, v26, v40
    v_sub_f32 v27, v27, v40
    v_cvt_pk_bf16_f32 v41, v26, v27
    v_lshlrev_b32 v26, 16, v41
    v_and_b32 v27, 0xffff0000, v41
    v_mul_f32 v26, v26, v43
    v_mul_f32 v27, v27, v43
    v_sub_f32 v28, v28, v40
    v_sub_f32 v29, v29, v40
    v_cvt_pk_bf16_f32 v41, v28, v29
    v_lshlrev_b32 v28, 16, v41
    v_and_b32 v29, 0xffff0000, v41
    v_mul_f32 v28, v28, v43
    v_mul_f32 v29, v29, v43
    v_sub_f32 v30, v30, v40
    v_sub_f32 v31, v31, v40
    v_cvt_pk_bf16_f32 v41, v30, v31
    v_lshlrev_b32 v30, 16, v41
    v_and_b32 v31, 0xffff0000, v41
    v_mul_f32 v30, v30, v43
    v_mul_f32 v31, v31, v43
    v_sub_f32 v32, v32, v40
    v_sub_f32 v33, v33, v40
    v_cvt_pk_bf16_f32 v41, v32, v33
    v_lshlrev_b32 v32, 16, v41
    v_and_b32 v33, 0xffff0000, v41
    v_mul_f32 v32, v32, v43
    v_mul_f32 v33, v33, v43
    v_sub_f32 v34, v34, v40
    v_sub_f32 v35, v35, v40
    v_cvt_pk_bf16_f32 v41, v34, v35
    v_lshlrev_b32 v34, 16, v41
    v_and_b32 v35, 0xffff0000, v41
    v_mul_f32 v34, v34, v43
    v_mul_f32 v35, v35, v43
    v_cvt_pk_bf16_f32 v4, v20, v21
    v_cvt_pk_bf16_f32 v5, v22, v23
    v_cvt_pk_bf16_f32 v6, v24, v25
    v_cvt_pk_bf16_f32 v7, v26, v27
    v_cvt_pk_bf16_f32 v8, v28, v29
    v_cvt_pk_bf16_f32 v9, v30, v31
    v_cvt_pk_bf16_f32 v10, v32, v33
    v_cvt_pk_bf16_f32 v11, v34, v35
    buffer_store_dwordx4 v[4:7], v2, s[12:15], 0 offen
    buffer_store_dwordx4 v[8:11], v2, s[12:15], 0 offen offset:1024
    s_waitcnt vmcnt(0)
L_end_ln1_0_kernel:
    s_endpgm
.globl qkv_0_kernel
.p2align 8
.type qkv_0_kernel,@function
qkv_0_kernel:
    s_cmp_ge_u32 s2, 256
    s_cbranch_scc1 L_end_qkv_0_kernel
    s_load_dwordx2 s[40:41], s[0:1], 80
    s_load_dwordx2 s[42:43], s[0:1], 8
    s_load_dwordx2 s[50:51], s[0:1], 80
    v_and_b32 v1, 63, v0
    v_lshrrev_b32 v2, 6, v0
    s_and_b32 s24, s2, 15
    v_readfirstlane_b32 s26, v2
    s_lshr_b32 s25, s2, 4
    s_nop 1
    s_lshr_b32 s27, s26, 2
    s_and_b32 s28, s26, 1
    s_bfe_u32 s29, s26, 0x10001
    v_lshrrev_b32 v2, 3, v1
    v_and_b32 v3, 7, v1
    v_xor_b32 v3, v3, v2
    s_lshl_b32 s38, s26, 4
    s_lshl_b32 s39, s24, 7
    s_add_u32 s38, s38, s39
    v_add_u32 v4, s38, v2
    s_mov_b32 s38, 2048
    v_mul_lo_u32 v4, v4, s38
    v_lshlrev_b32 v3, 4, v3
    v_add_u32 v10, v4, v3
    v_add_u32 v11, 16384, v10
    v_lshrrev_b32 v2, 3, v1
    s_lshl_b32 s38, s26, 3
    v_add_u32 v2, s38, v2
    s_mov_b32 s38, 6144
    v_mul_lo_u32 v2, v2, s38
    v_bfe_u32 v3, v1, 1, 2
    v_bfe_u32 v4, v1, 4, 1
    s_and_b32 s38, s26, 1
    s_lshl_b32 s38, s38, 1
    v_or_b32 v4, s38, v4
    v_xor_b32 v3, v3, v4
    v_lshlrev_b32 v3, 5, v3
    v_and_b32 v4, 1, v1
    v_lshlrev_b32 v4, 4, v4
    v_add3_u32 v12, v2, v3, v4
    v_and_b32 v2, 15, v1
    s_lshl_b32 s38, s28, 6
    v_add_u32 v2, s38, v2
    v_lshlrev_b32 v2, 7, v2
    v_lshrrev_b32 v3, 4, v1
    s_lshl_b32 s38, s27, 2
    v_add_u32 v3, s38, v3
    v_and_b32 v4, 7, v1
    v_xor_b32 v3, v3, v4
    v_lshlrev_b32 v3, 4, v3
    v_add_u32 v13, v2, v3
    v_lshrrev_b32 v2, 4, v1
    v_lshlrev_b32 v2, 3, v2
    v_bfe_u32 v3, v1, 2, 2
    v_add_u32 v2, v2, v3
    v_lshlrev_b32 v2, 7, v2
    v_and_b32 v3, 3, v1
    v_lshlrev_b32 v3, 3, v3
    v_add_u32 v2, v2, v3
    s_lshl_b32 s38, s27, 12
    s_add_u32 s38, s38, 16384
    v_add_u32 v2, s38, v2
    v_bfe_u32 v3, v1, 3, 1
    v_bfe_u32 v4, v1, 4, 1
    v_lshlrev_b32 v4, 1, v4
    v_or_b32 v3, v3, v4
    s_lshl_b32 s38, s29, 1
    v_xor_b32 v4, s38, v3
    v_lshlrev_b32 v4, 5, v4
    v_add_u32 v14, v2, v4
    v_xor_b32 v4, 32, v4
    v_add_u32 v15, v2, v4
    s_waitcnt lgkmcnt(0)
    s_mov_b32 s4, s40
    s_mov_b32 s5, s41
    s_mov_b32 s6, 4194304
    s_mov_b32 s7, 0x00020000
    s_mov_b32 s8, s42
    s_mov_b32 s9, s43
    s_mov_b32 s10, 6291456
    s_mov_b32 s11, 0x00020000
    s_mov_b32 s31, 0
    s_mul_i32 s32, s25, 128
    s_add_u32 s33, s32, 2048
    s_add_u32 s34, s32, 4096
    s_mov_b32 s36, 0
    s_lshl_b32 s44, s26, 11
    s_add_u32 s45, s44, 1024
    s_lshl_b32 s46, s26, 10
    s_add_u32 s46, s46, 16384
    s_add_u32 s47, s46, 8192
    s_add_u32 s48, s46, 16384
    s_add_u32 m0, s36, s44
    s_nop 0
    buffer_load_dwordx4 v10, s[4:7], s31 offen lds
    s_add_u32 m0, s36, s45
    s_nop 0
    buffer_load_dwordx4 v11, s[4:7], s31 offen lds
    s_add_u32 m0, s36, s46
    s_nop 0
    buffer_load_dwordx4 v12, s[8:11], s32 offen lds
    s_add_u32 m0, s36, s47
    s_nop 0
    buffer_load_dwordx4 v12, s[8:11], s33 offen lds
    s_add_u32 m0, s36, s48
    s_nop 0
    buffer_load_dwordx4 v12, s[8:11], s34 offen lds
    s_add_u32 s31, s31, 128
    s_add_u32 s32, s32, 393216
    s_add_u32 s33, s33, 393216
    s_add_u32 s34, s34, 393216
    s_add_u32 s36, s36, 40960
    s_cmp_ge_u32 s36, 122880
    s_cselect_b32 s36, 0, s36
    v_mov_b32 v100, 0
    v_mov_b32 v101, 0
    v_mov_b32 v102, 0
    v_mov_b32 v103, 0
    v_mov_b32 v104, 0
    v_mov_b32 v105, 0
    v_mov_b32 v106, 0
    v_mov_b32 v107, 0
    v_mov_b32 v108, 0
    v_mov_b32 v109, 0
    v_mov_b32 v110, 0
    v_mov_b32 v111, 0
    v_mov_b32 v112, 0
    v_mov_b32 v113, 0
    v_mov_b32 v114, 0
    v_mov_b32 v115, 0
    v_mov_b32 v116, 0
    v_mov_b32 v117, 0
    v_mov_b32 v118, 0
    v_mov_b32 v119, 0
    v_mov_b32 v120, 0
    v_mov_b32 v121, 0
    v_mov_b32 v122, 0
    v_mov_b32 v123, 0
    v_mov_b32 v124, 0
    v_mov_b32 v125, 0
    v_mov_b32 v126, 0
    v_mov_b32 v127, 0
    v_mov_b32 v128, 0
    v_mov_b32 v129, 0
    v_mov_b32 v130, 0
    v_mov_b32 v131, 0
    v_mov_b32 v132, 0
    v_mov_b32 v133, 0
    v_mov_b32 v134, 0
    v_mov_b32 v135, 0
    v_mov_b32 v136, 0
    v_mov_b32 v137, 0
    v_mov_b32 v138, 0
    v_mov_b32 v139, 0
    v_mov_b32 v140, 0
    v_mov_b32 v141, 0
    v_mov_b32 v142, 0
    v_mov_b32 v143, 0
    v_mov_b32 v144, 0
    v_mov_b32 v145, 0
    v_mov_b32 v146, 0
    v_mov_b32 v147, 0
    v_mov_b32 v148, 0
    v_mov_b32 v149, 0
    v_mov_b32 v150, 0
    v_mov_b32 v151, 0
    v_mov_b32 v152, 0
    v_mov_b32 v153, 0
    v_mov_b32 v154, 0
    v_mov_b32 v155, 0
    v_mov_b32 v156, 0
    v_mov_b32 v157, 0
    v_mov_b32 v158, 0
    v_mov_b32 v159, 0
    v_mov_b32 v160, 0
    v_mov_b32 v161, 0
    v_mov_b32 v162, 0
    v_mov_b32 v163, 0
    v_mov_b32 v164, 0
    v_mov_b32 v165, 0
    v_mov_b32 v166, 0
    v_mov_b32 v167, 0
    v_mov_b32 v168, 0
    v_mov_b32 v169, 0
    v_mov_b32 v170, 0
    v_mov_b32 v171, 0
    v_mov_b32 v172, 0
    v_mov_b32 v173, 0
    v_mov_b32 v174, 0
    v_mov_b32 v175, 0
    v_mov_b32 v176, 0
    v_mov_b32 v177, 0
    v_mov_b32 v178, 0
    v_mov_b32 v179, 0
    v_mov_b32 v180, 0
    v_mov_b32 v181, 0
    v_mov_b32 v182, 0
    v_mov_b32 v183, 0
    v_mov_b32 v184, 0
    v_mov_b32 v185, 0
    v_mov_b32 v186, 0
    v_mov_b32 v187, 0
    v_mov_b32 v188, 0
    v_mov_b32 v189, 0
    v_mov_b32 v190, 0
    v_mov_b32 v191, 0
    v_mov_b32 v192, 0
    v_mov_b32 v193, 0
    v_mov_b32 v194, 0
    v_mov_b32 v195, 0
    s_add_u32 m0, s36, s44
    s_nop 0
    buffer_load_dwordx4 v10, s[4:7], s31 offen lds
    s_add_u32 m0, s36, s45
    s_nop 0
    buffer_load_dwordx4 v11, s[4:7], s31 offen lds
    s_add_u32 m0, s36, s46
    s_nop 0
    buffer_load_dwordx4 v12, s[8:11], s32 offen lds
    s_add_u32 m0, s36, s47
    s_nop 0
    buffer_load_dwordx4 v12, s[8:11], s33 offen lds
    s_add_u32 m0, s36, s48
    s_nop 0
    buffer_load_dwordx4 v12, s[8:11], s34 offen lds
    s_add_u32 s31, s31, 128
    s_add_u32 s32, s32, 393216
    s_add_u32 s33, s33, 393216
    s_add_u32 s34, s34, 393216
    s_add_u32 s36, s36, 40960
    s_cmp_ge_u32 s36, 122880
    s_cselect_b32 s36, 0, s36
    s_add_u32 m0, s36, s44
    s_nop 0
    buffer_load_dwordx4 v10, s[4:7], s31 offen lds
    s_add_u32 m0, s36, s45
    s_nop 0
    buffer_load_dwordx4 v11, s[4:7], s31 offen lds
    s_add_u32 m0, s36, s46
    s_nop 0
    buffer_load_dwordx4 v12, s[8:11], s32 offen lds
    s_add_u32 m0, s36, s47
    s_nop 0
    buffer_load_dwordx4 v12, s[8:11], s33 offen lds
    s_add_u32 m0, s36, s48
    s_nop 0
    buffer_load_dwordx4 v12, s[8:11], s34 offen lds
    s_add_u32 s31, s31, 128
    s_add_u32 s32, s32, 393216
    s_add_u32 s33, s33, 393216
    s_add_u32 s34, s34, 393216
    s_add_u32 s36, s36, 40960
    s_cmp_ge_u32 s36, 122880
    s_cselect_b32 s36, 0, s36
    s_mov_b32 s37, 0
    s_waitcnt vmcnt(10)
    s_barrier
    v_add_u32 v16, s37, v13
    v_add_u32 v17, s37, v14
    v_add_u32 v18, s37, v15
    s_add_u32 s37, s37, 40960
    s_cmp_ge_u32 s37, 122880
    s_cselect_b32 s37, 0, s37
    ds_read_b128 v[20:23], v16 offset:0
    ds_read_b128 v[24:27], v16 offset:2048
    ds_read_b128 v[28:31], v16 offset:4096
    ds_read_b128 v[32:35], v16 offset:6144
    ds_read_b64_tr_b16 v[52:53], v17 offset:0
    ds_read_b64_tr_b16 v[54:55], v17 offset:512
    ds_read_b64_tr_b16 v[56:57], v18 offset:0
    ds_read_b64_tr_b16 v[58:59], v18 offset:512
    ds_read_b64_tr_b16 v[60:61], v17 offset:8192
    ds_read_b64_tr_b16 v[62:63], v17 offset:8704
    ds_read_b64_tr_b16 v[64:65], v18 offset:8192
    ds_read_b64_tr_b16 v[66:67], v18 offset:8704
    ds_read_b64_tr_b16 v[68:69], v17 offset:16384
    ds_read_b64_tr_b16 v[70:71], v17 offset:16896
    ds_read_b64_tr_b16 v[72:73], v18 offset:16384
    ds_read_b64_tr_b16 v[74:75], v18 offset:16896
    s_mov_b32 s30, 6
L_loop_qkv_0_kernel:
    s_waitcnt lgkmcnt(0)
    v_mfma_f32_16x16x32_bf16 v[100:103], v[52:55], v[20:23], v[100:103]
    v_mfma_f32_16x16x32_bf16 v[104:107], v[56:59], v[20:23], v[104:107]
    v_mfma_f32_16x16x32_bf16 v[108:111], v[20:23], v[60:63], v[108:111]
    v_mfma_f32_16x16x32_bf16 v[112:115], v[20:23], v[64:67], v[112:115]
    v_mfma_f32_16x16x32_bf16 v[116:119], v[20:23], v[68:71], v[116:119]
    v_mfma_f32_16x16x32_bf16 v[120:123], v[20:23], v[72:75], v[120:123]
    v_mfma_f32_16x16x32_bf16 v[124:127], v[52:55], v[24:27], v[124:127]
    v_mfma_f32_16x16x32_bf16 v[128:131], v[56:59], v[24:27], v[128:131]
    v_mfma_f32_16x16x32_bf16 v[132:135], v[24:27], v[60:63], v[132:135]
    v_mfma_f32_16x16x32_bf16 v[136:139], v[24:27], v[64:67], v[136:139]
    v_mfma_f32_16x16x32_bf16 v[140:143], v[24:27], v[68:71], v[140:143]
    v_mfma_f32_16x16x32_bf16 v[144:147], v[24:27], v[72:75], v[144:147]
    s_waitcnt vmcnt(5)
    s_barrier
    v_add_u32 v16, s37, v13
    v_add_u32 v17, s37, v14
    v_add_u32 v18, s37, v15
    s_add_u32 s37, s37, 40960
    s_cmp_ge_u32 s37, 122880
    s_cselect_b32 s37, 0, s37
    ds_read_b128 v[36:39], v16 offset:0
    ds_read_b128 v[40:43], v16 offset:2048
    ds_read_b128 v[44:47], v16 offset:4096
    ds_read_b128 v[48:51], v16 offset:6144
    ds_read_b64_tr_b16 v[76:77], v17 offset:0
    ds_read_b64_tr_b16 v[78:79], v17 offset:512
    ds_read_b64_tr_b16 v[80:81], v18 offset:0
    ds_read_b64_tr_b16 v[82:83], v18 offset:512
    ds_read_b64_tr_b16 v[84:85], v17 offset:8192
    ds_read_b64_tr_b16 v[86:87], v17 offset:8704
    ds_read_b64_tr_b16 v[88:89], v18 offset:8192
    ds_read_b64_tr_b16 v[90:91], v18 offset:8704
    ds_read_b64_tr_b16 v[92:93], v17 offset:16384
    ds_read_b64_tr_b16 v[94:95], v17 offset:16896
    ds_read_b64_tr_b16 v[96:97], v18 offset:16384
    ds_read_b64_tr_b16 v[98:99], v18 offset:16896
    s_add_u32 m0, s36, s44
    v_mfma_f32_16x16x32_bf16 v[148:151], v[52:55], v[28:31], v[148:151]
    buffer_load_dwordx4 v10, s[4:7], s31 offen lds
    v_mfma_f32_16x16x32_bf16 v[152:155], v[56:59], v[28:31], v[152:155]
    s_add_u32 m0, s36, s45
    v_mfma_f32_16x16x32_bf16 v[156:159], v[28:31], v[60:63], v[156:159]
    buffer_load_dwordx4 v11, s[4:7], s31 offen lds
    v_mfma_f32_16x16x32_bf16 v[160:163], v[28:31], v[64:67], v[160:163]
    s_add_u32 m0, s36, s46
    v_mfma_f32_16x16x32_bf16 v[164:167], v[28:31], v[68:71], v[164:167]
    buffer_load_dwordx4 v12, s[8:11], s32 offen lds
    v_mfma_f32_16x16x32_bf16 v[168:171], v[28:31], v[72:75], v[168:171]
    s_add_u32 m0, s36, s47
    v_mfma_f32_16x16x32_bf16 v[172:175], v[52:55], v[32:35], v[172:175]
    buffer_load_dwordx4 v12, s[8:11], s33 offen lds
    v_mfma_f32_16x16x32_bf16 v[176:179], v[56:59], v[32:35], v[176:179]
    s_add_u32 m0, s36, s48
    v_mfma_f32_16x16x32_bf16 v[180:183], v[32:35], v[60:63], v[180:183]
    buffer_load_dwordx4 v12, s[8:11], s34 offen lds
    v_mfma_f32_16x16x32_bf16 v[184:187], v[32:35], v[64:67], v[184:187]
    v_mfma_f32_16x16x32_bf16 v[188:191], v[32:35], v[68:71], v[188:191]
    v_mfma_f32_16x16x32_bf16 v[192:195], v[32:35], v[72:75], v[192:195]
    s_add_u32 s31, s31, 128
    s_add_u32 s32, s32, 393216
    s_add_u32 s33, s33, 393216
    s_add_u32 s34, s34, 393216
    s_add_u32 s36, s36, 40960
    s_cmp_ge_u32 s36, 122880
    s_cselect_b32 s36, 0, s36
    s_waitcnt lgkmcnt(0)
    v_mfma_f32_16x16x32_bf16 v[100:103], v[76:79], v[36:39], v[100:103]
    v_mfma_f32_16x16x32_bf16 v[104:107], v[80:83], v[36:39], v[104:107]
    v_mfma_f32_16x16x32_bf16 v[108:111], v[36:39], v[84:87], v[108:111]
    v_mfma_f32_16x16x32_bf16 v[112:115], v[36:39], v[88:91], v[112:115]
    v_mfma_f32_16x16x32_bf16 v[116:119], v[36:39], v[92:95], v[116:119]
    v_mfma_f32_16x16x32_bf16 v[120:123], v[36:39], v[96:99], v[120:123]
    v_mfma_f32_16x16x32_bf16 v[124:127], v[76:79], v[40:43], v[124:127]
    v_mfma_f32_16x16x32_bf16 v[128:131], v[80:83], v[40:43], v[128:131]
    v_mfma_f32_16x16x32_bf16 v[132:135], v[40:43], v[84:87], v[132:135]
    v_mfma_f32_16x16x32_bf16 v[136:139], v[40:43], v[88:91], v[136:139]
    v_mfma_f32_16x16x32_bf16 v[140:143], v[40:43], v[92:95], v[140:143]
    v_mfma_f32_16x16x32_bf16 v[144:147], v[40:43], v[96:99], v[144:147]
    s_waitcnt vmcnt(5)
    s_barrier
    v_add_u32 v16, s37, v13
    v_add_u32 v17, s37, v14
    v_add_u32 v18, s37, v15
    s_add_u32 s37, s37, 40960
    s_cmp_ge_u32 s37, 122880
    s_cselect_b32 s37, 0, s37
    ds_read_b128 v[20:23], v16 offset:0
    ds_read_b128 v[24:27], v16 offset:2048
    ds_read_b128 v[28:31], v16 offset:4096
    ds_read_b128 v[32:35], v16 offset:6144
    ds_read_b64_tr_b16 v[52:53], v17 offset:0
    ds_read_b64_tr_b16 v[54:55], v17 offset:512
    ds_read_b64_tr_b16 v[56:57], v18 offset:0
    ds_read_b64_tr_b16 v[58:59], v18 offset:512
    ds_read_b64_tr_b16 v[60:61], v17 offset:8192
    ds_read_b64_tr_b16 v[62:63], v17 offset:8704
    ds_read_b64_tr_b16 v[64:65], v18 offset:8192
    ds_read_b64_tr_b16 v[66:67], v18 offset:8704
    ds_read_b64_tr_b16 v[68:69], v17 offset:16384
    ds_read_b64_tr_b16 v[70:71], v17 offset:16896
    ds_read_b64_tr_b16 v[72:73], v18 offset:16384
    ds_read_b64_tr_b16 v[74:75], v18 offset:16896
    s_add_u32 m0, s36, s44
    v_mfma_f32_16x16x32_bf16 v[148:151], v[76:79], v[44:47], v[148:151]
    buffer_load_dwordx4 v10, s[4:7], s31 offen lds
    v_mfma_f32_16x16x32_bf16 v[152:155], v[80:83], v[44:47], v[152:155]
    s_add_u32 m0, s36, s45
    v_mfma_f32_16x16x32_bf16 v[156:159], v[44:47], v[84:87], v[156:159]
    buffer_load_dwordx4 v11, s[4:7], s31 offen lds
    v_mfma_f32_16x16x32_bf16 v[160:163], v[44:47], v[88:91], v[160:163]
    s_add_u32 m0, s36, s46
    v_mfma_f32_16x16x32_bf16 v[164:167], v[44:47], v[92:95], v[164:167]
    buffer_load_dwordx4 v12, s[8:11], s32 offen lds
    v_mfma_f32_16x16x32_bf16 v[168:171], v[44:47], v[96:99], v[168:171]
    s_add_u32 m0, s36, s47
    v_mfma_f32_16x16x32_bf16 v[172:175], v[76:79], v[48:51], v[172:175]
    buffer_load_dwordx4 v12, s[8:11], s33 offen lds
    v_mfma_f32_16x16x32_bf16 v[176:179], v[80:83], v[48:51], v[176:179]
    s_add_u32 m0, s36, s48
    v_mfma_f32_16x16x32_bf16 v[180:183], v[48:51], v[84:87], v[180:183]
    buffer_load_dwordx4 v12, s[8:11], s34 offen lds
    v_mfma_f32_16x16x32_bf16 v[184:187], v[48:51], v[88:91], v[184:187]
    v_mfma_f32_16x16x32_bf16 v[188:191], v[48:51], v[92:95], v[188:191]
    v_mfma_f32_16x16x32_bf16 v[192:195], v[48:51], v[96:99], v[192:195]
    s_add_u32 s31, s31, 128
    s_add_u32 s32, s32, 393216
    s_add_u32 s33, s33, 393216
    s_add_u32 s34, s34, 393216
    s_add_u32 s36, s36, 40960
    s_cmp_ge_u32 s36, 122880
    s_cselect_b32 s36, 0, s36
    s_sub_u32 s30, s30, 1
    s_cmp_lg_u32 s30, 0
    s_cbranch_scc1 L_loop_qkv_0_kernel
    s_waitcnt lgkmcnt(0)
    v_mfma_f32_16x16x32_bf16 v[100:103], v[52:55], v[20:23], v[100:103]
    v_mfma_f32_16x16x32_bf16 v[104:107], v[56:59], v[20:23], v[104:107]
    v_mfma_f32_16x16x32_bf16 v[108:111], v[20:23], v[60:63], v[108:111]
    v_mfma_f32_16x16x32_bf16 v[112:115], v[20:23], v[64:67], v[112:115]
    v_mfma_f32_16x16x32_bf16 v[116:119], v[20:23], v[68:71], v[116:119]
    v_mfma_f32_16x16x32_bf16 v[120:123], v[20:23], v[72:75], v[120:123]
    v_mfma_f32_16x16x32_bf16 v[124:127], v[52:55], v[24:27], v[124:127]
    v_mfma_f32_16x16x32_bf16 v[128:131], v[56:59], v[24:27], v[128:131]
    v_mfma_f32_16x16x32_bf16 v[132:135], v[24:27], v[60:63], v[132:135]
    v_mfma_f32_16x16x32_bf16 v[136:139], v[24:27], v[64:67], v[136:139]
    v_mfma_f32_16x16x32_bf16 v[140:143], v[24:27], v[68:71], v[140:143]
    v_mfma_f32_16x16x32_bf16 v[144:147], v[24:27], v[72:75], v[144:147]
    s_waitcnt vmcnt(5)
    s_barrier
    v_add_u32 v16, s37, v13
    v_add_u32 v17, s37, v14
    v_add_u32 v18, s37, v15
    s_add_u32 s37, s37, 40960
    s_cmp_ge_u32 s37, 122880
    s_cselect_b32 s37, 0, s37
    ds_read_b128 v[36:39], v16 offset:0
    ds_read_b128 v[40:43], v16 offset:2048
    ds_read_b128 v[44:47], v16 offset:4096
    ds_read_b128 v[48:51], v16 offset:6144
    ds_read_b64_tr_b16 v[76:77], v17 offset:0
    ds_read_b64_tr_b16 v[78:79], v17 offset:512
    ds_read_b64_tr_b16 v[80:81], v18 offset:0
    ds_read_b64_tr_b16 v[82:83], v18 offset:512
    ds_read_b64_tr_b16 v[84:85], v17 offset:8192
    ds_read_b64_tr_b16 v[86:87], v17 offset:8704
    ds_read_b64_tr_b16 v[88:89], v18 offset:8192
    ds_read_b64_tr_b16 v[90:91], v18 offset:8704
    ds_read_b64_tr_b16 v[92:93], v17 offset:16384
    ds_read_b64_tr_b16 v[94:95], v17 offset:16896
    ds_read_b64_tr_b16 v[96:97], v18 offset:16384
    ds_read_b64_tr_b16 v[98:99], v18 offset:16896
    s_add_u32 m0, s36, s44
    v_mfma_f32_16x16x32_bf16 v[148:151], v[52:55], v[28:31], v[148:151]
    buffer_load_dwordx4 v10, s[4:7], s31 offen lds
    v_mfma_f32_16x16x32_bf16 v[152:155], v[56:59], v[28:31], v[152:155]
    s_add_u32 m0, s36, s45
    v_mfma_f32_16x16x32_bf16 v[156:159], v[28:31], v[60:63], v[156:159]
    buffer_load_dwordx4 v11, s[4:7], s31 offen lds
    v_mfma_f32_16x16x32_bf16 v[160:163], v[28:31], v[64:67], v[160:163]
    s_add_u32 m0, s36, s46
    v_mfma_f32_16x16x32_bf16 v[164:167], v[28:31], v[68:71], v[164:167]
    buffer_load_dwordx4 v12, s[8:11], s32 offen lds
    v_mfma_f32_16x16x32_bf16 v[168:171], v[28:31], v[72:75], v[168:171]
    s_add_u32 m0, s36, s47
    v_mfma_f32_16x16x32_bf16 v[172:175], v[52:55], v[32:35], v[172:175]
    buffer_load_dwordx4 v12, s[8:11], s33 offen lds
    v_mfma_f32_16x16x32_bf16 v[176:179], v[56:59], v[32:35], v[176:179]
    s_add_u32 m0, s36, s48
    v_mfma_f32_16x16x32_bf16 v[180:183], v[32:35], v[60:63], v[180:183]
    buffer_load_dwordx4 v12, s[8:11], s34 offen lds
    v_mfma_f32_16x16x32_bf16 v[184:187], v[32:35], v[64:67], v[184:187]
    v_mfma_f32_16x16x32_bf16 v[188:191], v[32:35], v[68:71], v[188:191]
    v_mfma_f32_16x16x32_bf16 v[192:195], v[32:35], v[72:75], v[192:195]
    s_add_u32 s31, s31, 128
    s_add_u32 s32, s32, 393216
    s_add_u32 s33, s33, 393216
    s_add_u32 s34, s34, 393216
    s_add_u32 s36, s36, 40960
    s_cmp_ge_u32 s36, 122880
    s_cselect_b32 s36, 0, s36
    s_waitcnt lgkmcnt(0)
    v_mfma_f32_16x16x32_bf16 v[100:103], v[76:79], v[36:39], v[100:103]
    v_mfma_f32_16x16x32_bf16 v[104:107], v[80:83], v[36:39], v[104:107]
    v_mfma_f32_16x16x32_bf16 v[108:111], v[36:39], v[84:87], v[108:111]
    v_mfma_f32_16x16x32_bf16 v[112:115], v[36:39], v[88:91], v[112:115]
    v_mfma_f32_16x16x32_bf16 v[116:119], v[36:39], v[92:95], v[116:119]
    v_mfma_f32_16x16x32_bf16 v[120:123], v[36:39], v[96:99], v[120:123]
    v_mfma_f32_16x16x32_bf16 v[124:127], v[76:79], v[40:43], v[124:127]
    v_mfma_f32_16x16x32_bf16 v[128:131], v[80:83], v[40:43], v[128:131]
    v_mfma_f32_16x16x32_bf16 v[132:135], v[40:43], v[84:87], v[132:135]
    v_mfma_f32_16x16x32_bf16 v[136:139], v[40:43], v[88:91], v[136:139]
    v_mfma_f32_16x16x32_bf16 v[140:143], v[40:43], v[92:95], v[140:143]
    v_mfma_f32_16x16x32_bf16 v[144:147], v[40:43], v[96:99], v[144:147]
    s_waitcnt vmcnt(5)
    s_barrier
    v_add_u32 v16, s37, v13
    v_add_u32 v17, s37, v14
    v_add_u32 v18, s37, v15
    s_add_u32 s37, s37, 40960
    s_cmp_ge_u32 s37, 122880
    s_cselect_b32 s37, 0, s37
    ds_read_b128 v[20:23], v16 offset:0
    ds_read_b128 v[24:27], v16 offset:2048
    ds_read_b128 v[28:31], v16 offset:4096
    ds_read_b128 v[32:35], v16 offset:6144
    ds_read_b64_tr_b16 v[52:53], v17 offset:0
    ds_read_b64_tr_b16 v[54:55], v17 offset:512
    ds_read_b64_tr_b16 v[56:57], v18 offset:0
    ds_read_b64_tr_b16 v[58:59], v18 offset:512
    ds_read_b64_tr_b16 v[60:61], v17 offset:8192
    ds_read_b64_tr_b16 v[62:63], v17 offset:8704
    ds_read_b64_tr_b16 v[64:65], v18 offset:8192
    ds_read_b64_tr_b16 v[66:67], v18 offset:8704
    ds_read_b64_tr_b16 v[68:69], v17 offset:16384
    ds_read_b64_tr_b16 v[70:71], v17 offset:16896
    ds_read_b64_tr_b16 v[72:73], v18 offset:16384
    ds_read_b64_tr_b16 v[74:75], v18 offset:16896
    v_mfma_f32_16x16x32_bf16 v[148:151], v[76:79], v[44:47], v[148:151]
    v_mfma_f32_16x16x32_bf16 v[152:155], v[80:83], v[44:47], v[152:155]
    v_mfma_f32_16x16x32_bf16 v[156:159], v[44:47], v[84:87], v[156:159]
    v_mfma_f32_16x16x32_bf16 v[160:163], v[44:47], v[88:91], v[160:163]
    v_mfma_f32_16x16x32_bf16 v[164:167], v[44:47], v[92:95], v[164:167]
    v_mfma_f32_16x16x32_bf16 v[168:171], v[44:47], v[96:99], v[168:171]
    v_mfma_f32_16x16x32_bf16 v[172:175], v[76:79], v[48:51], v[172:175]
    v_mfma_f32_16x16x32_bf16 v[176:179], v[80:83], v[48:51], v[176:179]
    v_mfma_f32_16x16x32_bf16 v[180:183], v[48:51], v[84:87], v[180:183]
    v_mfma_f32_16x16x32_bf16 v[184:187], v[48:51], v[88:91], v[184:187]
    v_mfma_f32_16x16x32_bf16 v[188:191], v[48:51], v[92:95], v[188:191]
    v_mfma_f32_16x16x32_bf16 v[192:195], v[48:51], v[96:99], v[192:195]
    s_waitcnt lgkmcnt(0)
    v_mfma_f32_16x16x32_bf16 v[100:103], v[52:55], v[20:23], v[100:103]
    v_mfma_f32_16x16x32_bf16 v[104:107], v[56:59], v[20:23], v[104:107]
    v_mfma_f32_16x16x32_bf16 v[108:111], v[20:23], v[60:63], v[108:111]
    v_mfma_f32_16x16x32_bf16 v[112:115], v[20:23], v[64:67], v[112:115]
    v_mfma_f32_16x16x32_bf16 v[116:119], v[20:23], v[68:71], v[116:119]
    v_mfma_f32_16x16x32_bf16 v[120:123], v[20:23], v[72:75], v[120:123]
    v_mfma_f32_16x16x32_bf16 v[124:127], v[52:55], v[24:27], v[124:127]
    v_mfma_f32_16x16x32_bf16 v[128:131], v[56:59], v[24:27], v[128:131]
    v_mfma_f32_16x16x32_bf16 v[132:135], v[24:27], v[60:63], v[132:135]
    v_mfma_f32_16x16x32_bf16 v[136:139], v[24:27], v[64:67], v[136:139]
    v_mfma_f32_16x16x32_bf16 v[140:143], v[24:27], v[68:71], v[140:143]
    v_mfma_f32_16x16x32_bf16 v[144:147], v[24:27], v[72:75], v[144:147]
    s_waitcnt vmcnt(0)
    s_barrier
    v_add_u32 v16, s37, v13
    v_add_u32 v17, s37, v14
    v_add_u32 v18, s37, v15
    s_add_u32 s37, s37, 40960
    s_cmp_ge_u32 s37, 122880
    s_cselect_b32 s37, 0, s37
    ds_read_b128 v[36:39], v16 offset:0
    ds_read_b128 v[40:43], v16 offset:2048
    ds_read_b128 v[44:47], v16 offset:4096
    ds_read_b128 v[48:51], v16 offset:6144
    ds_read_b64_tr_b16 v[76:77], v17 offset:0
    ds_read_b64_tr_b16 v[78:79], v17 offset:512
    ds_read_b64_tr_b16 v[80:81], v18 offset:0
    ds_read_b64_tr_b16 v[82:83], v18 offset:512
    ds_read_b64_tr_b16 v[84:85], v17 offset:8192
    ds_read_b64_tr_b16 v[86:87], v17 offset:8704
    ds_read_b64_tr_b16 v[88:89], v18 offset:8192
    ds_read_b64_tr_b16 v[90:91], v18 offset:8704
    ds_read_b64_tr_b16 v[92:93], v17 offset:16384
    ds_read_b64_tr_b16 v[94:95], v17 offset:16896
    ds_read_b64_tr_b16 v[96:97], v18 offset:16384
    ds_read_b64_tr_b16 v[98:99], v18 offset:16896
    v_mfma_f32_16x16x32_bf16 v[148:151], v[52:55], v[28:31], v[148:151]
    v_mfma_f32_16x16x32_bf16 v[152:155], v[56:59], v[28:31], v[152:155]
    v_mfma_f32_16x16x32_bf16 v[156:159], v[28:31], v[60:63], v[156:159]
    v_mfma_f32_16x16x32_bf16 v[160:163], v[28:31], v[64:67], v[160:163]
    v_mfma_f32_16x16x32_bf16 v[164:167], v[28:31], v[68:71], v[164:167]
    v_mfma_f32_16x16x32_bf16 v[168:171], v[28:31], v[72:75], v[168:171]
    v_mfma_f32_16x16x32_bf16 v[172:175], v[52:55], v[32:35], v[172:175]
    v_mfma_f32_16x16x32_bf16 v[176:179], v[56:59], v[32:35], v[176:179]
    v_mfma_f32_16x16x32_bf16 v[180:183], v[32:35], v[60:63], v[180:183]
    v_mfma_f32_16x16x32_bf16 v[184:187], v[32:35], v[64:67], v[184:187]
    v_mfma_f32_16x16x32_bf16 v[188:191], v[32:35], v[68:71], v[188:191]
    v_mfma_f32_16x16x32_bf16 v[192:195], v[32:35], v[72:75], v[192:195]
    s_waitcnt lgkmcnt(0)
    v_mfma_f32_16x16x32_bf16 v[100:103], v[76:79], v[36:39], v[100:103]
    v_mfma_f32_16x16x32_bf16 v[104:107], v[80:83], v[36:39], v[104:107]
    v_mfma_f32_16x16x32_bf16 v[108:111], v[36:39], v[84:87], v[108:111]
    v_mfma_f32_16x16x32_bf16 v[112:115], v[36:39], v[88:91], v[112:115]
    v_mfma_f32_16x16x32_bf16 v[116:119], v[36:39], v[92:95], v[116:119]
    v_mfma_f32_16x16x32_bf16 v[120:123], v[36:39], v[96:99], v[120:123]
    v_mfma_f32_16x16x32_bf16 v[124:127], v[76:79], v[40:43], v[124:127]
    v_mfma_f32_16x16x32_bf16 v[128:131], v[80:83], v[40:43], v[128:131]
    v_mfma_f32_16x16x32_bf16 v[132:135], v[40:43], v[84:87], v[132:135]
    v_mfma_f32_16x16x32_bf16 v[136:139], v[40:43], v[88:91], v[136:139]
    v_mfma_f32_16x16x32_bf16 v[140:143], v[40:43], v[92:95], v[140:143]
    v_mfma_f32_16x16x32_bf16 v[144:147], v[40:43], v[96:99], v[144:147]
    v_mfma_f32_16x16x32_bf16 v[148:151], v[76:79], v[44:47], v[148:151]
    v_mfma_f32_16x16x32_bf16 v[152:155], v[80:83], v[44:47], v[152:155]
    v_mfma_f32_16x16x32_bf16 v[156:159], v[44:47], v[84:87], v[156:159]
    v_mfma_f32_16x16x32_bf16 v[160:163], v[44:47], v[88:91], v[160:163]
    v_mfma_f32_16x16x32_bf16 v[164:167], v[44:47], v[92:95], v[164:167]
    v_mfma_f32_16x16x32_bf16 v[168:171], v[44:47], v[96:99], v[168:171]
    v_mfma_f32_16x16x32_bf16 v[172:175], v[76:79], v[48:51], v[172:175]
    v_mfma_f32_16x16x32_bf16 v[176:179], v[80:83], v[48:51], v[176:179]
    v_mfma_f32_16x16x32_bf16 v[180:183], v[48:51], v[84:87], v[180:183]
    v_mfma_f32_16x16x32_bf16 v[184:187], v[48:51], v[88:91], v[184:187]
    v_mfma_f32_16x16x32_bf16 v[188:191], v[48:51], v[92:95], v[188:191]
    v_mfma_f32_16x16x32_bf16 v[192:195], v[48:51], v[96:99], v[192:195]
    s_waitcnt vmcnt(0) lgkmcnt(0)
    s_barrier
    s_xor_b32 s38, s26, 4
    s_mul_i32 s38, s38, 12288
    v_lshlrev_b32 v2, 4, v1
    v_add_u32 v2, s38, v2
    s_nop 7
    s_cmp_eq_u32 s27, 0
    s_cbranch_scc0 L_give1_qkv_0_kernel
    ds_write_b128 v2, v[148:151] offset:0
    ds_write_b128 v2, v[152:155] offset:1024
    ds_write_b128 v2, v[156:159] offset:2048
    ds_write_b128 v2, v[160:163] offset:3072
    ds_write_b128 v2, v[164:167] offset:4096
    ds_write_b128 v2, v[168:171] offset:5120
    ds_write_b128 v2, v[172:175] offset:6144
    ds_write_b128 v2, v[176:179] offset:7168
    ds_write_b128 v2, v[180:183] offset:8192
    ds_write_b128 v2, v[184:187] offset:9216
    ds_write_b128 v2, v[188:191] offset:10240
    ds_write_b128 v2, v[192:195] offset:11264
    s_branch L_give_done_qkv_0_kernel
L_give1_qkv_0_kernel:
    ds_write_b128 v2, v[100:103] offset:0
    ds_write_b128 v2, v[104:107] offset:1024
    ds_write_b128 v2, v[108:111] offset:2048
    ds_write_b128 v2, v[112:115] offset:3072
    ds_write_b128 v2, v[116:119] offset:4096
    ds_write_b128 v2, v[120:123] offset:5120
    ds_write_b128 v2, v[124:127] offset:6144
    ds_write_b128 v2, v[128:131] offset:7168
    ds_write_b128 v2, v[132:135] offset:8192
    ds_write_b128 v2, v[136:139] offset:9216
    ds_write_b128 v2, v[140:143] offset:10240
    ds_write_b128 v2, v[144:147] offset:11264
L_give_done_qkv_0_kernel:
    s_waitcnt lgkmcnt(0)
    s_barrier
    s_mul_i32 s38, s26, 12288
    v_lshlrev_b32 v2, 4, v1
    v_add_u32 v2, s38, v2
    s_mul_i32 s38, s27, 48
    s_cmp_eq_u32 s27, 0
    s_cbranch_scc0 L_keep1_qkv_0_kernel
    ds_read_b128 v[20:23], v2 offset:0
    ds_read_b128 v[24:27], v2 offset:1024
    ds_read_b128 v[28:31], v2 offset:2048
    ds_read_b128 v[32:35], v2 offset:3072
    ds_read_b128 v[36:39], v2 offset:4096
    ds_read_b128 v[40:43], v2 offset:5120
    ds_read_b128 v[44:47], v2 offset:6144
    ds_read_b128 v[48:51], v2 offset:7168
    ds_read_b128 v[52:55], v2 offset:8192
    ds_read_b128 v[56:59], v2 offset:9216
    ds_read_b128 v[60:63], v2 offset:10240
    ds_read_b128 v[64:67], v2 offset:11264
    s_waitcnt lgkmcnt(0)
    v_add_f32 v20, v100, v20
    v_add_f32 v21, v101, v21
    v_add_f32 v22, v102, v22
    v_add_f32 v23, v103, v23
    v_add_f32 v24, v104, v24
    v_add_f32 v25, v105, v25
    v_add_f32 v26, v106, v26
    v_add_f32 v27, v107, v27
    v_add_f32 v28, v108, v28
    v_add_f32 v29, v109, v29
    v_add_f32 v30, v110, v30
    v_add_f32 v31, v111, v31
    v_add_f32 v32, v112, v32
    v_add_f32 v33, v113, v33
    v_add_f32 v34, v114, v34
    v_add_f32 v35, v115, v35
    v_add_f32 v36, v116, v36
    v_add_f32 v37, v117, v37
    v_add_f32 v38, v118, v38
    v_add_f32 v39, v119, v39
    v_add_f32 v40, v120, v40
    v_add_f32 v41, v121, v41
    v_add_f32 v42, v122, v42
    v_add_f32 v43, v123, v43
    v_add_f32 v44, v124, v44
    v_add_f32 v45, v125, v45
    v_add_f32 v46, v126, v46
    v_add_f32 v47, v127, v47
    v_add_f32 v48, v128, v48
    v_add_f32 v49, v129, v49
    v_add_f32 v50, v130, v50
    v_add_f32 v51, v131, v51
    v_add_f32 v52, v132, v52
    v_add_f32 v53, v133, v53
    v_add_f32 v54, v134, v54
    v_add_f32 v55, v135, v55
    v_add_f32 v56, v136, v56
    v_add_f32 v57, v137, v57
    v_add_f32 v58, v138, v58
    v_add_f32 v59, v139, v59
    v_add_f32 v60, v140, v60
    v_add_f32 v61, v141, v61
    v_add_f32 v62, v142, v62
    v_add_f32 v63, v143, v63
    v_add_f32 v64, v144, v64
    v_add_f32 v65, v145, v65
    v_add_f32 v66, v146, v66
    v_add_f32 v67, v147, v67
    s_branch L_keep_done_qkv_0_kernel
L_keep1_qkv_0_kernel:
    ds_read_b128 v[20:23], v2 offset:0
    ds_read_b128 v[24:27], v2 offset:1024
    ds_read_b128 v[28:31], v2 offset:2048
    ds_read_b128 v[32:35], v2 offset:3072
    ds_read_b128 v[36:39], v2 offset:4096
    ds_read_b128 v[40:43], v2 offset:5120
    ds_read_b128 v[44:47], v2 offset:6144
    ds_read_b128 v[48:51], v2 offset:7168
    ds_read_b128 v[52:55], v2 offset:8192
    ds_read_b128 v[56:59], v2 offset:9216
    ds_read_b128 v[60:63], v2 offset:10240
    ds_read_b128 v[64:67], v2 offset:11264
    s_waitcnt lgkmcnt(0)
    v_add_f32 v20, v148, v20
    v_add_f32 v21, v149, v21
    v_add_f32 v22, v150, v22
    v_add_f32 v23, v151, v23
    v_add_f32 v24, v152, v24
    v_add_f32 v25, v153, v25
    v_add_f32 v26, v154, v26
    v_add_f32 v27, v155, v27
    v_add_f32 v28, v156, v28
    v_add_f32 v29, v157, v29
    v_add_f32 v30, v158, v30
    v_add_f32 v31, v159, v31
    v_add_f32 v32, v160, v32
    v_add_f32 v33, v161, v33
    v_add_f32 v34, v162, v34
    v_add_f32 v35, v163, v35
    v_add_f32 v36, v164, v36
    v_add_f32 v37, v165, v37
    v_add_f32 v38, v166, v38
    v_add_f32 v39, v167, v39
    v_add_f32 v40, v168, v40
    v_add_f32 v41, v169, v41
    v_add_f32 v42, v170, v42
    v_add_f32 v43, v171, v43
    v_add_f32 v44, v172, v44
    v_add_f32 v45, v173, v45
    v_add_f32 v46, v174, v46
    v_add_f32 v47, v175, v47
    v_add_f32 v48, v176, v48
    v_add_f32 v49, v177, v49
    v_add_f32 v50, v178, v50
    v_add_f32 v51, v179, v51
    v_add_f32 v52, v180, v52
    v_add_f32 v53, v181, v53
    v_add_f32 v54, v182, v54
    v_add_f32 v55, v183, v55
    v_add_f32 v56, v184, v56
    v_add_f32 v57, v185, v57
    v_add_f32 v58, v186, v58
    v_add_f32 v59, v187, v59
    v_add_f32 v60, v188, v60
    v_add_f32 v61, v189, v61
    v_add_f32 v62, v190, v62
    v_add_f32 v63, v191, v63
    v_add_f32 v64, v192, v64
    v_add_f32 v65, v193, v65
    v_add_f32 v66, v194, v66
    v_add_f32 v67, v195, v67
L_keep_done_qkv_0_kernel:
    s_add_u32 s12, s50, 4194304
    s_addc_u32 s13, s51, 0
    s_mov_b32 s14, 4194304
    s_mov_b32 s15, 0x00020000
    v_and_b32 v2, 15, v1
    s_lshl_b32 s38, s24, 7
    s_lshl_b32 s39, s28, 6
    s_add_u32 s38, s38, s39
    s_lshl_b32 s39, s27, 5
    s_add_u32 s38, s38, s39
    v_add_u32 v2, s38, v2
    v_lshlrev_b32 v2, 11, v2
    v_lshrrev_b32 v3, 4, v1
    v_lshlrev_b32 v3, 3, v3
    s_lshl_b32 s38, s25, 1
    s_add_u32 s38, s38, s29
    s_lshl_b32 s38, s38, 6
    v_add3_u32 v2, v2, v3, s38
    v_cvt_pk_bf16_f32 v68, v20, v21
    v_lshlrev_b32 v20, 16, v68
    v_and_b32 v21, 0xffff0000, v68
    v_cvt_pk_bf16_f32 v68, v22, v23
    v_lshlrev_b32 v22, 16, v68
    v_and_b32 v23, 0xffff0000, v68
    v_mul_f32 v68, 0x3fb8aa3b, v20
    v_mul_f32 v69, 0x3fb8aa3b, v21
    v_mul_f32 v70, 0x3fb8aa3b, v22
    v_mul_f32 v71, 0x3fb8aa3b, v23
    v_exp_f32 v68, v68
    v_exp_f32 v69, v69
    v_exp_f32 v70, v70
    v_exp_f32 v71, v71
    v_cmp_lt_f32 vcc, 0, v20
    v_add_f32 v20, 1.0, v20
    s_nop 0
    v_cndmask_b32 v20, v68, v20, vcc
    v_cmp_lt_f32 vcc, 0, v21
    v_add_f32 v21, 1.0, v21
    s_nop 0
    v_cndmask_b32 v21, v69, v21, vcc
    v_cmp_lt_f32 vcc, 0, v22
    v_add_f32 v22, 1.0, v22
    s_nop 0
    v_cndmask_b32 v22, v70, v22, vcc
    v_cmp_lt_f32 vcc, 0, v23
    v_add_f32 v23, 1.0, v23
    s_nop 0
    v_cndmask_b32 v23, v71, v23, vcc
    v_cvt_pk_bf16_f32 v68, v20, v21
    v_lshlrev_b32 v20, 16, v68
    v_and_b32 v21, 0xffff0000, v68
    v_cvt_pk_bf16_f32 v68, v22, v23
    v_lshlrev_b32 v22, 16, v68
    v_and_b32 v23, 0xffff0000, v68
    v_add_f32 v20, 0x358637bd, v20
    v_add_f32 v21, 0x358637bd, v21
    v_add_f32 v22, 0x358637bd, v22
    v_add_f32 v23, 0x358637bd, v23
    v_cvt_pk_bf16_f32 v4, v20, v21
    v_cvt_pk_bf16_f32 v5, v22, v23
    s_mov_b32 s39, 0
    buffer_store_dwordx2 v[4:5], v2, s[12:15], s39 offen offset:0
    v_cvt_pk_bf16_f32 v68, v24, v25
    v_lshlrev_b32 v24, 16, v68
    v_and_b32 v25, 0xffff0000, v68
    v_cvt_pk_bf16_f32 v68, v26, v27
    v_lshlrev_b32 v26, 16, v68
    v_and_b32 v27, 0xffff0000, v68
    v_mul_f32 v68, 0x3fb8aa3b, v24
    v_mul_f32 v69, 0x3fb8aa3b, v25
    v_mul_f32 v70, 0x3fb8aa3b, v26
    v_mul_f32 v71, 0x3fb8aa3b, v27
    v_exp_f32 v68, v68
    v_exp_f32 v69, v69
    v_exp_f32 v70, v70
    v_exp_f32 v71, v71
    v_cmp_lt_f32 vcc, 0, v24
    v_add_f32 v24, 1.0, v24
    s_nop 0
    v_cndmask_b32 v24, v68, v24, vcc
    v_cmp_lt_f32 vcc, 0, v25
    v_add_f32 v25, 1.0, v25
    s_nop 0
    v_cndmask_b32 v25, v69, v25, vcc
    v_cmp_lt_f32 vcc, 0, v26
    v_add_f32 v26, 1.0, v26
    s_nop 0
    v_cndmask_b32 v26, v70, v26, vcc
    v_cmp_lt_f32 vcc, 0, v27
    v_add_f32 v27, 1.0, v27
    s_nop 0
    v_cndmask_b32 v27, v71, v27, vcc
    v_cvt_pk_bf16_f32 v68, v24, v25
    v_lshlrev_b32 v24, 16, v68
    v_and_b32 v25, 0xffff0000, v68
    v_cvt_pk_bf16_f32 v68, v26, v27
    v_lshlrev_b32 v26, 16, v68
    v_and_b32 v27, 0xffff0000, v68
    v_add_f32 v24, 0x358637bd, v24
    v_add_f32 v25, 0x358637bd, v25
    v_add_f32 v26, 0x358637bd, v26
    v_add_f32 v27, 0x358637bd, v27
    v_cvt_pk_bf16_f32 v4, v24, v25
    v_cvt_pk_bf16_f32 v5, v26, v27
    s_mov_b32 s39, 0
    buffer_store_dwordx2 v[4:5], v2, s[12:15], s39 offen offset:32
    v_cvt_pk_bf16_f32 v68, v44, v45
    v_lshlrev_b32 v44, 16, v68
    v_and_b32 v45, 0xffff0000, v68
    v_cvt_pk_bf16_f32 v68, v46, v47
    v_lshlrev_b32 v46, 16, v68
    v_and_b32 v47, 0xffff0000, v68
    v_mul_f32 v68, 0x3fb8aa3b, v44
    v_mul_f32 v69, 0x3fb8aa3b, v45
    v_mul_f32 v70, 0x3fb8aa3b, v46
    v_mul_f32 v71, 0x3fb8aa3b, v47
    v_exp_f32 v68, v68
    v_exp_f32 v69, v69
    v_exp_f32 v70, v70
    v_exp_f32 v71, v71
    v_cmp_lt_f32 vcc, 0, v44
    v_add_f32 v44, 1.0, v44
    s_nop 0
    v_cndmask_b32 v44, v68, v44, vcc
    v_cmp_lt_f32 vcc, 0, v45
    v_add_f32 v45, 1.0, v45
    s_nop 0
    v_cndmask_b32 v45, v69, v45, vcc
    v_cmp_lt_f32 vcc, 0, v46
    v_add_f32 v46, 1.0, v46
    s_nop 0
    v_cndmask_b32 v46, v70, v46, vcc
    v_cmp_lt_f32 vcc, 0, v47
    v_add_f32 v47, 1.0, v47
    s_nop 0
    v_cndmask_b32 v47, v71, v47, vcc
    v_cvt_pk_bf16_f32 v68, v44, v45
    v_lshlrev_b32 v44, 16, v68
    v_and_b32 v45, 0xffff0000, v68
    v_cvt_pk_bf16_f32 v68, v46, v47
    v_lshlrev_b32 v46, 16, v68
    v_and_b32 v47, 0xffff0000, v68
    v_add_f32 v44, 0x358637bd, v44
    v_add_f32 v45, 0x358637bd, v45
    v_add_f32 v46, 0x358637bd, v46
    v_add_f32 v47, 0x358637bd, v47
    v_cvt_pk_bf16_f32 v4, v44, v45
    v_cvt_pk_bf16_f32 v5, v46, v47
    s_mov_b32 s39, 32768
    buffer_store_dwordx2 v[4:5], v2, s[12:15], s39 offen offset:0
    v_cvt_pk_bf16_f32 v68, v48, v49
    v_lshlrev_b32 v48, 16, v68
    v_and_b32 v49, 0xffff0000, v68
    v_cvt_pk_bf16_f32 v68, v50, v51
    v_lshlrev_b32 v50, 16, v68
    v_and_b32 v51, 0xffff0000, v68
    v_mul_f32 v68, 0x3fb8aa3b, v48
    v_mul_f32 v69, 0x3fb8aa3b, v49
    v_mul_f32 v70, 0x3fb8aa3b, v50
    v_mul_f32 v71, 0x3fb8aa3b, v51
    v_exp_f32 v68, v68
    v_exp_f32 v69, v69
    v_exp_f32 v70, v70
    v_exp_f32 v71, v71
    v_cmp_lt_f32 vcc, 0, v48
    v_add_f32 v48, 1.0, v48
    s_nop 0
    v_cndmask_b32 v48, v68, v48, vcc
    v_cmp_lt_f32 vcc, 0, v49
    v_add_f32 v49, 1.0, v49
    s_nop 0
    v_cndmask_b32 v49, v69, v49, vcc
    v_cmp_lt_f32 vcc, 0, v50
    v_add_f32 v50, 1.0, v50
    s_nop 0
    v_cndmask_b32 v50, v70, v50, vcc
    v_cmp_lt_f32 vcc, 0, v51
    v_add_f32 v51, 1.0, v51
    s_nop 0
    v_cndmask_b32 v51, v71, v51, vcc
    v_cvt_pk_bf16_f32 v68, v48, v49
    v_lshlrev_b32 v48, 16, v68
    v_and_b32 v49, 0xffff0000, v68
    v_cvt_pk_bf16_f32 v68, v50, v51
    v_lshlrev_b32 v50, 16, v68
    v_and_b32 v51, 0xffff0000, v68
    v_add_f32 v48, 0x358637bd, v48
    v_add_f32 v49, 0x358637bd, v49
    v_add_f32 v50, 0x358637bd, v50
    v_add_f32 v51, 0x358637bd, v51
    v_cvt_pk_bf16_f32 v4, v48, v49
    v_cvt_pk_bf16_f32 v5, v50, v51
    s_mov_b32 s39, 32768
    buffer_store_dwordx2 v[4:5], v2, s[12:15], s39 offen offset:32
    v_cvt_pk_bf16_f32 v68, v28, v29
    v_lshlrev_b32 v28, 16, v68
    v_and_b32 v29, 0xffff0000, v68
    v_cvt_pk_bf16_f32 v68, v30, v31
    v_lshlrev_b32 v30, 16, v68
    v_and_b32 v31, 0xffff0000, v68
    v_mul_f32 v68, 0x3fb8aa3b, v28
    v_mul_f32 v69, 0x3fb8aa3b, v29
    v_mul_f32 v70, 0x3fb8aa3b, v30
    v_mul_f32 v71, 0x3fb8aa3b, v31
    v_exp_f32 v68, v68
    v_exp_f32 v69, v69
    v_exp_f32 v70, v70
    v_exp_f32 v71, v71
    v_cmp_lt_f32 vcc, 0, v28
    v_add_f32 v28, 1.0, v28
    s_nop 0
    v_cndmask_b32 v28, v68, v28, vcc
    v_cmp_lt_f32 vcc, 0, v29
    v_add_f32 v29, 1.0, v29
    s_nop 0
    v_cndmask_b32 v29, v69, v29, vcc
    v_cmp_lt_f32 vcc, 0, v30
    v_add_f32 v30, 1.0, v30
    s_nop 0
    v_cndmask_b32 v30, v70, v30, vcc
    v_cmp_lt_f32 vcc, 0, v31
    v_add_f32 v31, 1.0, v31
    s_nop 0
    v_cndmask_b32 v31, v71, v31, vcc
    v_cvt_pk_bf16_f32 v68, v28, v29
    v_lshlrev_b32 v28, 16, v68
    v_and_b32 v29, 0xffff0000, v68
    v_cvt_pk_bf16_f32 v68, v30, v31
    v_lshlrev_b32 v30, 16, v68
    v_and_b32 v31, 0xffff0000, v68
    v_add_f32 v28, 0x358637bd, v28
    v_add_f32 v29, 0x358637bd, v29
    v_add_f32 v30, 0x358637bd, v30
    v_add_f32 v31, 0x358637bd, v31
    v_cvt_pk_bf16_f32 v76, v28, v29
    v_cvt_pk_bf16_f32 v77, v30, v31
    v_cvt_pk_bf16_f32 v84, v36, v37
    v_cvt_pk_bf16_f32 v85, v38, v39
    v_cvt_pk_bf16_f32 v68, v52, v53
    v_lshlrev_b32 v52, 16, v68
    v_and_b32 v53, 0xffff0000, v68
    v_cvt_pk_bf16_f32 v68, v54, v55
    v_lshlrev_b32 v54, 16, v68
    v_and_b32 v55, 0xffff0000, v68
    v_mul_f32 v68, 0x3fb8aa3b, v52
    v_mul_f32 v69, 0x3fb8aa3b, v53
    v_mul_f32 v70, 0x3fb8aa3b, v54
    v_mul_f32 v71, 0x3fb8aa3b, v55
    v_exp_f32 v68, v68
    v_exp_f32 v69, v69
    v_exp_f32 v70, v70
    v_exp_f32 v71, v71
    v_cmp_lt_f32 vcc, 0, v52
    v_add_f32 v52, 1.0, v52
    s_nop 0
    v_cndmask_b32 v52, v68, v52, vcc
    v_cmp_lt_f32 vcc, 0, v53
    v_add_f32 v53, 1.0, v53
    s_nop 0
    v_cndmask_b32 v53, v69, v53, vcc
    v_cmp_lt_f32 vcc, 0, v54
    v_add_f32 v54, 1.0, v54
    s_nop 0
    v_cndmask_b32 v54, v70, v54, vcc
    v_cmp_lt_f32 vcc, 0, v55
    v_add_f32 v55, 1.0, v55
    s_nop 0
    v_cndmask_b32 v55, v71, v55, vcc
    v_cvt_pk_bf16_f32 v68, v52, v53
    v_lshlrev_b32 v52, 16, v68
    v_and_b32 v53, 0xffff0000, v68
    v_cvt_pk_bf16_f32 v68, v54, v55
    v_lshlrev_b32 v54, 16, v68
    v_and_b32 v55, 0xffff0000, v68
    v_add_f32 v52, 0x358637bd, v52
    v_add_f32 v53, 0x358637bd, v53
    v_add_f32 v54, 0x358637bd, v54
    v_add_f32 v55, 0x358637bd, v55
    v_cvt_pk_bf16_f32 v78, v52, v53
    v_cvt_pk_bf16_f32 v79, v54, v55
    v_cvt_pk_bf16_f32 v86, v60, v61
    v_cvt_pk_bf16_f32 v87, v62, v63
    v_cvt_pk_bf16_f32 v68, v32, v33
    v_lshlrev_b32 v32, 16, v68
    v_and_b32 v33, 0xffff0000, v68
    v_cvt_pk_bf16_f32 v68, v34, v35
    v_lshlrev_b32 v34, 16, v68
    v_and_b32 v35, 0xffff0000, v68
    v_mul_f32 v68, 0x3fb8aa3b, v32
    v_mul_f32 v69, 0x3fb8aa3b, v33
    v_mul_f32 v70, 0x3fb8aa3b, v34
    v_mul_f32 v71, 0x3fb8aa3b, v35
    v_exp_f32 v68, v68
    v_exp_f32 v69, v69
    v_exp_f32 v70, v70
    v_exp_f32 v71, v71
    v_cmp_lt_f32 vcc, 0, v32
    v_add_f32 v32, 1.0, v32
    s_nop 0
    v_cndmask_b32 v32, v68, v32, vcc
    v_cmp_lt_f32 vcc, 0, v33
    v_add_f32 v33, 1.0, v33
    s_nop 0
    v_cndmask_b32 v33, v69, v33, vcc
    v_cmp_lt_f32 vcc, 0, v34
    v_add_f32 v34, 1.0, v34
    s_nop 0
    v_cndmask_b32 v34, v70, v34, vcc
    v_cmp_lt_f32 vcc, 0, v35
    v_add_f32 v35, 1.0, v35
    s_nop 0
    v_cndmask_b32 v35, v71, v35, vcc
    v_cvt_pk_bf16_f32 v68, v32, v33
    v_lshlrev_b32 v32, 16, v68
    v_and_b32 v33, 0xffff0000, v68
    v_cvt_pk_bf16_f32 v68, v34, v35
    v_lshlrev_b32 v34, 16, v68
    v_and_b32 v35, 0xffff0000, v68
    v_add_f32 v32, 0x358637bd, v32
    v_add_f32 v33, 0x358637bd, v33
    v_add_f32 v34, 0x358637bd, v34
    v_add_f32 v35, 0x358637bd, v35
    v_cvt_pk_bf16_f32 v80, v32, v33
    v_cvt_pk_bf16_f32 v81, v34, v35
    v_cvt_pk_bf16_f32 v88, v40, v41
    v_cvt_pk_bf16_f32 v89, v42, v43
    v_cvt_pk_bf16_f32 v68, v56, v57
    v_lshlrev_b32 v56, 16, v68
    v_and_b32 v57, 0xffff0000, v68
    v_cvt_pk_bf16_f32 v68, v58, v59
    v_lshlrev_b32 v58, 16, v68
    v_and_b32 v59, 0xffff0000, v68
    v_mul_f32 v68, 0x3fb8aa3b, v56
    v_mul_f32 v69, 0x3fb8aa3b, v57
    v_mul_f32 v70, 0x3fb8aa3b, v58
    v_mul_f32 v71, 0x3fb8aa3b, v59
    v_exp_f32 v68, v68
    v_exp_f32 v69, v69
    v_exp_f32 v70, v70
    v_exp_f32 v71, v71
    v_cmp_lt_f32 vcc, 0, v56
    v_add_f32 v56, 1.0, v56
    s_nop 0
    v_cndmask_b32 v56, v68, v56, vcc
    v_cmp_lt_f32 vcc, 0, v57
    v_add_f32 v57, 1.0, v57
    s_nop 0
    v_cndmask_b32 v57, v69, v57, vcc
    v_cmp_lt_f32 vcc, 0, v58
    v_add_f32 v58, 1.0, v58
    s_nop 0
    v_cndmask_b32 v58, v70, v58, vcc
    v_cmp_lt_f32 vcc, 0, v59
    v_add_f32 v59, 1.0, v59
    s_nop 0
    v_cndmask_b32 v59, v71, v59, vcc
    v_cvt_pk_bf16_f32 v68, v56, v57
    v_lshlrev_b32 v56, 16, v68
    v_and_b32 v57, 0xffff0000, v68
    v_cvt_pk_bf16_f32 v68, v58, v59
    v_lshlrev_b32 v58, 16, v68
    v_and_b32 v59, 0xffff0000, v68
    v_add_f32 v56, 0x358637bd, v56
    v_add_f32 v57, 0x358637bd, v57
    v_add_f32 v58, 0x358637bd, v58
    v_add_f32 v59, 0x358637bd, v59
    v_cvt_pk_bf16_f32 v82, v56, v57
    v_cvt_pk_bf16_f32 v83, v58, v59
    v_cvt_pk_bf16_f32 v90, v64, v65
    v_cvt_pk_bf16_f32 v91, v66, v67
    v_mov_b32 v92, 0x3f803f80
    v_mov_b32 v93, 0x3f803f80
    v_mov_b32 v94, 0x3f803f80
    v_mov_b32 v95, 0x3f803f80
    v_mov_b32 v96, 0
    v_mov_b32 v97, 0
    v_mov_b32 v98, 0
    v_mov_b32 v99, 0
    v_mov_b32 v100, 0
    v_mov_b32 v101, 0
    v_mov_b32 v102, 0
    v_mov_b32 v103, 0
    v_mov_b32 v104, 0
    v_mov_b32 v105, 0
    v_mov_b32 v106, 0
    v_mov_b32 v107, 0
    v_mov_b32 v108, 0
    v_mov_b32 v109, 0
    v_mov_b32 v110, 0
    v_mov_b32 v111, 0
    v_mov_b32 v112, 0
    v_mov_b32 v113, 0
    v_mov_b32 v114, 0
    v_mov_b32 v115, 0
    v_mov_b32 v116, 0
    v_mov_b32 v117, 0
    v_mov_b32 v118, 0
    v_mov_b32 v119, 0
    s_nop 1
    v_mfma_f32_16x16x32_bf16 v[96:99], v[76:79], v[84:87], v[96:99]
    v_mfma_f32_16x16x32_bf16 v[100:103], v[76:79], v[88:91], v[100:103]
    v_mfma_f32_16x16x32_bf16 v[112:115], v[76:79], v[92:95], v[112:115]
    v_mfma_f32_16x16x32_bf16 v[104:107], v[80:83], v[84:87], v[104:107]
    v_mfma_f32_16x16x32_bf16 v[108:111], v[80:83], v[88:91], v[108:111]
    v_mfma_f32_16x16x32_bf16 v[116:119], v[80:83], v[92:95], v[116:119]
    s_barrier
    s_mul_i32 s38, s26, 6144
    v_lshlrev_b32 v3, 4, v1
    v_add_u32 v3, s38, v3
    s_nop 7
    ds_write_b128 v3, v[96:99] offset:0
    ds_write_b128 v3, v[100:103] offset:1024
    ds_write_b128 v3, v[104:107] offset:2048
    ds_write_b128 v3, v[108:111] offset:3072
    ds_write_b128 v3, v[112:115] offset:4096
    ds_write_b128 v3, v[116:119] offset:5120
    s_waitcnt lgkmcnt(0)
    s_barrier
    s_lshl_b32 s38, s28, 1
    s_add_u32 s38, s38, s27
    s_lshl_b32 s39, s29, 1
    s_mul_i32 s39, s39, 6144
    s_lshl_b32 s40, s38, 10
    s_add_u32 s39, s39, s40
    v_lshlrev_b32 v3, 4, v1
    v_add_u32 v3, s39, v3
    s_add_u32 s16, s50, 41943040
    s_addc_u32 s17, s51, 0
    s_mov_b32 s18, 135168
    s_mov_b32 s19, 0x00020000
    s_lshl_b32 s40, s25, 1
    s_add_u32 s40, s40, s29
    s_mul_i32 s40, s40, 4224
    v_lshrrev_b32 v4, 4, v1
    v_lshlrev_b32 v4, 9, v4
    v_and_b32 v5, 15, v1
    v_lshlrev_b32 v5, 2, v5
    v_add_u32 v4, v4, v5
    s_lshr_b32 s41, s38, 1
    s_lshl_b32 s41, s41, 11
    s_add_u32 s40, s40, s41
    s_and_b32 s41, s38, 1
    s_lshl_b32 s41, s41, 6
    s_add_u32 s41, s40, s41
    v_add_u32 v4, s41, v4
    ds_read_b128 v[96:99], v3 offset:0
    ds_read_b128 v[100:103], v3 offset:6144
    ds_read_b128 v[104:107], v3 offset:24576
    ds_read_b128 v[108:111], v3 offset:30720
    s_waitcnt lgkmcnt(0)
    v_add_f32 v96, v96, v100
    v_add_f32 v104, v104, v108
    v_add_f32 v96, v96, v104
    v_add_f32 v97, v97, v101
    v_add_f32 v105, v105, v109
    v_add_f32 v97, v97, v105
    v_add_f32 v98, v98, v102
    v_add_f32 v106, v106, v110
    v_add_f32 v98, v98, v106
    v_add_f32 v99, v99, v103
    v_add_f32 v107, v107, v111
    v_add_f32 v99, v99, v107
    buffer_atomic_add_f32 v96, v4, s[16:19], 0 offen offset:0
    buffer_atomic_add_f32 v97, v4, s[16:19], 0 offen offset:128
    buffer_atomic_add_f32 v98, v4, s[16:19], 0 offen offset:256
    buffer_atomic_add_f32 v99, v4, s[16:19], 0 offen offset:384
    s_cmp_ge_u32 s38, 2
    s_cbranch_scc1 L_at_done_qkv_0_kernel
    ds_read_b128 v[96:99], v3 offset:4096
    ds_read_b128 v[100:103], v3 offset:10240
    ds_read_b128 v[104:107], v3 offset:28672
    ds_read_b128 v[108:111], v3 offset:34816
    s_lshl_b32 s41, s38, 6
    s_add_u32 s41, s41, s40
    s_add_u32 s41, s41, 4096
    v_lshrrev_b32 v4, 4, v1
    v_lshlrev_b32 v4, 4, v4
    v_add_u32 v4, s41, v4
    s_waitcnt lgkmcnt(0)
    v_add_f32 v96, v96, v100
    v_add_f32 v104, v104, v108
    v_add_f32 v96, v96, v104
    v_add_f32 v97, v97, v101
    v_add_f32 v105, v105, v109
    v_add_f32 v97, v97, v105
    v_add_f32 v98, v98, v102
    v_add_f32 v106, v106, v110
    v_add_f32 v98, v98, v106
    v_add_f32 v99, v99, v103
    v_add_f32 v107, v107, v111
    v_add_f32 v99, v99, v107
    v_and_b32 v5, 15, v1
    v_cmp_eq_u32 vcc, 0, v5
    s_and_saveexec_b64 s[42:43], vcc
    buffer_atomic_add_f32 v96, v4, s[16:19], 0 offen offset:0
    buffer_atomic_add_f32 v97, v4, s[16:19], 0 offen offset:4
    buffer_atomic_add_f32 v98, v4, s[16:19], 0 offen offset:8
    buffer_atomic_add_f32 v99, v4, s[16:19], 0 offen offset:12
    s_mov_b64 exec, s[42:43]
L_at_done_qkv_0_kernel:
    s_waitcnt vmcnt(0)
    s_waitcnt vmcnt(0)
L_end_qkv_0_kernel:
    s_endpgm
.globl o_0_kernel
.p2align 8
.type o_0_kernel,@function
o_0_kernel:
    s_cmp_ge_u32 s2, 256
    s_cbranch_scc1 L_end_o_0_kernel
    s_load_dwordx2 s[6:7], s[0:1], 80
    v_lshrrev_b32 v2, 6, v0
    v_and_b32 v1, 63, v0
    s_nop 0
    v_readfirstlane_b32 s3, v2
    s_lshl_b32 s4, s2, 2
    s_add_u32 s4, s4, s3
    s_and_b32 s5, s4, 31
    s_lshr_b32 s4, s4, 5
    s_waitcnt lgkmcnt(0)
    s_add_u32 s8, s6, 4194304
    s_addc_u32 s9, s7, 0
    s_mov_b32 s10, 4194304
    s_mov_b32 s11, 0x00020000
    s_add_u32 s12, s6, 8388608
    s_addc_u32 s13, s7, 0
    s_mov_b32 s14, 4194304
    s_mov_b32 s15, 0x00020000
    s_add_u32 s16, s6, 41943040
    s_addc_u32 s17, s7, 0
    s_mov_b32 s18, 135168
    s_mov_b32 s19, 0x00020000
    v_and_b32 v2, 15, v1
    s_lshl_b32 s20, s4, 6
    v_add_u32 v2, s20, v2
    v_lshlrev_b32 v2, 11, v2
    v_lshrrev_b32 v3, 4, v1
    v_lshlrev_b32 v4, 4, v3
    s_lshl_b32 s20, s5, 6
    v_add3_u32 v2, v2, v4, s20
    s_mov_b32 s21, 0
    buffer_load_dwordx4 v[20:23], v2, s[8:11], s21 offen
    s_mov_b32 s21, 32768
    buffer_load_dwordx4 v[24:27], v2, s[8:11], s21 offen
    s_mov_b32 s21, 65536
    buffer_load_dwordx4 v[28:31], v2, s[8:11], s21 offen
    s_mov_b32 s21, 98304
    buffer_load_dwordx4 v[32:35], v2, s[8:11], s21 offen
    s_mul_i32 s20, s5, 4224
    v_lshlrev_b32 v4, 10, v3
    v_and_b32 v5, 15, v1
    v_lshlrev_b32 v5, 2, v5
    v_add3_u32 v4, v4, v5, s20
    buffer_load_dword v40, v4, s[16:19], 0 offen offset:0
    buffer_load_dword v41, v4, s[16:19], 0 offen offset:128
    buffer_load_dword v42, v4, s[16:19], 0 offen offset:256
    buffer_load_dword v43, v4, s[16:19], 0 offen offset:384
    buffer_load_dword v44, v4, s[16:19], 0 offen offset:512
    buffer_load_dword v45, v4, s[16:19], 0 offen offset:640
    buffer_load_dword v46, v4, s[16:19], 0 offen offset:768
    buffer_load_dword v47, v4, s[16:19], 0 offen offset:896
    buffer_load_dword v48, v4, s[16:19], 0 offen offset:64
    buffer_load_dword v49, v4, s[16:19], 0 offen offset:192
    buffer_load_dword v50, v4, s[16:19], 0 offen offset:320
    buffer_load_dword v51, v4, s[16:19], 0 offen offset:448
    buffer_load_dword v52, v4, s[16:19], 0 offen offset:576
    buffer_load_dword v53, v4, s[16:19], 0 offen offset:704
    buffer_load_dword v54, v4, s[16:19], 0 offen offset:832
    buffer_load_dword v55, v4, s[16:19], 0 offen offset:960
    v_lshlrev_b32 v5, 5, v3
    v_add_u32 v5, s20, v5
    v_add_u32 v5, 0x1000, v5
    buffer_load_dword v56, v5, s[16:19], 0 offen offset:0
    buffer_load_dword v57, v5, s[16:19], 0 offen offset:4
    buffer_load_dword v58, v5, s[16:19], 0 offen offset:8
    buffer_load_dword v59, v5, s[16:19], 0 offen offset:12
    buffer_load_dword v60, v5, s[16:19], 0 offen offset:16
    buffer_load_dword v61, v5, s[16:19], 0 offen offset:20
    buffer_load_dword v62, v5, s[16:19], 0 offen offset:24
    buffer_load_dword v63, v5, s[16:19], 0 offen offset:28
    v_accvgpr_write_b32 a0, 0
    v_accvgpr_write_b32 a1, 0
    v_accvgpr_write_b32 a2, 0
    v_accvgpr_write_b32 a3, 0
    v_accvgpr_write_b32 a4, 0
    v_accvgpr_write_b32 a5, 0
    v_accvgpr_write_b32 a6, 0
    v_accvgpr_write_b32 a7, 0
    v_accvgpr_write_b32 a8, 0
    v_accvgpr_write_b32 a9, 0
    v_accvgpr_write_b32 a10, 0
    v_accvgpr_write_b32 a11, 0
    v_accvgpr_write_b32 a12, 0
    v_accvgpr_write_b32 a13, 0
    v_accvgpr_write_b32 a14, 0
    v_accvgpr_write_b32 a15, 0
    v_accvgpr_write_b32 a16, 0
    v_accvgpr_write_b32 a17, 0
    v_accvgpr_write_b32 a18, 0
    v_accvgpr_write_b32 a19, 0
    v_accvgpr_write_b32 a20, 0
    v_accvgpr_write_b32 a21, 0
    v_accvgpr_write_b32 a22, 0
    v_accvgpr_write_b32 a23, 0
    v_accvgpr_write_b32 a24, 0
    v_accvgpr_write_b32 a25, 0
    v_accvgpr_write_b32 a26, 0
    v_accvgpr_write_b32 a27, 0
    v_accvgpr_write_b32 a28, 0
    v_accvgpr_write_b32 a29, 0
    v_accvgpr_write_b32 a30, 0
    v_accvgpr_write_b32 a31, 0
    v_accvgpr_write_b32 a32, 0
    v_accvgpr_write_b32 a33, 0
    v_accvgpr_write_b32 a34, 0
    v_accvgpr_write_b32 a35, 0
    v_accvgpr_write_b32 a36, 0
    v_accvgpr_write_b32 a37, 0
    v_accvgpr_write_b32 a38, 0
    v_accvgpr_write_b32 a39, 0
    v_accvgpr_write_b32 a40, 0
    v_accvgpr_write_b32 a41, 0
    v_accvgpr_write_b32 a42, 0
    v_accvgpr_write_b32 a43, 0
    v_accvgpr_write_b32 a44, 0
    v_accvgpr_write_b32 a45, 0
    v_accvgpr_write_b32 a46, 0
    v_accvgpr_write_b32 a47, 0
    s_waitcnt vmcnt(0)
    v_cvt_pk_bf16_f32 v64, v40, v41
    v_cvt_pk_bf16_f32 v65, v42, v43
    v_cvt_pk_bf16_f32 v66, v44, v45
    v_cvt_pk_bf16_f32 v67, v46, v47
    v_cvt_pk_bf16_f32 v68, v48, v49
    v_cvt_pk_bf16_f32 v69, v50, v51
    v_cvt_pk_bf16_f32 v70, v52, v53
    v_cvt_pk_bf16_f32 v71, v54, v55
    v_cvt_pk_bf16_f32 v72, v56, v57
    v_cvt_pk_bf16_f32 v73, v58, v59
    v_cvt_pk_bf16_f32 v74, v60, v61
    v_cvt_pk_bf16_f32 v75, v62, v63
    s_nop 1
    v_mfma_f32_16x16x32_bf16 a[0:3], v[64:67], v[20:23], a[0:3]
    v_mfma_f32_16x16x32_bf16 a[4:7], v[68:71], v[20:23], a[4:7]
    v_mfma_f32_16x16x32_bf16 a[8:11], v[72:75], v[20:23], a[8:11]
    v_mfma_f32_16x16x32_bf16 a[12:15], v[64:67], v[24:27], a[12:15]
    v_mfma_f32_16x16x32_bf16 a[16:19], v[68:71], v[24:27], a[16:19]
    v_mfma_f32_16x16x32_bf16 a[20:23], v[72:75], v[24:27], a[20:23]
    v_mfma_f32_16x16x32_bf16 a[24:27], v[64:67], v[28:31], a[24:27]
    v_mfma_f32_16x16x32_bf16 a[28:31], v[68:71], v[28:31], a[28:31]
    v_mfma_f32_16x16x32_bf16 a[32:35], v[72:75], v[28:31], a[32:35]
    v_mfma_f32_16x16x32_bf16 a[36:39], v[64:67], v[32:35], a[36:39]
    v_mfma_f32_16x16x32_bf16 a[40:43], v[68:71], v[32:35], a[40:43]
    v_mfma_f32_16x16x32_bf16 a[44:47], v[72:75], v[32:35], a[44:47]
    s_nop 7
    s_nop 7
    v_lshlrev_b32 v4, 3, v3
    v_and_b32 v2, 15, v1
    s_lshl_b32 s20, s4, 6
    v_add_u32 v2, s20, v2
    v_lshlrev_b32 v2, 11, v2
    s_lshl_b32 s20, s5, 6
    v_add3_u32 v2, v2, v4, s20
    v_accvgpr_read_b32 v40, a8
    s_nop 0
    v_mov_b32 v41, v40
    v_cvt_pk_bf16_f32 v42, v40, v41
    v_lshlrev_b32 v40, 16, v42
    v_and_b32 v41, 0xffff0000, v42
    v_add_f32 v40, 0x358637bd, v40
    v_mov_b32 v41, v40
    v_cvt_pk_bf16_f32 v42, v40, v41
    v_lshlrev_b32 v40, 16, v42
    v_and_b32 v41, 0xffff0000, v42
    v_rcp_f32 v40, v40
    v_accvgpr_read_b32 v44, a0
    v_accvgpr_read_b32 v45, a1
    v_accvgpr_read_b32 v46, a2
    v_accvgpr_read_b32 v47, a3
    s_nop 0
    v_cvt_pk_bf16_f32 v42, v44, v45
    v_lshlrev_b32 v44, 16, v42
    v_and_b32 v45, 0xffff0000, v42
    v_cvt_pk_bf16_f32 v42, v46, v47
    v_lshlrev_b32 v46, 16, v42
    v_and_b32 v47, 0xffff0000, v42
    v_mul_f32 v44, v44, v40
    v_mul_f32 v45, v45, v40
    v_mul_f32 v46, v46, v40
    v_mul_f32 v47, v47, v40
    v_cvt_pk_bf16_f32 v48, v44, v45
    v_cvt_pk_bf16_f32 v49, v46, v47
    s_mov_b32 s21, 0
    buffer_store_dwordx2 v[48:49], v2, s[12:15], s21 offen offset:0
    v_accvgpr_read_b32 v44, a4
    v_accvgpr_read_b32 v45, a5
    v_accvgpr_read_b32 v46, a6
    v_accvgpr_read_b32 v47, a7
    s_nop 0
    v_cvt_pk_bf16_f32 v42, v44, v45
    v_lshlrev_b32 v44, 16, v42
    v_and_b32 v45, 0xffff0000, v42
    v_cvt_pk_bf16_f32 v42, v46, v47
    v_lshlrev_b32 v46, 16, v42
    v_and_b32 v47, 0xffff0000, v42
    v_mul_f32 v44, v44, v40
    v_mul_f32 v45, v45, v40
    v_mul_f32 v46, v46, v40
    v_mul_f32 v47, v47, v40
    v_cvt_pk_bf16_f32 v48, v44, v45
    v_cvt_pk_bf16_f32 v49, v46, v47
    s_mov_b32 s21, 0
    buffer_store_dwordx2 v[48:49], v2, s[12:15], s21 offen offset:32
    v_accvgpr_read_b32 v40, a20
    s_nop 0
    v_mov_b32 v41, v40
    v_cvt_pk_bf16_f32 v42, v40, v41
    v_lshlrev_b32 v40, 16, v42
    v_and_b32 v41, 0xffff0000, v42
    v_add_f32 v40, 0x358637bd, v40
    v_mov_b32 v41, v40
    v_cvt_pk_bf16_f32 v42, v40, v41
    v_lshlrev_b32 v40, 16, v42
    v_and_b32 v41, 0xffff0000, v42
    v_rcp_f32 v40, v40
    v_accvgpr_read_b32 v44, a12
    v_accvgpr_read_b32 v45, a13
    v_accvgpr_read_b32 v46, a14
    v_accvgpr_read_b32 v47, a15
    s_nop 0
    v_cvt_pk_bf16_f32 v42, v44, v45
    v_lshlrev_b32 v44, 16, v42
    v_and_b32 v45, 0xffff0000, v42
    v_cvt_pk_bf16_f32 v42, v46, v47
    v_lshlrev_b32 v46, 16, v42
    v_and_b32 v47, 0xffff0000, v42
    v_mul_f32 v44, v44, v40
    v_mul_f32 v45, v45, v40
    v_mul_f32 v46, v46, v40
    v_mul_f32 v47, v47, v40
    v_cvt_pk_bf16_f32 v48, v44, v45
    v_cvt_pk_bf16_f32 v49, v46, v47
    s_mov_b32 s21, 32768
    buffer_store_dwordx2 v[48:49], v2, s[12:15], s21 offen offset:0
    v_accvgpr_read_b32 v44, a16
    v_accvgpr_read_b32 v45, a17
    v_accvgpr_read_b32 v46, a18
    v_accvgpr_read_b32 v47, a19
    s_nop 0
    v_cvt_pk_bf16_f32 v42, v44, v45
    v_lshlrev_b32 v44, 16, v42
    v_and_b32 v45, 0xffff0000, v42
    v_cvt_pk_bf16_f32 v42, v46, v47
    v_lshlrev_b32 v46, 16, v42
    v_and_b32 v47, 0xffff0000, v42
    v_mul_f32 v44, v44, v40
    v_mul_f32 v45, v45, v40
    v_mul_f32 v46, v46, v40
    v_mul_f32 v47, v47, v40
    v_cvt_pk_bf16_f32 v48, v44, v45
    v_cvt_pk_bf16_f32 v49, v46, v47
    s_mov_b32 s21, 32768
    buffer_store_dwordx2 v[48:49], v2, s[12:15], s21 offen offset:32
    v_accvgpr_read_b32 v40, a32
    s_nop 0
    v_mov_b32 v41, v40
    v_cvt_pk_bf16_f32 v42, v40, v41
    v_lshlrev_b32 v40, 16, v42
    v_and_b32 v41, 0xffff0000, v42
    v_add_f32 v40, 0x358637bd, v40
    v_mov_b32 v41, v40
    v_cvt_pk_bf16_f32 v42, v40, v41
    v_lshlrev_b32 v40, 16, v42
    v_and_b32 v41, 0xffff0000, v42
    v_rcp_f32 v40, v40
    v_accvgpr_read_b32 v44, a24
    v_accvgpr_read_b32 v45, a25
    v_accvgpr_read_b32 v46, a26
    v_accvgpr_read_b32 v47, a27
    s_nop 0
    v_cvt_pk_bf16_f32 v42, v44, v45
    v_lshlrev_b32 v44, 16, v42
    v_and_b32 v45, 0xffff0000, v42
    v_cvt_pk_bf16_f32 v42, v46, v47
    v_lshlrev_b32 v46, 16, v42
    v_and_b32 v47, 0xffff0000, v42
    v_mul_f32 v44, v44, v40
    v_mul_f32 v45, v45, v40
    v_mul_f32 v46, v46, v40
    v_mul_f32 v47, v47, v40
    v_cvt_pk_bf16_f32 v48, v44, v45
    v_cvt_pk_bf16_f32 v49, v46, v47
    s_mov_b32 s21, 65536
    buffer_store_dwordx2 v[48:49], v2, s[12:15], s21 offen offset:0
    v_accvgpr_read_b32 v44, a28
    v_accvgpr_read_b32 v45, a29
    v_accvgpr_read_b32 v46, a30
    v_accvgpr_read_b32 v47, a31
    s_nop 0
    v_cvt_pk_bf16_f32 v42, v44, v45
    v_lshlrev_b32 v44, 16, v42
    v_and_b32 v45, 0xffff0000, v42
    v_cvt_pk_bf16_f32 v42, v46, v47
    v_lshlrev_b32 v46, 16, v42
    v_and_b32 v47, 0xffff0000, v42
    v_mul_f32 v44, v44, v40
    v_mul_f32 v45, v45, v40
    v_mul_f32 v46, v46, v40
    v_mul_f32 v47, v47, v40
    v_cvt_pk_bf16_f32 v48, v44, v45
    v_cvt_pk_bf16_f32 v49, v46, v47
    s_mov_b32 s21, 65536
    buffer_store_dwordx2 v[48:49], v2, s[12:15], s21 offen offset:32
    v_accvgpr_read_b32 v40, a44
    s_nop 0
    v_mov_b32 v41, v40
    v_cvt_pk_bf16_f32 v42, v40, v41
    v_lshlrev_b32 v40, 16, v42
    v_and_b32 v41, 0xffff0000, v42
    v_add_f32 v40, 0x358637bd, v40
    v_mov_b32 v41, v40
    v_cvt_pk_bf16_f32 v42, v40, v41
    v_lshlrev_b32 v40, 16, v42
    v_and_b32 v41, 0xffff0000, v42
    v_rcp_f32 v40, v40
    v_accvgpr_read_b32 v44, a36
    v_accvgpr_read_b32 v45, a37
    v_accvgpr_read_b32 v46, a38
    v_accvgpr_read_b32 v47, a39
    s_nop 0
    v_cvt_pk_bf16_f32 v42, v44, v45
    v_lshlrev_b32 v44, 16, v42
    v_and_b32 v45, 0xffff0000, v42
    v_cvt_pk_bf16_f32 v42, v46, v47
    v_lshlrev_b32 v46, 16, v42
    v_and_b32 v47, 0xffff0000, v42
    v_mul_f32 v44, v44, v40
    v_mul_f32 v45, v45, v40
    v_mul_f32 v46, v46, v40
    v_mul_f32 v47, v47, v40
    v_cvt_pk_bf16_f32 v48, v44, v45
    v_cvt_pk_bf16_f32 v49, v46, v47
    s_mov_b32 s21, 98304
    buffer_store_dwordx2 v[48:49], v2, s[12:15], s21 offen offset:0
    v_accvgpr_read_b32 v44, a40
    v_accvgpr_read_b32 v45, a41
    v_accvgpr_read_b32 v46, a42
    v_accvgpr_read_b32 v47, a43
    s_nop 0
    v_cvt_pk_bf16_f32 v42, v44, v45
    v_lshlrev_b32 v44, 16, v42
    v_and_b32 v45, 0xffff0000, v42
    v_cvt_pk_bf16_f32 v42, v46, v47
    v_lshlrev_b32 v46, 16, v42
    v_and_b32 v47, 0xffff0000, v42
    v_mul_f32 v44, v44, v40
    v_mul_f32 v45, v45, v40
    v_mul_f32 v46, v46, v40
    v_mul_f32 v47, v47, v40
    v_cvt_pk_bf16_f32 v48, v44, v45
    v_cvt_pk_bf16_f32 v49, v46, v47
    s_mov_b32 s21, 98304
    buffer_store_dwordx2 v[48:49], v2, s[12:15], s21 offen offset:32
    s_waitcnt vmcnt(0)
L_end_o_0_kernel:
    s_endpgm
.globl proj_0_kernel
.p2align 8
.type proj_0_kernel,@function
proj_0_kernel:
    s_cmp_ge_u32 s2, 256
    s_cbranch_scc1 L_end_proj_0_kernel
    s_load_dwordx2 s[40:41], s[0:1], 80
    s_load_dwordx2 s[42:43], s[0:1], 16
    s_load_dwordx2 s[50:51], s[0:1], 80
    s_load_dwordx2 s[54:55], s[0:1], 0
    v_and_b32 v1, 63, v0
    v_lshrrev_b32 v2, 6, v0
    s_and_b32 s24, s2, 15
    v_readfirstlane_b32 s26, v2
    s_lshr_b32 s25, s2, 4
    s_nop 1
    s_lshr_b32 s27, s26, 2
    s_and_b32 s28, s26, 1
    s_bfe_u32 s29, s26, 0x10001
    v_lshrrev_b32 v2, 3, v1
    v_and_b32 v3, 7, v1
    v_xor_b32 v3, v3, v2
    s_lshl_b32 s38, s26, 4
    s_lshl_b32 s39, s24, 7
    s_add_u32 s38, s38, s39
    v_add_u32 v4, s38, v2
    s_mov_b32 s38, 2048
    v_mul_lo_u32 v4, v4, s38
    v_lshlrev_b32 v3, 4, v3
    v_add_u32 v10, v4, v3
    v_add_u32 v11, 16384, v10
    v_lshrrev_b32 v2, 3, v1
    s_lshl_b32 s38, s26, 3
    v_add_u32 v2, s38, v2
    s_mov_b32 s38, 2048
    v_mul_lo_u32 v2, v2, s38
    v_bfe_u32 v3, v1, 1, 2
    v_bfe_u32 v4, v1, 4, 1
    s_and_b32 s38, s26, 1
    s_lshl_b32 s38, s38, 1
    v_or_b32 v4, s38, v4
    v_xor_b32 v3, v3, v4
    v_lshlrev_b32 v3, 5, v3
    v_and_b32 v4, 1, v1
    v_lshlrev_b32 v4, 4, v4
    v_add3_u32 v12, v2, v3, v4
    v_and_b32 v2, 15, v1
    s_lshl_b32 s38, s28, 6
    v_add_u32 v2, s38, v2
    v_lshlrev_b32 v2, 7, v2
    v_lshrrev_b32 v3, 4, v1
    s_lshl_b32 s38, s27, 2
    v_add_u32 v3, s38, v3
    v_and_b32 v4, 7, v1
    v_xor_b32 v3, v3, v4
    v_lshlrev_b32 v3, 4, v3
    v_add_u32 v13, v2, v3
    v_lshrrev_b32 v2, 4, v1
    v_lshlrev_b32 v2, 3, v2
    v_bfe_u32 v3, v1, 2, 2
    v_add_u32 v2, v2, v3
    v_lshlrev_b32 v2, 7, v2
    v_and_b32 v3, 3, v1
    v_lshlrev_b32 v3, 3, v3
    v_add_u32 v2, v2, v3
    s_lshl_b32 s38, s27, 12
    s_add_u32 s38, s38, 16384
    v_add_u32 v2, s38, v2
    v_bfe_u32 v3, v1, 3, 1
    v_bfe_u32 v4, v1, 4, 1
    v_lshlrev_b32 v4, 1, v4
    v_or_b32 v3, v3, v4
    s_lshl_b32 s38, s29, 1
    v_xor_b32 v4, s38, v3
    v_lshlrev_b32 v4, 5, v4
    v_add_u32 v14, v2, v4
    v_xor_b32 v4, 32, v4
    v_add_u32 v15, v2, v4
    s_waitcnt lgkmcnt(0)
    s_add_u32 s4, s40, 8388608
    s_addc_u32 s5, s41, 0
    s_mov_b32 s6, 4194304
    s_mov_b32 s7, 0x00020000
    s_mov_b32 s8, s42
    s_mov_b32 s9, s43
    s_mov_b32 s10, 2097152
    s_mov_b32 s11, 0x00020000
    s_mov_b32 s31, 0
    s_mul_i32 s32, s25, 128
    s_mov_b32 s36, 0
    s_lshl_b32 s44, s26, 11
    s_add_u32 s45, s44, 1024
    s_lshl_b32 s46, s26, 10
    s_add_u32 s46, s46, 16384
    s_add_u32 m0, s36, s44
    s_nop 0
    buffer_load_dwordx4 v10, s[4:7], s31 offen lds
    s_add_u32 m0, s36, s45
    s_nop 0
    buffer_load_dwordx4 v11, s[4:7], s31 offen lds
    s_add_u32 m0, s36, s46
    s_nop 0
    buffer_load_dwordx4 v12, s[8:11], s32 offen lds
    s_add_u32 s31, s31, 128
    s_add_u32 s32, s32, 131072
    s_add_u32 s36, s36, 24576
    s_cmp_ge_u32 s36, 147456
    s_cselect_b32 s36, 0, s36
    v_mov_b32 v68, 0
    v_mov_b32 v69, 0
    v_mov_b32 v70, 0
    v_mov_b32 v71, 0
    v_mov_b32 v72, 0
    v_mov_b32 v73, 0
    v_mov_b32 v74, 0
    v_mov_b32 v75, 0
    v_mov_b32 v76, 0
    v_mov_b32 v77, 0
    v_mov_b32 v78, 0
    v_mov_b32 v79, 0
    v_mov_b32 v80, 0
    v_mov_b32 v81, 0
    v_mov_b32 v82, 0
    v_mov_b32 v83, 0
    v_mov_b32 v84, 0
    v_mov_b32 v85, 0
    v_mov_b32 v86, 0
    v_mov_b32 v87, 0
    v_mov_b32 v88, 0
    v_mov_b32 v89, 0
    v_mov_b32 v90, 0
    v_mov_b32 v91, 0
    v_mov_b32 v92, 0
    v_mov_b32 v93, 0
    v_mov_b32 v94, 0
    v_mov_b32 v95, 0
    v_mov_b32 v96, 0
    v_mov_b32 v97, 0
    v_mov_b32 v98, 0
    v_mov_b32 v99, 0
    s_add_u32 m0, s36, s44
    s_nop 0
    buffer_load_dwordx4 v10, s[4:7], s31 offen lds
    s_add_u32 m0, s36, s45
    s_nop 0
    buffer_load_dwordx4 v11, s[4:7], s31 offen lds
    s_add_u32 m0, s36, s46
    s_nop 0
    buffer_load_dwordx4 v12, s[8:11], s32 offen lds
    s_add_u32 s31, s31, 128
    s_add_u32 s32, s32, 131072
    s_add_u32 s36, s36, 24576
    s_cmp_ge_u32 s36, 147456
    s_cselect_b32 s36, 0, s36
    s_add_u32 m0, s36, s44
    s_nop 0
    buffer_load_dwordx4 v10, s[4:7], s31 offen lds
    s_add_u32 m0, s36, s45
    s_nop 0
    buffer_load_dwordx4 v11, s[4:7], s31 offen lds
    s_add_u32 m0, s36, s46
    s_nop 0
    buffer_load_dwordx4 v12, s[8:11], s32 offen lds
    s_add_u32 s31, s31, 128
    s_add_u32 s32, s32, 131072
    s_add_u32 s36, s36, 24576
    s_cmp_ge_u32 s36, 147456
    s_cselect_b32 s36, 0, s36
    s_add_u32 m0, s36, s44
    s_nop 0
    buffer_load_dwordx4 v10, s[4:7], s31 offen lds
    s_add_u32 m0, s36, s45
    s_nop 0
    buffer_load_dwordx4 v11, s[4:7], s31 offen lds
    s_add_u32 m0, s36, s46
    s_nop 0
    buffer_load_dwordx4 v12, s[8:11], s32 offen lds
    s_add_u32 s31, s31, 128
    s_add_u32 s32, s32, 131072
    s_add_u32 s36, s36, 24576
    s_cmp_ge_u32 s36, 147456
    s_cselect_b32 s36, 0, s36
    s_add_u32 m0, s36, s44
    s_nop 0
    buffer_load_dwordx4 v10, s[4:7], s31 offen lds
    s_add_u32 m0, s36, s45
    s_nop 0
    buffer_load_dwordx4 v11, s[4:7], s31 offen lds
    s_add_u32 m0, s36, s46
    s_nop 0
    buffer_load_dwordx4 v12, s[8:11], s32 offen lds
    s_add_u32 s31, s31, 128
    s_add_u32 s32, s32, 131072
    s_add_u32 s36, s36, 24576
    s_cmp_ge_u32 s36, 147456
    s_cselect_b32 s36, 0, s36
    s_add_u32 m0, s36, s44
    s_nop 0
    buffer_load_dwordx4 v10, s[4:7], s31 offen lds
    s_add_u32 m0, s36, s45
    s_nop 0
    buffer_load_dwordx4 v11, s[4:7], s31 offen lds
    s_add_u32 m0, s36, s46
    s_nop 0
    buffer_load_dwordx4 v12, s[8:11], s32 offen lds
    s_add_u32 s31, s31, 128
    s_add_u32 s32, s32, 131072
    s_add_u32 s36, s36, 24576
    s_cmp_ge_u32 s36, 147456
    s_cselect_b32 s36, 0, s36
    s_mov_b32 s37, 0
    s_waitcnt vmcnt(15)
    s_barrier
    v_add_u32 v16, s37, v13
    v_add_u32 v17, s37, v14
    v_add_u32 v18, s37, v15
    s_add_u32 s37, s37, 24576
    s_cmp_ge_u32 s37, 147456
    s_cselect_b32 s37, 0, s37
    ds_read_b128 v[20:23], v16 offset:0
    ds_read_b128 v[24:27], v16 offset:2048
    ds_read_b128 v[28:31], v16 offset:4096
    ds_read_b128 v[32:35], v16 offset:6144
    ds_read_b64_tr_b16 v[52:53], v17 offset:0
    ds_read_b64_tr_b16 v[54:55], v17 offset:512
    ds_read_b64_tr_b16 v[56:57], v18 offset:0
    ds_read_b64_tr_b16 v[58:59], v18 offset:512
    s_mov_b32 s30, 5
L_loop_proj_0_kernel:
    s_waitcnt lgkmcnt(0)
    v_mfma_f32_16x16x32_bf16 v[68:71], v[52:55], v[20:23], v[68:71]
    v_mfma_f32_16x16x32_bf16 v[72:75], v[56:59], v[20:23], v[72:75]
    v_mfma_f32_16x16x32_bf16 v[76:79], v[52:55], v[24:27], v[76:79]
    v_mfma_f32_16x16x32_bf16 v[80:83], v[56:59], v[24:27], v[80:83]
    s_waitcnt vmcnt(12)
    s_barrier
    v_add_u32 v16, s37, v13
    v_add_u32 v17, s37, v14
    v_add_u32 v18, s37, v15
    s_add_u32 s37, s37, 24576
    s_cmp_ge_u32 s37, 147456
    s_cselect_b32 s37, 0, s37
    ds_read_b128 v[36:39], v16 offset:0
    ds_read_b128 v[40:43], v16 offset:2048
    ds_read_b128 v[44:47], v16 offset:4096
    ds_read_b128 v[48:51], v16 offset:6144
    ds_read_b64_tr_b16 v[60:61], v17 offset:0
    ds_read_b64_tr_b16 v[62:63], v17 offset:512
    ds_read_b64_tr_b16 v[64:65], v18 offset:0
    ds_read_b64_tr_b16 v[66:67], v18 offset:512
    s_add_u32 m0, s36, s44
    v_mfma_f32_16x16x32_bf16 v[84:87], v[52:55], v[28:31], v[84:87]
    buffer_load_dwordx4 v10, s[4:7], s31 offen lds
    s_add_u32 m0, s36, s45
    v_mfma_f32_16x16x32_bf16 v[88:91], v[56:59], v[28:31], v[88:91]
    buffer_load_dwordx4 v11, s[4:7], s31 offen lds
    s_add_u32 m0, s36, s46
    v_mfma_f32_16x16x32_bf16 v[92:95], v[52:55], v[32:35], v[92:95]
    buffer_load_dwordx4 v12, s[8:11], s32 offen lds
    v_mfma_f32_16x16x32_bf16 v[96:99], v[56:59], v[32:35], v[96:99]
    s_add_u32 s31, s31, 128
    s_add_u32 s32, s32, 131072
    s_add_u32 s36, s36, 24576
    s_cmp_ge_u32 s36, 147456
    s_cselect_b32 s36, 0, s36
    s_waitcnt lgkmcnt(0)
    v_mfma_f32_16x16x32_bf16 v[68:71], v[60:63], v[36:39], v[68:71]
    v_mfma_f32_16x16x32_bf16 v[72:75], v[64:67], v[36:39], v[72:75]
    v_mfma_f32_16x16x32_bf16 v[76:79], v[60:63], v[40:43], v[76:79]
    v_mfma_f32_16x16x32_bf16 v[80:83], v[64:67], v[40:43], v[80:83]
    s_waitcnt vmcnt(12)
    s_barrier
    v_add_u32 v16, s37, v13
    v_add_u32 v17, s37, v14
    v_add_u32 v18, s37, v15
    s_add_u32 s37, s37, 24576
    s_cmp_ge_u32 s37, 147456
    s_cselect_b32 s37, 0, s37
    ds_read_b128 v[20:23], v16 offset:0
    ds_read_b128 v[24:27], v16 offset:2048
    ds_read_b128 v[28:31], v16 offset:4096
    ds_read_b128 v[32:35], v16 offset:6144
    ds_read_b64_tr_b16 v[52:53], v17 offset:0
    ds_read_b64_tr_b16 v[54:55], v17 offset:512
    ds_read_b64_tr_b16 v[56:57], v18 offset:0
    ds_read_b64_tr_b16 v[58:59], v18 offset:512
    s_add_u32 m0, s36, s44
    v_mfma_f32_16x16x32_bf16 v[84:87], v[60:63], v[44:47], v[84:87]
    buffer_load_dwordx4 v10, s[4:7], s31 offen lds
    s_add_u32 m0, s36, s45
    v_mfma_f32_16x16x32_bf16 v[88:91], v[64:67], v[44:47], v[88:91]
    buffer_load_dwordx4 v11, s[4:7], s31 offen lds
    s_add_u32 m0, s36, s46
    v_mfma_f32_16x16x32_bf16 v[92:95], v[60:63], v[48:51], v[92:95]
    buffer_load_dwordx4 v12, s[8:11], s32 offen lds
    v_mfma_f32_16x16x32_bf16 v[96:99], v[64:67], v[48:51], v[96:99]
    s_add_u32 s31, s31, 128
    s_add_u32 s32, s32, 131072
    s_add_u32 s36, s36, 24576
    s_cmp_ge_u32 s36, 147456
    s_cselect_b32 s36, 0, s36
    s_sub_u32 s30, s30, 1
    s_cmp_lg_u32 s30, 0
    s_cbranch_scc1 L_loop_proj_0_kernel
    s_waitcnt lgkmcnt(0)
    v_mfma_f32_16x16x32_bf16 v[68:71], v[52:55], v[20:23], v[68:71]
    v_mfma_f32_16x16x32_bf16 v[72:75], v[56:59], v[20:23], v[72:75]
    v_mfma_f32_16x16x32_bf16 v[76:79], v[52:55], v[24:27], v[76:79]
    v_mfma_f32_16x16x32_bf16 v[80:83], v[56:59], v[24:27], v[80:83]
    s_waitcnt vmcnt(12)
    s_barrier
    v_add_u32 v16, s37, v13
    v_add_u32 v17, s37, v14
    v_add_u32 v18, s37, v15
    s_add_u32 s37, s37, 24576
    s_cmp_ge_u32 s37, 147456
    s_cselect_b32 s37, 0, s37
    ds_read_b128 v[36:39], v16 offset:0
    ds_read_b128 v[40:43], v16 offset:2048
    ds_read_b128 v[44:47], v16 offset:4096
    ds_read_b128 v[48:51], v16 offset:6144
    ds_read_b64_tr_b16 v[60:61], v17 offset:0
    ds_read_b64_tr_b16 v[62:63], v17 offset:512
    ds_read_b64_tr_b16 v[64:65], v18 offset:0
    ds_read_b64_tr_b16 v[66:67], v18 offset:512
    v_mfma_f32_16x16x32_bf16 v[84:87], v[52:55], v[28:31], v[84:87]
    v_mfma_f32_16x16x32_bf16 v[88:91], v[56:59], v[28:31], v[88:91]
    v_mfma_f32_16x16x32_bf16 v[92:95], v[52:55], v[32:35], v[92:95]
    v_mfma_f32_16x16x32_bf16 v[96:99], v[56:59], v[32:35], v[96:99]
    s_waitcnt lgkmcnt(0)
    v_mfma_f32_16x16x32_bf16 v[68:71], v[60:63], v[36:39], v[68:71]
    v_mfma_f32_16x16x32_bf16 v[72:75], v[64:67], v[36:39], v[72:75]
    v_mfma_f32_16x16x32_bf16 v[76:79], v[60:63], v[40:43], v[76:79]
    v_mfma_f32_16x16x32_bf16 v[80:83], v[64:67], v[40:43], v[80:83]
    s_waitcnt vmcnt(9)
    s_barrier
    v_add_u32 v16, s37, v13
    v_add_u32 v17, s37, v14
    v_add_u32 v18, s37, v15
    s_add_u32 s37, s37, 24576
    s_cmp_ge_u32 s37, 147456
    s_cselect_b32 s37, 0, s37
    ds_read_b128 v[20:23], v16 offset:0
    ds_read_b128 v[24:27], v16 offset:2048
    ds_read_b128 v[28:31], v16 offset:4096
    ds_read_b128 v[32:35], v16 offset:6144
    ds_read_b64_tr_b16 v[52:53], v17 offset:0
    ds_read_b64_tr_b16 v[54:55], v17 offset:512
    ds_read_b64_tr_b16 v[56:57], v18 offset:0
    ds_read_b64_tr_b16 v[58:59], v18 offset:512
    v_mfma_f32_16x16x32_bf16 v[84:87], v[60:63], v[44:47], v[84:87]
    v_mfma_f32_16x16x32_bf16 v[88:91], v[64:67], v[44:47], v[88:91]
    v_mfma_f32_16x16x32_bf16 v[92:95], v[60:63], v[48:51], v[92:95]
    v_mfma_f32_16x16x32_bf16 v[96:99], v[64:67], v[48:51], v[96:99]
    s_waitcnt lgkmcnt(0)
    v_mfma_f32_16x16x32_bf16 v[68:71], v[52:55], v[20:23], v[68:71]
    v_mfma_f32_16x16x32_bf16 v[72:75], v[56:59], v[20:23], v[72:75]
    v_mfma_f32_16x16x32_bf16 v[76:79], v[52:55], v[24:27], v[76:79]
    v_mfma_f32_16x16x32_bf16 v[80:83], v[56:59], v[24:27], v[80:83]
    s_waitcnt vmcnt(6)
    s_barrier
    v_add_u32 v16, s37, v13
    v_add_u32 v17, s37, v14
    v_add_u32 v18, s37, v15
    s_add_u32 s37, s37, 24576
    s_cmp_ge_u32 s37, 147456
    s_cselect_b32 s37, 0, s37
    ds_read_b128 v[36:39], v16 offset:0
    ds_read_b128 v[40:43], v16 offset:2048
    ds_read_b128 v[44:47], v16 offset:4096
    ds_read_b128 v[48:51], v16 offset:6144
    ds_read_b64_tr_b16 v[60:61], v17 offset:0
    ds_read_b64_tr_b16 v[62:63], v17 offset:512
    ds_read_b64_tr_b16 v[64:65], v18 offset:0
    ds_read_b64_tr_b16 v[66:67], v18 offset:512
    v_mfma_f32_16x16x32_bf16 v[84:87], v[52:55], v[28:31], v[84:87]
    v_mfma_f32_16x16x32_bf16 v[88:91], v[56:59], v[28:31], v[88:91]
    v_mfma_f32_16x16x32_bf16 v[92:95], v[52:55], v[32:35], v[92:95]
    v_mfma_f32_16x16x32_bf16 v[96:99], v[56:59], v[32:35], v[96:99]
    s_waitcnt lgkmcnt(0)
    v_mfma_f32_16x16x32_bf16 v[68:71], v[60:63], v[36:39], v[68:71]
    v_mfma_f32_16x16x32_bf16 v[72:75], v[64:67], v[36:39], v[72:75]
    v_mfma_f32_16x16x32_bf16 v[76:79], v[60:63], v[40:43], v[76:79]
    v_mfma_f32_16x16x32_bf16 v[80:83], v[64:67], v[40:43], v[80:83]
    s_waitcnt vmcnt(3)
    s_barrier
    v_add_u32 v16, s37, v13
    v_add_u32 v17, s37, v14
    v_add_u32 v18, s37, v15
    s_add_u32 s37, s37, 24576
    s_cmp_ge_u32 s37, 147456
    s_cselect_b32 s37, 0, s37
    ds_read_b128 v[20:23], v16 offset:0
    ds_read_b128 v[24:27], v16 offset:2048
    ds_read_b128 v[28:31], v16 offset:4096
    ds_read_b128 v[32:35], v16 offset:6144
    ds_read_b64_tr_b16 v[52:53], v17 offset:0
    ds_read_b64_tr_b16 v[54:55], v17 offset:512
    ds_read_b64_tr_b16 v[56:57], v18 offset:0
    ds_read_b64_tr_b16 v[58:59], v18 offset:512
    v_mfma_f32_16x16x32_bf16 v[84:87], v[60:63], v[44:47], v[84:87]
    v_mfma_f32_16x16x32_bf16 v[88:91], v[64:67], v[44:47], v[88:91]
    v_mfma_f32_16x16x32_bf16 v[92:95], v[60:63], v[48:51], v[92:95]
    v_mfma_f32_16x16x32_bf16 v[96:99], v[64:67], v[48:51], v[96:99]
    s_waitcnt lgkmcnt(0)
    v_mfma_f32_16x16x32_bf16 v[68:71], v[52:55], v[20:23], v[68:71]
    v_mfma_f32_16x16x32_bf16 v[72:75], v[56:59], v[20:23], v[72:75]
    v_mfma_f32_16x16x32_bf16 v[76:79], v[52:55], v[24:27], v[76:79]
    v_mfma_f32_16x16x32_bf16 v[80:83], v[56:59], v[24:27], v[80:83]
    s_waitcnt vmcnt(0)
    s_barrier
    v_add_u32 v16, s37, v13
    v_add_u32 v17, s37, v14
    v_add_u32 v18, s37, v15
    s_add_u32 s37, s37, 24576
    s_cmp_ge_u32 s37, 147456
    s_cselect_b32 s37, 0, s37
    ds_read_b128 v[36:39], v16 offset:0
    ds_read_b128 v[40:43], v16 offset:2048
    ds_read_b128 v[44:47], v16 offset:4096
    ds_read_b128 v[48:51], v16 offset:6144
    ds_read_b64_tr_b16 v[60:61], v17 offset:0
    ds_read_b64_tr_b16 v[62:63], v17 offset:512
    ds_read_b64_tr_b16 v[64:65], v18 offset:0
    ds_read_b64_tr_b16 v[66:67], v18 offset:512
    v_mfma_f32_16x16x32_bf16 v[84:87], v[52:55], v[28:31], v[84:87]
    v_mfma_f32_16x16x32_bf16 v[88:91], v[56:59], v[28:31], v[88:91]
    v_mfma_f32_16x16x32_bf16 v[92:95], v[52:55], v[32:35], v[92:95]
    v_mfma_f32_16x16x32_bf16 v[96:99], v[56:59], v[32:35], v[96:99]
    s_waitcnt lgkmcnt(0)
    v_mfma_f32_16x16x32_bf16 v[68:71], v[60:63], v[36:39], v[68:71]
    v_mfma_f32_16x16x32_bf16 v[72:75], v[64:67], v[36:39], v[72:75]
    v_mfma_f32_16x16x32_bf16 v[76:79], v[60:63], v[40:43], v[76:79]
    v_mfma_f32_16x16x32_bf16 v[80:83], v[64:67], v[40:43], v[80:83]
    v_mfma_f32_16x16x32_bf16 v[84:87], v[60:63], v[44:47], v[84:87]
    v_mfma_f32_16x16x32_bf16 v[88:91], v[64:67], v[44:47], v[88:91]
    v_mfma_f32_16x16x32_bf16 v[92:95], v[60:63], v[48:51], v[92:95]
    v_mfma_f32_16x16x32_bf16 v[96:99], v[64:67], v[48:51], v[96:99]
    s_waitcnt vmcnt(0) lgkmcnt(0)
    s_barrier
    s_xor_b32 s38, s26, 4
    s_mul_i32 s38, s38, 4096
    v_lshlrev_b32 v2, 4, v1
    v_add_u32 v2, s38, v2
    s_nop 7
    s_cmp_eq_u32 s27, 0
    s_cbranch_scc0 L_give1_proj_0_kernel
    ds_write_b128 v2, v[84:87] offset:0
    ds_write_b128 v2, v[88:91] offset:1024
    ds_write_b128 v2, v[92:95] offset:2048
    ds_write_b128 v2, v[96:99] offset:3072
    s_branch L_give_done_proj_0_kernel
L_give1_proj_0_kernel:
    ds_write_b128 v2, v[68:71] offset:0
    ds_write_b128 v2, v[72:75] offset:1024
    ds_write_b128 v2, v[76:79] offset:2048
    ds_write_b128 v2, v[80:83] offset:3072
L_give_done_proj_0_kernel:
    s_waitcnt lgkmcnt(0)
    s_barrier
    s_mul_i32 s38, s26, 4096
    v_lshlrev_b32 v2, 4, v1
    v_add_u32 v2, s38, v2
    s_mul_i32 s38, s27, 16
    s_cmp_eq_u32 s27, 0
    s_cbranch_scc0 L_keep1_proj_0_kernel
    ds_read_b128 v[20:23], v2 offset:0
    ds_read_b128 v[24:27], v2 offset:1024
    ds_read_b128 v[28:31], v2 offset:2048
    ds_read_b128 v[32:35], v2 offset:3072
    s_waitcnt lgkmcnt(0)
    v_add_f32 v20, v68, v20
    v_add_f32 v21, v69, v21
    v_add_f32 v22, v70, v22
    v_add_f32 v23, v71, v23
    v_add_f32 v24, v72, v24
    v_add_f32 v25, v73, v25
    v_add_f32 v26, v74, v26
    v_add_f32 v27, v75, v27
    v_add_f32 v28, v76, v28
    v_add_f32 v29, v77, v29
    v_add_f32 v30, v78, v30
    v_add_f32 v31, v79, v31
    v_add_f32 v32, v80, v32
    v_add_f32 v33, v81, v33
    v_add_f32 v34, v82, v34
    v_add_f32 v35, v83, v35
    s_branch L_keep_done_proj_0_kernel
L_keep1_proj_0_kernel:
    ds_read_b128 v[20:23], v2 offset:0
    ds_read_b128 v[24:27], v2 offset:1024
    ds_read_b128 v[28:31], v2 offset:2048
    ds_read_b128 v[32:35], v2 offset:3072
    s_waitcnt lgkmcnt(0)
    v_add_f32 v20, v84, v20
    v_add_f32 v21, v85, v21
    v_add_f32 v22, v86, v22
    v_add_f32 v23, v87, v23
    v_add_f32 v24, v88, v24
    v_add_f32 v25, v89, v25
    v_add_f32 v26, v90, v26
    v_add_f32 v27, v91, v27
    v_add_f32 v28, v92, v28
    v_add_f32 v29, v93, v29
    v_add_f32 v30, v94, v30
    v_add_f32 v31, v95, v31
    v_add_f32 v32, v96, v32
    v_add_f32 v33, v97, v33
    v_add_f32 v34, v98, v34
    v_add_f32 v35, v99, v35
L_keep_done_proj_0_kernel:
    s_add_u32 s12, s50, 12582912
    s_addc_u32 s13, s51, 0
    s_mov_b32 s14, 4194304
    s_mov_b32 s15, 0x00020000
    s_mov_b32 s16, s54
    s_mov_b32 s17, s55
    s_mov_b32 s18, 4194304
    s_mov_b32 s19, 0x00020000
    v_and_b32 v2, 15, v1
    s_lshl_b32 s38, s24, 7
    s_lshl_b32 s39, s28, 6
    s_add_u32 s38, s38, s39
    s_lshl_b32 s39, s27, 5
    s_add_u32 s38, s38, s39
    v_add_u32 v2, s38, v2
    s_mov_b32 s38, 2048
    v_mul_lo_u32 v2, v2, s38
    v_lshrrev_b32 v3, 4, v1
    v_lshlrev_b32 v3, 3, v3
    s_lshl_b32 s38, s29, 6
    s_mul_i32 s39, s25, 128
    s_add_u32 s38, s38, s39
    v_add3_u32 v2, v2, v3, s38
    s_mov_b32 s39, 0
    buffer_load_dwordx2 v[36:37], v2, s[16:19], s39 offen offset:0
    s_mov_b32 s39, 0
    buffer_load_dwordx2 v[38:39], v2, s[16:19], s39 offen offset:32
    s_mov_b32 s39, 32768
    buffer_load_dwordx2 v[40:41], v2, s[16:19], s39 offen offset:0
    s_mov_b32 s39, 32768
    buffer_load_dwordx2 v[42:43], v2, s[16:19], s39 offen offset:32
    s_waitcnt vmcnt(0)
    v_cvt_pk_bf16_f32 v4, v20, v21
    v_lshlrev_b32 v20, 16, v4
    v_and_b32 v21, 0xffff0000, v4
    v_cvt_pk_bf16_f32 v4, v22, v23
    v_lshlrev_b32 v22, 16, v4
    v_and_b32 v23, 0xffff0000, v4
    v_lshlrev_b32 v4, 16, v36
    v_add_f32 v20, v4, v20
    v_and_b32 v4, 0xffff0000, v36
    v_add_f32 v21, v4, v21
    v_lshlrev_b32 v4, 16, v37
    v_add_f32 v22, v4, v22
    v_and_b32 v4, 0xffff0000, v37
    v_add_f32 v23, v4, v23
    v_cvt_pk_bf16_f32 v4, v20, v21
    v_cvt_pk_bf16_f32 v5, v22, v23
    s_mov_b32 s39, 0
    buffer_store_dwordx2 v[4:5], v2, s[12:15], s39 offen offset:0
    v_cvt_pk_bf16_f32 v4, v24, v25
    v_lshlrev_b32 v24, 16, v4
    v_and_b32 v25, 0xffff0000, v4
    v_cvt_pk_bf16_f32 v4, v26, v27
    v_lshlrev_b32 v26, 16, v4
    v_and_b32 v27, 0xffff0000, v4
    v_lshlrev_b32 v4, 16, v38
    v_add_f32 v24, v4, v24
    v_and_b32 v4, 0xffff0000, v38
    v_add_f32 v25, v4, v25
    v_lshlrev_b32 v4, 16, v39
    v_add_f32 v26, v4, v26
    v_and_b32 v4, 0xffff0000, v39
    v_add_f32 v27, v4, v27
    v_cvt_pk_bf16_f32 v4, v24, v25
    v_cvt_pk_bf16_f32 v5, v26, v27
    s_mov_b32 s39, 0
    buffer_store_dwordx2 v[4:5], v2, s[12:15], s39 offen offset:32
    v_cvt_pk_bf16_f32 v4, v28, v29
    v_lshlrev_b32 v28, 16, v4
    v_and_b32 v29, 0xffff0000, v4
    v_cvt_pk_bf16_f32 v4, v30, v31
    v_lshlrev_b32 v30, 16, v4
    v_and_b32 v31, 0xffff0000, v4
    v_lshlrev_b32 v4, 16, v40
    v_add_f32 v28, v4, v28
    v_and_b32 v4, 0xffff0000, v40
    v_add_f32 v29, v4, v29
    v_lshlrev_b32 v4, 16, v41
    v_add_f32 v30, v4, v30
    v_and_b32 v4, 0xffff0000, v41
    v_add_f32 v31, v4, v31
    v_cvt_pk_bf16_f32 v4, v28, v29
    v_cvt_pk_bf16_f32 v5, v30, v31
    s_mov_b32 s39, 32768
    buffer_store_dwordx2 v[4:5], v2, s[12:15], s39 offen offset:0
    v_cvt_pk_bf16_f32 v4, v32, v33
    v_lshlrev_b32 v32, 16, v4
    v_and_b32 v33, 0xffff0000, v4
    v_cvt_pk_bf16_f32 v4, v34, v35
    v_lshlrev_b32 v34, 16, v4
    v_and_b32 v35, 0xffff0000, v4
    v_lshlrev_b32 v4, 16, v42
    v_add_f32 v32, v4, v32
    v_and_b32 v4, 0xffff0000, v42
    v_add_f32 v33, v4, v33
    v_lshlrev_b32 v4, 16, v43
    v_add_f32 v34, v4, v34
    v_and_b32 v4, 0xffff0000, v43
    v_add_f32 v35, v4, v35
    v_cvt_pk_bf16_f32 v4, v32, v33
    v_cvt_pk_bf16_f32 v5, v34, v35
    s_mov_b32 s39, 32768
    buffer_store_dwordx2 v[4:5], v2, s[12:15], s39 offen offset:32
    s_waitcnt vmcnt(0)
    s_waitcnt vmcnt(0)
L_end_proj_0_kernel:
    s_endpgm
.globl ln2_0_kernel
.p2align 8
.type ln2_0_kernel,@function
ln2_0_kernel:
    s_cmp_ge_u32 s2, 512
    s_cbranch_scc1 L_end_ln2_0_kernel
    s_load_dwordx2 s[4:5], s[0:1], 80
    s_load_dwordx2 s[6:7], s[0:1], 80
    v_lshrrev_b32 v2, 6, v0
    v_and_b32 v1, 63, v0
    s_lshl_b32 s3, s2, 2
    v_add_u32 v2, s3, v2
    v_lshlrev_b32 v2, 11, v2
    v_lshlrev_b32 v3, 4, v1
    v_add_u32 v2, v2, v3
    s_waitcnt lgkmcnt(0)
    s_add_u32 s8, s4, 12582912
    s_addc_u32 s9, s5, 0
    s_mov_b32 s10, 4194304
    s_mov_b32 s11, 0x00020000
    s_add_u32 s12, s6, 0
    s_addc_u32 s13, s7, 0
    s_mov_b32 s14, 4194304
    s_mov_b32 s15, 0x00020000
    buffer_load_dwordx4 v[4:7], v2, s[8:11], 0 offen
    buffer_load_dwordx4 v[8:11], v2, s[8:11], 0 offen offset:1024
    s_waitcnt vmcnt(0)
    v_lshlrev_b32 v20, 16, v4
    v_and_b32 v21, 0xffff0000, v4
    v_lshlrev_b32 v22, 16, v5
    v_and_b32 v23, 0xffff0000, v5
    v_lshlrev_b32 v24, 16, v6
    v_and_b32 v25, 0xffff0000, v6
    v_lshlrev_b32 v26, 16, v7
    v_and_b32 v27, 0xffff0000, v7
    v_lshlrev_b32 v28, 16, v8
    v_and_b32 v29, 0xffff0000, v8
    v_lshlrev_b32 v30, 16, v9
    v_and_b32 v31, 0xffff0000, v9
    v_lshlrev_b32 v32, 16, v10
    v_and_b32 v33, 0xffff0000, v10
    v_lshlrev_b32 v34, 16, v11
    v_and_b32 v35, 0xffff0000, v11
    v_add_f32 v40, v20, v21
    v_add_f32 v40, v40, v22
    v_add_f32 v40, v40, v23
    v_add_f32 v40, v40, v24
    v_add_f32 v40, v40, v25
    v_add_f32 v40, v40, v26
    v_add_f32 v40, v40, v27
    v_add_f32 v40, v40, v28
    v_add_f32 v40, v40, v29
    v_add_f32 v40, v40, v30
    v_add_f32 v40, v40, v31
    v_add_f32 v40, v40, v32
    v_add_f32 v40, v40, v33
    v_add_f32 v40, v40, v34
    v_add_f32 v40, v40, v35
    s_nop 1
    v_add_f32_dpp v40, v40, v40 quad_perm:[1,0,3,2] row_mask:0xf bank_mask:0xf
    s_nop 1
    v_add_f32_dpp v40, v40, v40 quad_perm:[2,3,0,1] row_mask:0xf bank_mask:0xf
    s_nop 1
    v_add_f32_dpp v40, v40, v40 row_ror:4 row_mask:0xf bank_mask:0xf
    s_nop 1
    v_add_f32_dpp v40, v40, v40 row_ror:8 row_mask:0xf bank_mask:0xf
    v_mov_b32 v41, v40
    s_nop 1
    v_permlane16_swap_b32 v40, v41
    s_nop 1
    v_add_f32 v40, v40, v41
    v_mov_b32 v41, v40
    s_nop 1
    v_permlane32_swap_b32 v40, v41
    s_nop 1
    v_add_f32 v40, v40, v41
    v_mul_f32 v40, 0x3a800000, v40
    v_sub_f32 v42, v20, v40
    v_mul_f32 v43, v42, v42
    v_sub_f32 v42, v21, v40
    v_fmac_f32 v43, v42, v42
    v_sub_f32 v42, v22, v40
    v_fmac_f32 v43, v42, v42
    v_sub_f32 v42, v23, v40
    v_fmac_f32 v43, v42, v42
    v_sub_f32 v42, v24, v40
    v_fmac_f32 v43, v42, v42
    v_sub_f32 v42, v25, v40
    v_fmac_f32 v43, v42, v42
    v_sub_f32 v42, v26, v40
    v_fmac_f32 v43, v42, v42
    v_sub_f32 v42, v27, v40
    v_fmac_f32 v43, v42, v42
    v_sub_f32 v42, v28, v40
    v_fmac_f32 v43, v42, v42
    v_sub_f32 v42, v29, v40
    v_fmac_f32 v43, v42, v42
    v_sub_f32 v42, v30, v40
    v_fmac_f32 v43, v42, v42
    v_sub_f32 v42, v31, v40
    v_fmac_f32 v43, v42, v42
    v_sub_f32 v42, v32, v40
    v_fmac_f32 v43, v42, v42
    v_sub_f32 v42, v33, v40
    v_fmac_f32 v43, v42, v42
    v_sub_f32 v42, v34, v40
    v_fmac_f32 v43, v42, v42
    v_sub_f32 v42, v35, v40
    v_fmac_f32 v43, v42, v42
    s_nop 1
    v_add_f32_dpp v43, v43, v43 quad_perm:[1,0,3,2] row_mask:0xf bank_mask:0xf
    s_nop 1
    v_add_f32_dpp v43, v43, v43 quad_perm:[2,3,0,1] row_mask:0xf bank_mask:0xf
    s_nop 1
    v_add_f32_dpp v43, v43, v43 row_ror:4 row_mask:0xf bank_mask:0xf
    s_nop 1
    v_add_f32_dpp v43, v43, v43 row_ror:8 row_mask:0xf bank_mask:0xf
    v_mov_b32 v41, v43
    s_nop 1
    v_permlane16_swap_b32 v43, v41
    s_nop 1
    v_add_f32 v43, v43, v41
    v_mov_b32 v41, v43
    s_nop 1
    v_permlane32_swap_b32 v43, v41
    s_nop 1
    v_add_f32 v43, v43, v41
    v_mul_f32 v43, 0x3a800000, v43
    v_cvt_pk_bf16_f32 v41, v40, v43
    v_lshlrev_b32 v40, 16, v41
    v_and_b32 v43, 0xffff0000, v41
    v_add_f32 v43, 0x3727c5ac, v43
    v_mov_b32 v44, v43
    v_cvt_pk_bf16_f32 v41, v43, v44
    v_lshlrev_b32 v43, 16, v41
    v_and_b32 v44, 0xffff0000, v41
    v_sqrt_f32 v43, v43
    s_nop 0
    v_mov_b32 v44, v43
    v_cvt_pk_bf16_f32 v41, v43, v44
    v_lshlrev_b32 v43, 16, v41
    v_and_b32 v44, 0xffff0000, v41
    v_rcp_f32 v43, v43
    s_nop 0
    v_sub_f32 v20, v20, v40
    v_sub_f32 v21, v21, v40
    v_cvt_pk_bf16_f32 v41, v20, v21
    v_lshlrev_b32 v20, 16, v41
    v_and_b32 v21, 0xffff0000, v41
    v_mul_f32 v20, v20, v43
    v_mul_f32 v21, v21, v43
    v_cvt_pk_bf16_f32 v41, v20, v21
    v_lshlrev_b32 v20, 16, v41
    v_and_b32 v21, 0xffff0000, v41
    v_sub_f32 v22, v22, v40
    v_sub_f32 v23, v23, v40
    v_cvt_pk_bf16_f32 v41, v22, v23
    v_lshlrev_b32 v22, 16, v41
    v_and_b32 v23, 0xffff0000, v41
    v_mul_f32 v22, v22, v43
    v_mul_f32 v23, v23, v43
    v_cvt_pk_bf16_f32 v41, v22, v23
    v_lshlrev_b32 v22, 16, v41
    v_and_b32 v23, 0xffff0000, v41
    v_sub_f32 v24, v24, v40
    v_sub_f32 v25, v25, v40
    v_cvt_pk_bf16_f32 v41, v24, v25
    v_lshlrev_b32 v24, 16, v41
    v_and_b32 v25, 0xffff0000, v41
    v_mul_f32 v24, v24, v43
    v_mul_f32 v25, v25, v43
    v_cvt_pk_bf16_f32 v41, v24, v25
    v_lshlrev_b32 v24, 16, v41
    v_and_b32 v25, 0xffff0000, v41
    v_sub_f32 v26, v26, v40
    v_sub_f32 v27, v27, v40
    v_cvt_pk_bf16_f32 v41, v26, v27
    v_lshlrev_b32 v26, 16, v41
    v_and_b32 v27, 0xffff0000, v41
    v_mul_f32 v26, v26, v43
    v_mul_f32 v27, v27, v43
    v_cvt_pk_bf16_f32 v41, v26, v27
    v_lshlrev_b32 v26, 16, v41
    v_and_b32 v27, 0xffff0000, v41
    v_sub_f32 v28, v28, v40
    v_sub_f32 v29, v29, v40
    v_cvt_pk_bf16_f32 v41, v28, v29
    v_lshlrev_b32 v28, 16, v41
    v_and_b32 v29, 0xffff0000, v41
    v_mul_f32 v28, v28, v43
    v_mul_f32 v29, v29, v43
    v_cvt_pk_bf16_f32 v41, v28, v29
    v_lshlrev_b32 v28, 16, v41
    v_and_b32 v29, 0xffff0000, v41
    v_sub_f32 v30, v30, v40
    v_sub_f32 v31, v31, v40
    v_cvt_pk_bf16_f32 v41, v30, v31
    v_lshlrev_b32 v30, 16, v41
    v_and_b32 v31, 0xffff0000, v41
    v_mul_f32 v30, v30, v43
    v_mul_f32 v31, v31, v43
    v_cvt_pk_bf16_f32 v41, v30, v31
    v_lshlrev_b32 v30, 16, v41
    v_and_b32 v31, 0xffff0000, v41
    v_sub_f32 v32, v32, v40
    v_sub_f32 v33, v33, v40
    v_cvt_pk_bf16_f32 v41, v32, v33
    v_lshlrev_b32 v32, 16, v41
    v_and_b32 v33, 0xffff0000, v41
    v_mul_f32 v32, v32, v43
    v_mul_f32 v33, v33, v43
    v_cvt_pk_bf16_f32 v41, v32, v33
    v_lshlrev_b32 v32, 16, v41
    v_and_b32 v33, 0xffff0000, v41
    v_sub_f32 v34, v34, v40
    v_sub_f32 v35, v35, v40
    v_cvt_pk_bf16_f32 v41, v34, v35
    v_lshlrev_b32 v34, 16, v41
    v_and_b32 v35, 0xffff0000, v41
    v_mul_f32 v34, v34, v43
    v_mul_f32 v35, v35, v43
    v_cvt_pk_bf16_f32 v41, v34, v35
    v_lshlrev_b32 v34, 16, v41
    v_and_b32 v35, 0xffff0000, v41
    v_add_f32 v40, v20, v21
    v_add_f32 v40, v40, v22
    v_add_f32 v40, v40, v23
    v_add_f32 v40, v40, v24
    v_add_f32 v40, v40, v25
    v_add_f32 v40, v40, v26
    v_add_f32 v40, v40, v27
    v_add_f32 v40, v40, v28
    v_add_f32 v40, v40, v29
    v_add_f32 v40, v40, v30
    v_add_f32 v40, v40, v31
    v_add_f32 v40, v40, v32
    v_add_f32 v40, v40, v33
    v_add_f32 v40, v40, v34
    v_add_f32 v40, v40, v35
    s_nop 1
    v_add_f32_dpp v40, v40, v40 quad_perm:[1,0,3,2] row_mask:0xf bank_mask:0xf
    s_nop 1
    v_add_f32_dpp v40, v40, v40 quad_perm:[2,3,0,1] row_mask:0xf bank_mask:0xf
    s_nop 1
    v_add_f32_dpp v40, v40, v40 row_ror:4 row_mask:0xf bank_mask:0xf
    s_nop 1
    v_add_f32_dpp v40, v40, v40 row_ror:8 row_mask:0xf bank_mask:0xf
    v_mov_b32 v41, v40
    s_nop 1
    v_permlane16_swap_b32 v40, v41
    s_nop 1
    v_add_f32 v40, v40, v41
    v_mov_b32 v41, v40
    s_nop 1
    v_permlane32_swap_b32 v40, v41
    s_nop 1
    v_add_f32 v40, v40, v41
    v_mul_f32 v40, 0x3a800000, v40
    v_sub_f32 v42, v20, v40
    v_mul_f32 v43, v42, v42
    v_sub_f32 v42, v21, v40
    v_fmac_f32 v43, v42, v42
    v_sub_f32 v42, v22, v40
    v_fmac_f32 v43, v42, v42
    v_sub_f32 v42, v23, v40
    v_fmac_f32 v43, v42, v42
    v_sub_f32 v42, v24, v40
    v_fmac_f32 v43, v42, v42
    v_sub_f32 v42, v25, v40
    v_fmac_f32 v43, v42, v42
    v_sub_f32 v42, v26, v40
    v_fmac_f32 v43, v42, v42
    v_sub_f32 v42, v27, v40
    v_fmac_f32 v43, v42, v42
    v_sub_f32 v42, v28, v40
    v_fmac_f32 v43, v42, v42
    v_sub_f32 v42, v29, v40
    v_fmac_f32 v43, v42, v42
    v_sub_f32 v42, v30, v40
    v_fmac_f32 v43, v42, v42
    v_sub_f32 v42, v31, v40
    v_fmac_f32 v43, v42, v42
    v_sub_f32 v42, v32, v40
    v_fmac_f32 v43, v42, v42
    v_sub_f32 v42, v33, v40
    v_fmac_f32 v43, v42, v42
    v_sub_f32 v42, v34, v40
    v_fmac_f32 v43, v42, v42
    v_sub_f32 v42, v35, v40
    v_fmac_f32 v43, v42, v42
    s_nop 1
    v_add_f32_dpp v43, v43, v43 quad_perm:[1,0,3,2] row_mask:0xf bank_mask:0xf
    s_nop 1
    v_add_f32_dpp v43, v43, v43 quad_perm:[2,3,0,1] row_mask:0xf bank_mask:0xf
    s_nop 1
    v_add_f32_dpp v43, v43, v43 row_ror:4 row_mask:0xf bank_mask:0xf
    s_nop 1
    v_add_f32_dpp v43, v43, v43 row_ror:8 row_mask:0xf bank_mask:0xf
    v_mov_b32 v41, v43
    s_nop 1
    v_permlane16_swap_b32 v43, v41
    s_nop 1
    v_add_f32 v43, v43, v41
    v_mov_b32 v41, v43
    s_nop 1
    v_permlane32_swap_b32 v43, v41
    s_nop 1
    v_add_f32 v43, v43, v41
    v_mul_f32 v43, 0x3a800000, v43
    v_cvt_pk_bf16_f32 v41, v40, v43
    v_lshlrev_b32 v40, 16, v41
    v_and_b32 v43, 0xffff0000, v41
    v_add_f32 v43, 0x3727c5ac, v43
    v_mov_b32 v44, v43
    v_cvt_pk_bf16_f32 v41, v43, v44
    v_lshlrev_b32 v43, 16, v41
    v_and_b32 v44, 0xffff0000, v41
    v_sqrt_f32 v43, v43
    s_nop 0
    v_mov_b32 v44, v43
    v_cvt_pk_bf16_f32 v41, v43, v44
    v_lshlrev_b32 v43, 16, v41
    v_and_b32 v44, 0xffff0000, v41
    v_rcp_f32 v43, v43
    s_nop 0
    v_sub_f32 v20, v20, v40
    v_sub_f32 v21, v21, v40
    v_cvt_pk_bf16_f32 v41, v20, v21
    v_lshlrev_b32 v20, 16, v41
    v_and_b32 v21, 0xffff0000, v41
    v_mul_f32 v20, v20, v43
    v_mul_f32 v21, v21, v43
    v_sub_f32 v22, v22, v40
    v_sub_f32 v23, v23, v40
    v_cvt_pk_bf16_f32 v41, v22, v23
    v_lshlrev_b32 v22, 16, v41
    v_and_b32 v23, 0xffff0000, v41
    v_mul_f32 v22, v22, v43
    v_mul_f32 v23, v23, v43
    v_sub_f32 v24, v24, v40
    v_sub_f32 v25, v25, v40
    v_cvt_pk_bf16_f32 v41, v24, v25
    v_lshlrev_b32 v24, 16, v41
    v_and_b32 v25, 0xffff0000, v41
    v_mul_f32 v24, v24, v43
    v_mul_f32 v25, v25, v43
    v_sub_f32 v26, v26, v40
    v_sub_f32 v27, v27, v40
    v_cvt_pk_bf16_f32 v41, v26, v27
    v_lshlrev_b32 v26, 16, v41
    v_and_b32 v27, 0xffff0000, v41
    v_mul_f32 v26, v26, v43
    v_mul_f32 v27, v27, v43
    v_sub_f32 v28, v28, v40
    v_sub_f32 v29, v29, v40
    v_cvt_pk_bf16_f32 v41, v28, v29
    v_lshlrev_b32 v28, 16, v41
    v_and_b32 v29, 0xffff0000, v41
    v_mul_f32 v28, v28, v43
    v_mul_f32 v29, v29, v43
    v_sub_f32 v30, v30, v40
    v_sub_f32 v31, v31, v40
    v_cvt_pk_bf16_f32 v41, v30, v31
    v_lshlrev_b32 v30, 16, v41
    v_and_b32 v31, 0xffff0000, v41
    v_mul_f32 v30, v30, v43
    v_mul_f32 v31, v31, v43
    v_sub_f32 v32, v32, v40
    v_sub_f32 v33, v33, v40
    v_cvt_pk_bf16_f32 v41, v32, v33
    v_lshlrev_b32 v32, 16, v41
    v_and_b32 v33, 0xffff0000, v41
    v_mul_f32 v32, v32, v43
    v_mul_f32 v33, v33, v43
    v_sub_f32 v34, v34, v40
    v_sub_f32 v35, v35, v40
    v_cvt_pk_bf16_f32 v41, v34, v35
    v_lshlrev_b32 v34, 16, v41
    v_and_b32 v35, 0xffff0000, v41
    v_mul_f32 v34, v34, v43
    v_mul_f32 v35, v35, v43
    v_cvt_pk_bf16_f32 v4, v20, v21
    v_cvt_pk_bf16_f32 v5, v22, v23
    v_cvt_pk_bf16_f32 v6, v24, v25
    v_cvt_pk_bf16_f32 v7, v26, v27
    v_cvt_pk_bf16_f32 v8, v28, v29
    v_cvt_pk_bf16_f32 v9, v30, v31
    v_cvt_pk_bf16_f32 v10, v32, v33
    v_cvt_pk_bf16_f32 v11, v34, v35
    buffer_store_dwordx4 v[4:7], v2, s[12:15], 0 offen
    buffer_store_dwordx4 v[8:11], v2, s[12:15], 0 offen offset:1024
    s_waitcnt vmcnt(0)
L_end_ln2_0_kernel:
    s_endpgm
.globl mlp1_0_kernel
.p2align 8
.type mlp1_0_kernel,@function
mlp1_0_kernel:
    s_cmp_ge_u32 s2, 224
    s_cbranch_scc1 L_end_mlp1_0_kernel
    s_load_dwordx2 s[40:41], s[0:1], 80
    s_load_dwordx2 s[42:43], s[0:1], 32
    s_load_dwordx2 s[50:51], s[0:1], 80
    s_load_dwordx2 s[56:57], s[0:1], 40
    v_and_b32 v1, 63, v0
    v_lshrrev_b32 v2, 6, v0
    s_and_b32 s24, s2, 15
    v_readfirstlane_b32 s26, v2
    s_lshr_b32 s25, s2, 4
    s_nop 1
    s_lshr_b32 s27, s26, 2
    s_and_b32 s28, s26, 1
    s_bfe_u32 s29, s26, 0x10001
    v_lshrrev_b32 v2, 3, v1
    v_and_b32 v3, 7, v1
    v_xor_b32 v3, v3, v2
    s_lshl_b32 s38, s26, 4
    s_lshl_b32 s39, s24, 7
    s_add_u32 s38, s38, s39
    v_add_u32 v4, s38, v2
    s_mov_b32 s38, 2048
    v_mul_lo_u32 v4, v4, s38
    v_lshlrev_b32 v3, 4, v3
    v_add_u32 v10, v4, v3
    v_add_u32 v11, 16384, v10
    v_lshrrev_b32 v2, 3, v1
    s_lshl_b32 s38, s26, 3
    v_add_u32 v2, s38, v2
    s_mov_b32 s38, 7168
    v_mul_lo_u32 v2, v2, s38
    v_bfe_u32 v3, v1, 1, 2
    v_bfe_u32 v4, v1, 4, 1
    s_and_b32 s38, s26, 1
    s_lshl_b32 s38, s38, 1
    v_or_b32 v4, s38, v4
    v_xor_b32 v3, v3, v4
    v_lshlrev_b32 v3, 5, v3
    v_and_b32 v4, 1, v1
    v_lshlrev_b32 v4, 4, v4
    v_add3_u32 v12, v2, v3, v4
    v_and_b32 v2, 15, v1
    s_lshl_b32 s38, s28, 6
    v_add_u32 v2, s38, v2
    v_lshlrev_b32 v2, 7, v2
    v_lshrrev_b32 v3, 4, v1
    s_lshl_b32 s38, s27, 2
    v_add_u32 v3, s38, v3
    v_and_b32 v4, 7, v1
    v_xor_b32 v3, v3, v4
    v_lshlrev_b32 v3, 4, v3
    v_add_u32 v13, v2, v3
    v_lshrrev_b32 v2, 4, v1
    v_lshlrev_b32 v2, 3, v2
    v_bfe_u32 v3, v1, 2, 2
    v_add_u32 v2, v2, v3
    v_lshlrev_b32 v2, 7, v2
    v_and_b32 v3, 3, v1
    v_lshlrev_b32 v3, 3, v3
    v_add_u32 v2, v2, v3
    s_lshl_b32 s38, s27, 12
    s_add_u32 s38, s38, 16384
    v_add_u32 v2, s38, v2
    v_bfe_u32 v3, v1, 3, 1
    v_bfe_u32 v4, v1, 4, 1
    v_lshlrev_b32 v4, 1, v4
    v_or_b32 v3, v3, v4
    s_lshl_b32 s38, s29, 1
    v_xor_b32 v4, s38, v3
    v_lshlrev_b32 v4, 5, v4
    v_add_u32 v14, v2, v4
    v_xor_b32 v4, 32, v4
    v_add_u32 v15, v2, v4
    s_waitcnt lgkmcnt(0)
    s_mov_b32 s4, s40
    s_mov_b32 s5, s41
    s_mov_b32 s6, 4194304
    s_mov_b32 s7, 0x00020000
    s_mov_b32 s8, s42
    s_mov_b32 s9, s43
    s_mov_b32 s10, 7340032
    s_mov_b32 s11, 0x00020000
    s_mov_b32 s31, 0
    s_mul_i32 s32, s25, 512
    s_add_u32 s33, s32, 128
    s_add_u32 s34, s32, 256
    s_add_u32 s35, s32, 384
    s_mov_b32 s36, 0
    s_lshl_b32 s44, s26, 11
    s_add_u32 s45, s44, 1024
    s_lshl_b32 s46, s26, 10
    s_add_u32 s46, s46, 16384
    s_add_u32 s47, s46, 8192
    s_add_u32 s48, s46, 16384
    s_add_u32 s49, s46, 24576
    s_add_u32 m0, s36, s44
    s_nop 0
    buffer_load_dwordx4 v10, s[4:7], s31 offen lds
    s_add_u32 m0, s36, s45
    s_nop 0
    buffer_load_dwordx4 v11, s[4:7], s31 offen lds
    s_add_u32 m0, s36, s46
    s_nop 0
    buffer_load_dwordx4 v12, s[8:11], s32 offen lds
    s_add_u32 m0, s36, s47
    s_nop 0
    buffer_load_dwordx4 v12, s[8:11], s33 offen lds
    s_add_u32 m0, s36, s48
    s_nop 0
    buffer_load_dwordx4 v12, s[8:11], s34 offen lds
    s_add_u32 m0, s36, s49
    s_nop 0
    buffer_load_dwordx4 v12, s[8:11], s35 offen lds
    s_add_u32 s31, s31, 128
    s_add_u32 s32, s32, 458752
    s_add_u32 s33, s33, 458752
    s_add_u32 s34, s34, 458752
    s_add_u32 s35, s35, 458752
    s_add_u32 s36, s36, 49152
    s_cmp_ge_u32 s36, 147456
    s_cselect_b32 s36, 0, s36
    v_mov_b32 v116, 0
    v_mov_b32 v117, 0
    v_mov_b32 v118, 0
    v_mov_b32 v119, 0
    v_mov_b32 v120, 0
    v_mov_b32 v121, 0
    v_mov_b32 v122, 0
    v_mov_b32 v123, 0
    v_mov_b32 v124, 0
    v_mov_b32 v125, 0
    v_mov_b32 v126, 0
    v_mov_b32 v127, 0
    v_mov_b32 v128, 0
    v_mov_b32 v129, 0
    v_mov_b32 v130, 0
    v_mov_b32 v131, 0
    v_mov_b32 v132, 0
    v_mov_b32 v133, 0
    v_mov_b32 v134, 0
    v_mov_b32 v135, 0
    v_mov_b32 v136, 0
    v_mov_b32 v137, 0
    v_mov_b32 v138, 0
    v_mov_b32 v139, 0
    v_mov_b32 v140, 0
    v_mov_b32 v141, 0
    v_mov_b32 v142, 0
    v_mov_b32 v143, 0
    v_mov_b32 v144, 0
    v_mov_b32 v145, 0
    v_mov_b32 v146, 0
    v_mov_b32 v147, 0
    v_mov_b32 v148, 0
    v_mov_b32 v149, 0
    v_mov_b32 v150, 0
    v_mov_b32 v151, 0
    v_mov_b32 v152, 0
    v_mov_b32 v153, 0
    v_mov_b32 v154, 0
    v_mov_b32 v155, 0
    v_mov_b32 v156, 0
    v_mov_b32 v157, 0
    v_mov_b32 v158, 0
    v_mov_b32 v159, 0
    v_mov_b32 v160, 0
    v_mov_b32 v161, 0
    v_mov_b32 v162, 0
    v_mov_b32 v163, 0
    v_mov_b32 v164, 0
    v_mov_b32 v165, 0
    v_mov_b32 v166, 0
    v_mov_b32 v167, 0
    v_mov_b32 v168, 0
    v_mov_b32 v169, 0
    v_mov_b32 v170, 0
    v_mov_b32 v171, 0
    v_mov_b32 v172, 0
    v_mov_b32 v173, 0
    v_mov_b32 v174, 0
    v_mov_b32 v175, 0
    v_mov_b32 v176, 0
    v_mov_b32 v177, 0
    v_mov_b32 v178, 0
    v_mov_b32 v179, 0
    v_mov_b32 v180, 0
    v_mov_b32 v181, 0
    v_mov_b32 v182, 0
    v_mov_b32 v183, 0
    v_mov_b32 v184, 0
    v_mov_b32 v185, 0
    v_mov_b32 v186, 0
    v_mov_b32 v187, 0
    v_mov_b32 v188, 0
    v_mov_b32 v189, 0
    v_mov_b32 v190, 0
    v_mov_b32 v191, 0
    v_mov_b32 v192, 0
    v_mov_b32 v193, 0
    v_mov_b32 v194, 0
    v_mov_b32 v195, 0
    v_mov_b32 v196, 0
    v_mov_b32 v197, 0
    v_mov_b32 v198, 0
    v_mov_b32 v199, 0
    v_mov_b32 v200, 0
    v_mov_b32 v201, 0
    v_mov_b32 v202, 0
    v_mov_b32 v203, 0
    v_mov_b32 v204, 0
    v_mov_b32 v205, 0
    v_mov_b32 v206, 0
    v_mov_b32 v207, 0
    v_mov_b32 v208, 0
    v_mov_b32 v209, 0
    v_mov_b32 v210, 0
    v_mov_b32 v211, 0
    v_mov_b32 v212, 0
    v_mov_b32 v213, 0
    v_mov_b32 v214, 0
    v_mov_b32 v215, 0
    v_mov_b32 v216, 0
    v_mov_b32 v217, 0
    v_mov_b32 v218, 0
    v_mov_b32 v219, 0
    v_mov_b32 v220, 0
    v_mov_b32 v221, 0
    v_mov_b32 v222, 0
    v_mov_b32 v223, 0
    v_mov_b32 v224, 0
    v_mov_b32 v225, 0
    v_mov_b32 v226, 0
    v_mov_b32 v227, 0
    v_mov_b32 v228, 0
    v_mov_b32 v229, 0
    v_mov_b32 v230, 0
    v_mov_b32 v231, 0
    v_mov_b32 v232, 0
    v_mov_b32 v233, 0
    v_mov_b32 v234, 0
    v_mov_b32 v235, 0
    v_mov_b32 v236, 0
    v_mov_b32 v237, 0
    v_mov_b32 v238, 0
    v_mov_b32 v239, 0
    v_mov_b32 v240, 0
    v_mov_b32 v241, 0
    v_mov_b32 v242, 0
    v_mov_b32 v243, 0
    s_add_u32 m0, s36, s44
    s_nop 0
    buffer_load_dwordx4 v10, s[4:7], s31 offen lds
    s_add_u32 m0, s36, s45
    s_nop 0
    buffer_load_dwordx4 v11, s[4:7], s31 offen lds
    s_add_u32 m0, s36, s46
    s_nop 0
    buffer_load_dwordx4 v12, s[8:11], s32 offen lds
    s_add_u32 m0, s36, s47
    s_nop 0
    buffer_load_dwordx4 v12, s[8:11], s33 offen lds
    s_add_u32 m0, s36, s48
    s_nop 0
    buffer_load_dwordx4 v12, s[8:11], s34 offen lds
    s_add_u32 m0, s36, s49
    s_nop 0
    buffer_load_dwordx4 v12, s[8:11], s35 offen lds
    s_add_u32 s31, s31, 128
    s_add_u32 s32, s32, 458752
    s_add_u32 s33, s33, 458752
    s_add_u32 s34, s34, 458752
    s_add_u32 s35, s35, 458752
    s_add_u32 s36, s36, 49152
    s_cmp_ge_u32 s36, 147456
    s_cselect_b32 s36, 0, s36
    s_add_u32 m0, s36, s44
    s_nop 0
    buffer_load_dwordx4 v10, s[4:7], s31 offen lds
    s_add_u32 m0, s36, s45
    s_nop 0
    buffer_load_dwordx4 v11, s[4:7], s31 offen lds
    s_add_u32 m0, s36, s46
    s_nop 0
    buffer_load_dwordx4 v12, s[8:11], s32 offen lds
    s_add_u32 m0, s36, s47
    s_nop 0
    buffer_load_dwordx4 v12, s[8:11], s33 offen lds
    s_add_u32 m0, s36, s48
    s_nop 0
    buffer_load_dwordx4 v12, s[8:11], s34 offen lds
    s_add_u32 m0, s36, s49
    s_nop 0
    buffer_load_dwordx4 v12, s[8:11], s35 offen lds
    s_add_u32 s31, s31, 128
    s_add_u32 s32, s32, 458752
    s_add_u32 s33, s33, 458752
    s_add_u32 s34, s34, 458752
    s_add_u32 s35, s35, 458752
    s_add_u32 s36, s36, 49152
    s_cmp_ge_u32 s36, 147456
    s_cselect_b32 s36, 0, s36
    s_mov_b32 s37, 0
    s_waitcnt vmcnt(12)
    s_barrier
    v_add_u32 v16, s37, v13
    v_add_u32 v17, s37, v14
    v_add_u32 v18, s37, v15
    s_add_u32 s37, s37, 49152
    s_cmp_ge_u32 s37, 147456
    s_cselect_b32 s37, 0, s37
    ds_read_b128 v[20:23], v16 offset:0
    ds_read_b128 v[24:27], v16 offset:2048
    ds_read_b128 v[28:31], v16 offset:4096
    ds_read_b128 v[32:35], v16 offset:6144
    ds_read_b64_tr_b16 v[52:53], v17 offset:0
    ds_read_b64_tr_b16 v[54:55], v17 offset:512
    ds_read_b64_tr_b16 v[56:57], v18 offset:0
    ds_read_b64_tr_b16 v[58:59], v18 offset:512
    ds_read_b64_tr_b16 v[60:61], v17 offset:8192
    ds_read_b64_tr_b16 v[62:63], v17 offset:8704
    ds_read_b64_tr_b16 v[64:65], v18 offset:8192
    ds_read_b64_tr_b16 v[66:67], v18 offset:8704
    ds_read_b64_tr_b16 v[68:69], v17 offset:16384
    ds_read_b64_tr_b16 v[70:71], v17 offset:16896
    ds_read_b64_tr_b16 v[72:73], v18 offset:16384
    ds_read_b64_tr_b16 v[74:75], v18 offset:16896
    ds_read_b64_tr_b16 v[76:77], v17 offset:24576
    ds_read_b64_tr_b16 v[78:79], v17 offset:25088
    ds_read_b64_tr_b16 v[80:81], v18 offset:24576
    ds_read_b64_tr_b16 v[82:83], v18 offset:25088
    s_mov_b32 s30, 6
L_loop_mlp1_0_kernel:
    s_waitcnt lgkmcnt(0)
    v_mfma_f32_16x16x32_bf16 v[116:119], v[52:55], v[20:23], v[116:119]
    v_mfma_f32_16x16x32_bf16 v[120:123], v[56:59], v[20:23], v[120:123]
    v_mfma_f32_16x16x32_bf16 v[124:127], v[60:63], v[20:23], v[124:127]
    v_mfma_f32_16x16x32_bf16 v[128:131], v[64:67], v[20:23], v[128:131]
    v_mfma_f32_16x16x32_bf16 v[132:135], v[68:71], v[20:23], v[132:135]
    v_mfma_f32_16x16x32_bf16 v[136:139], v[72:75], v[20:23], v[136:139]
    v_mfma_f32_16x16x32_bf16 v[140:143], v[76:79], v[20:23], v[140:143]
    v_mfma_f32_16x16x32_bf16 v[144:147], v[80:83], v[20:23], v[144:147]
    v_mfma_f32_16x16x32_bf16 v[148:151], v[52:55], v[24:27], v[148:151]
    v_mfma_f32_16x16x32_bf16 v[152:155], v[56:59], v[24:27], v[152:155]
    v_mfma_f32_16x16x32_bf16 v[156:159], v[60:63], v[24:27], v[156:159]
    v_mfma_f32_16x16x32_bf16 v[160:163], v[64:67], v[24:27], v[160:163]
    v_mfma_f32_16x16x32_bf16 v[164:167], v[68:71], v[24:27], v[164:167]
    v_mfma_f32_16x16x32_bf16 v[168:171], v[72:75], v[24:27], v[168:171]
    v_mfma_f32_16x16x32_bf16 v[172:175], v[76:79], v[24:27], v[172:175]
    v_mfma_f32_16x16x32_bf16 v[176:179], v[80:83], v[24:27], v[176:179]
    s_waitcnt vmcnt(6)
    s_barrier
    v_add_u32 v16, s37, v13
    v_add_u32 v17, s37, v14
    v_add_u32 v18, s37, v15
    s_add_u32 s37, s37, 49152
    s_cmp_ge_u32 s37, 147456
    s_cselect_b32 s37, 0, s37
    ds_read_b128 v[36:39], v16 offset:0
    ds_read_b128 v[40:43], v16 offset:2048
    ds_read_b128 v[44:47], v16 offset:4096
    ds_read_b128 v[48:51], v16 offset:6144
    ds_read_b64_tr_b16 v[84:85], v17 offset:0
    ds_read_b64_tr_b16 v[86:87], v17 offset:512
    ds_read_b64_tr_b16 v[88:89], v18 offset:0
    ds_read_b64_tr_b16 v[90:91], v18 offset:512
    ds_read_b64_tr_b16 v[92:93], v17 offset:8192
    ds_read_b64_tr_b16 v[94:95], v17 offset:8704
    ds_read_b64_tr_b16 v[96:97], v18 offset:8192
    ds_read_b64_tr_b16 v[98:99], v18 offset:8704
    ds_read_b64_tr_b16 v[100:101], v17 offset:16384
    ds_read_b64_tr_b16 v[102:103], v17 offset:16896
    ds_read_b64_tr_b16 v[104:105], v18 offset:16384
    ds_read_b64_tr_b16 v[106:107], v18 offset:16896
    ds_read_b64_tr_b16 v[108:109], v17 offset:24576
    ds_read_b64_tr_b16 v[110:111], v17 offset:25088
    ds_read_b64_tr_b16 v[112:113], v18 offset:24576
    ds_read_b64_tr_b16 v[114:115], v18 offset:25088
    s_add_u32 m0, s36, s44
    v_mfma_f32_16x16x32_bf16 v[180:183], v[52:55], v[28:31], v[180:183]
    buffer_load_dwordx4 v10, s[4:7], s31 offen lds
    v_mfma_f32_16x16x32_bf16 v[184:187], v[56:59], v[28:31], v[184:187]
    s_add_u32 m0, s36, s45
    v_mfma_f32_16x16x32_bf16 v[188:191], v[60:63], v[28:31], v[188:191]
    buffer_load_dwordx4 v11, s[4:7], s31 offen lds
    v_mfma_f32_16x16x32_bf16 v[192:195], v[64:67], v[28:31], v[192:195]
    s_add_u32 m0, s36, s46
    v_mfma_f32_16x16x32_bf16 v[196:199], v[68:71], v[28:31], v[196:199]
    buffer_load_dwordx4 v12, s[8:11], s32 offen lds
    v_mfma_f32_16x16x32_bf16 v[200:203], v[72:75], v[28:31], v[200:203]
    s_add_u32 m0, s36, s47
    v_mfma_f32_16x16x32_bf16 v[204:207], v[76:79], v[28:31], v[204:207]
    buffer_load_dwordx4 v12, s[8:11], s33 offen lds
    v_mfma_f32_16x16x32_bf16 v[208:211], v[80:83], v[28:31], v[208:211]
    s_add_u32 m0, s36, s48
    v_mfma_f32_16x16x32_bf16 v[212:215], v[52:55], v[32:35], v[212:215]
    buffer_load_dwordx4 v12, s[8:11], s34 offen lds
    v_mfma_f32_16x16x32_bf16 v[216:219], v[56:59], v[32:35], v[216:219]
    s_add_u32 m0, s36, s49
    v_mfma_f32_16x16x32_bf16 v[220:223], v[60:63], v[32:35], v[220:223]
    buffer_load_dwordx4 v12, s[8:11], s35 offen lds
    v_mfma_f32_16x16x32_bf16 v[224:227], v[64:67], v[32:35], v[224:227]
    v_mfma_f32_16x16x32_bf16 v[228:231], v[68:71], v[32:35], v[228:231]
    v_mfma_f32_16x16x32_bf16 v[232:235], v[72:75], v[32:35], v[232:235]
    v_mfma_f32_16x16x32_bf16 v[236:239], v[76:79], v[32:35], v[236:239]
    v_mfma_f32_16x16x32_bf16 v[240:243], v[80:83], v[32:35], v[240:243]
    s_add_u32 s31, s31, 128
    s_add_u32 s32, s32, 458752
    s_add_u32 s33, s33, 458752
    s_add_u32 s34, s34, 458752
    s_add_u32 s35, s35, 458752
    s_add_u32 s36, s36, 49152
    s_cmp_ge_u32 s36, 147456
    s_cselect_b32 s36, 0, s36
    s_waitcnt lgkmcnt(0)
    v_mfma_f32_16x16x32_bf16 v[116:119], v[84:87], v[36:39], v[116:119]
    v_mfma_f32_16x16x32_bf16 v[120:123], v[88:91], v[36:39], v[120:123]
    v_mfma_f32_16x16x32_bf16 v[124:127], v[92:95], v[36:39], v[124:127]
    v_mfma_f32_16x16x32_bf16 v[128:131], v[96:99], v[36:39], v[128:131]
    v_mfma_f32_16x16x32_bf16 v[132:135], v[100:103], v[36:39], v[132:135]
    v_mfma_f32_16x16x32_bf16 v[136:139], v[104:107], v[36:39], v[136:139]
    v_mfma_f32_16x16x32_bf16 v[140:143], v[108:111], v[36:39], v[140:143]
    v_mfma_f32_16x16x32_bf16 v[144:147], v[112:115], v[36:39], v[144:147]
    v_mfma_f32_16x16x32_bf16 v[148:151], v[84:87], v[40:43], v[148:151]
    v_mfma_f32_16x16x32_bf16 v[152:155], v[88:91], v[40:43], v[152:155]
    v_mfma_f32_16x16x32_bf16 v[156:159], v[92:95], v[40:43], v[156:159]
    v_mfma_f32_16x16x32_bf16 v[160:163], v[96:99], v[40:43], v[160:163]
    v_mfma_f32_16x16x32_bf16 v[164:167], v[100:103], v[40:43], v[164:167]
    v_mfma_f32_16x16x32_bf16 v[168:171], v[104:107], v[40:43], v[168:171]
    v_mfma_f32_16x16x32_bf16 v[172:175], v[108:111], v[40:43], v[172:175]
    v_mfma_f32_16x16x32_bf16 v[176:179], v[112:115], v[40:43], v[176:179]
    s_waitcnt vmcnt(6)
    s_barrier
    v_add_u32 v16, s37, v13
    v_add_u32 v17, s37, v14
    v_add_u32 v18, s37, v15
    s_add_u32 s37, s37, 49152
    s_cmp_ge_u32 s37, 147456
    s_cselect_b32 s37, 0, s37
    ds_read_b128 v[20:23], v16 offset:0
    ds_read_b128 v[24:27], v16 offset:2048
    ds_read_b128 v[28:31], v16 offset:4096
    ds_read_b128 v[32:35], v16 offset:6144
    ds_read_b64_tr_b16 v[52:53], v17 offset:0
    ds_read_b64_tr_b16 v[54:55], v17 offset:512
    ds_read_b64_tr_b16 v[56:57], v18 offset:0
    ds_read_b64_tr_b16 v[58:59], v18 offset:512
    ds_read_b64_tr_b16 v[60:61], v17 offset:8192
    ds_read_b64_tr_b16 v[62:63], v17 offset:8704
    ds_read_b64_tr_b16 v[64:65], v18 offset:8192
    ds_read_b64_tr_b16 v[66:67], v18 offset:8704
    ds_read_b64_tr_b16 v[68:69], v17 offset:16384
    ds_read_b64_tr_b16 v[70:71], v17 offset:16896
    ds_read_b64_tr_b16 v[72:73], v18 offset:16384
    ds_read_b64_tr_b16 v[74:75], v18 offset:16896
    ds_read_b64_tr_b16 v[76:77], v17 offset:24576
    ds_read_b64_tr_b16 v[78:79], v17 offset:25088
    ds_read_b64_tr_b16 v[80:81], v18 offset:24576
    ds_read_b64_tr_b16 v[82:83], v18 offset:25088
    s_add_u32 m0, s36, s44
    v_mfma_f32_16x16x32_bf16 v[180:183], v[84:87], v[44:47], v[180:183]
    buffer_load_dwordx4 v10, s[4:7], s31 offen lds
    v_mfma_f32_16x16x32_bf16 v[184:187], v[88:91], v[44:47], v[184:187]
    s_add_u32 m0, s36, s45
    v_mfma_f32_16x16x32_bf16 v[188:191], v[92:95], v[44:47], v[188:191]
    buffer_load_dwordx4 v11, s[4:7], s31 offen lds
    v_mfma_f32_16x16x32_bf16 v[192:195], v[96:99], v[44:47], v[192:195]
    s_add_u32 m0, s36, s46
    v_mfma_f32_16x16x32_bf16 v[196:199], v[100:103], v[44:47], v[196:199]
    buffer_load_dwordx4 v12, s[8:11], s32 offen lds
    v_mfma_f32_16x16x32_bf16 v[200:203], v[104:107], v[44:47], v[200:203]
    s_add_u32 m0, s36, s47
    v_mfma_f32_16x16x32_bf16 v[204:207], v[108:111], v[44:47], v[204:207]
    buffer_load_dwordx4 v12, s[8:11], s33 offen lds
    v_mfma_f32_16x16x32_bf16 v[208:211], v[112:115], v[44:47], v[208:211]
    s_add_u32 m0, s36, s48
    v_mfma_f32_16x16x32_bf16 v[212:215], v[84:87], v[48:51], v[212:215]
    buffer_load_dwordx4 v12, s[8:11], s34 offen lds
    v_mfma_f32_16x16x32_bf16 v[216:219], v[88:91], v[48:51], v[216:219]
    s_add_u32 m0, s36, s49
    v_mfma_f32_16x16x32_bf16 v[220:223], v[92:95], v[48:51], v[220:223]
    buffer_load_dwordx4 v12, s[8:11], s35 offen lds
    v_mfma_f32_16x16x32_bf16 v[224:227], v[96:99], v[48:51], v[224:227]
    v_mfma_f32_16x16x32_bf16 v[228:231], v[100:103], v[48:51], v[228:231]
    v_mfma_f32_16x16x32_bf16 v[232:235], v[104:107], v[48:51], v[232:235]
    v_mfma_f32_16x16x32_bf16 v[236:239], v[108:111], v[48:51], v[236:239]
    v_mfma_f32_16x16x32_bf16 v[240:243], v[112:115], v[48:51], v[240:243]
    s_add_u32 s31, s31, 128
    s_add_u32 s32, s32, 458752
    s_add_u32 s33, s33, 458752
    s_add_u32 s34, s34, 458752
    s_add_u32 s35, s35, 458752
    s_add_u32 s36, s36, 49152
    s_cmp_ge_u32 s36, 147456
    s_cselect_b32 s36, 0, s36
    s_sub_u32 s30, s30, 1
    s_cmp_lg_u32 s30, 0
    s_cbranch_scc1 L_loop_mlp1_0_kernel
    s_waitcnt lgkmcnt(0)
    v_mfma_f32_16x16x32_bf16 v[116:119], v[52:55], v[20:23], v[116:119]
    v_mfma_f32_16x16x32_bf16 v[120:123], v[56:59], v[20:23], v[120:123]
    v_mfma_f32_16x16x32_bf16 v[124:127], v[60:63], v[20:23], v[124:127]
    v_mfma_f32_16x16x32_bf16 v[128:131], v[64:67], v[20:23], v[128:131]
    v_mfma_f32_16x16x32_bf16 v[132:135], v[68:71], v[20:23], v[132:135]
    v_mfma_f32_16x16x32_bf16 v[136:139], v[72:75], v[20:23], v[136:139]
    v_mfma_f32_16x16x32_bf16 v[140:143], v[76:79], v[20:23], v[140:143]
    v_mfma_f32_16x16x32_bf16 v[144:147], v[80:83], v[20:23], v[144:147]
    v_mfma_f32_16x16x32_bf16 v[148:151], v[52:55], v[24:27], v[148:151]
    v_mfma_f32_16x16x32_bf16 v[152:155], v[56:59], v[24:27], v[152:155]
    v_mfma_f32_16x16x32_bf16 v[156:159], v[60:63], v[24:27], v[156:159]
    v_mfma_f32_16x16x32_bf16 v[160:163], v[64:67], v[24:27], v[160:163]
    v_mfma_f32_16x16x32_bf16 v[164:167], v[68:71], v[24:27], v[164:167]
    v_mfma_f32_16x16x32_bf16 v[168:171], v[72:75], v[24:27], v[168:171]
    v_mfma_f32_16x16x32_bf16 v[172:175], v[76:79], v[24:27], v[172:175]
    v_mfma_f32_16x16x32_bf16 v[176:179], v[80:83], v[24:27], v[176:179]
    s_waitcnt vmcnt(6)
    s_barrier
    v_add_u32 v16, s37, v13
    v_add_u32 v17, s37, v14
    v_add_u32 v18, s37, v15
    s_add_u32 s37, s37, 49152
    s_cmp_ge_u32 s37, 147456
    s_cselect_b32 s37, 0, s37
    ds_read_b128 v[36:39], v16 offset:0
    ds_read_b128 v[40:43], v16 offset:2048
    ds_read_b128 v[44:47], v16 offset:4096
    ds_read_b128 v[48:51], v16 offset:6144
    ds_read_b64_tr_b16 v[84:85], v17 offset:0
    ds_read_b64_tr_b16 v[86:87], v17 offset:512
    ds_read_b64_tr_b16 v[88:89], v18 offset:0
    ds_read_b64_tr_b16 v[90:91], v18 offset:512
    ds_read_b64_tr_b16 v[92:93], v17 offset:8192
    ds_read_b64_tr_b16 v[94:95], v17 offset:8704
    ds_read_b64_tr_b16 v[96:97], v18 offset:8192
    ds_read_b64_tr_b16 v[98:99], v18 offset:8704
    ds_read_b64_tr_b16 v[100:101], v17 offset:16384
    ds_read_b64_tr_b16 v[102:103], v17 offset:16896
    ds_read_b64_tr_b16 v[104:105], v18 offset:16384
    ds_read_b64_tr_b16 v[106:107], v18 offset:16896
    ds_read_b64_tr_b16 v[108:109], v17 offset:24576
    ds_read_b64_tr_b16 v[110:111], v17 offset:25088
    ds_read_b64_tr_b16 v[112:113], v18 offset:24576
    ds_read_b64_tr_b16 v[114:115], v18 offset:25088
    s_add_u32 m0, s36, s44
    v_mfma_f32_16x16x32_bf16 v[180:183], v[52:55], v[28:31], v[180:183]
    buffer_load_dwordx4 v10, s[4:7], s31 offen lds
    v_mfma_f32_16x16x32_bf16 v[184:187], v[56:59], v[28:31], v[184:187]
    s_add_u32 m0, s36, s45
    v_mfma_f32_16x16x32_bf16 v[188:191], v[60:63], v[28:31], v[188:191]
    buffer_load_dwordx4 v11, s[4:7], s31 offen lds
    v_mfma_f32_16x16x32_bf16 v[192:195], v[64:67], v[28:31], v[192:195]
    s_add_u32 m0, s36, s46
    v_mfma_f32_16x16x32_bf16 v[196:199], v[68:71], v[28:31], v[196:199]
    buffer_load_dwordx4 v12, s[8:11], s32 offen lds
    v_mfma_f32_16x16x32_bf16 v[200:203], v[72:75], v[28:31], v[200:203]
    s_add_u32 m0, s36, s47
    v_mfma_f32_16x16x32_bf16 v[204:207], v[76:79], v[28:31], v[204:207]
    buffer_load_dwordx4 v12, s[8:11], s33 offen lds
    v_mfma_f32_16x16x32_bf16 v[208:211], v[80:83], v[28:31], v[208:211]
    s_add_u32 m0, s36, s48
    v_mfma_f32_16x16x32_bf16 v[212:215], v[52:55], v[32:35], v[212:215]
    buffer_load_dwordx4 v12, s[8:11], s34 offen lds
    v_mfma_f32_16x16x32_bf16 v[216:219], v[56:59], v[32:35], v[216:219]
    s_add_u32 m0, s36, s49
    v_mfma_f32_16x16x32_bf16 v[220:223], v[60:63], v[32:35], v[220:223]
    buffer_load_dwordx4 v12, s[8:11], s35 offen lds
    v_mfma_f32_16x16x32_bf16 v[224:227], v[64:67], v[32:35], v[224:227]
    v_mfma_f32_16x16x32_bf16 v[228:231], v[68:71], v[32:35], v[228:231]
    v_mfma_f32_16x16x32_bf16 v[232:235], v[72:75], v[32:35], v[232:235]
    v_mfma_f32_16x16x32_bf16 v[236:239], v[76:79], v[32:35], v[236:239]
    v_mfma_f32_16x16x32_bf16 v[240:243], v[80:83], v[32:35], v[240:243]
    s_add_u32 s31, s31, 128
    s_add_u32 s32, s32, 458752
    s_add_u32 s33, s33, 458752
    s_add_u32 s34, s34, 458752
    s_add_u32 s35, s35, 458752
    s_add_u32 s36, s36, 49152
    s_cmp_ge_u32 s36, 147456
    s_cselect_b32 s36, 0, s36
    s_waitcnt lgkmcnt(0)
    v_mfma_f32_16x16x32_bf16 v[116:119], v[84:87], v[36:39], v[116:119]
    v_mfma_f32_16x16x32_bf16 v[120:123], v[88:91], v[36:39], v[120:123]
    v_mfma_f32_16x16x32_bf16 v[124:127], v[92:95], v[36:39], v[124:127]
    v_mfma_f32_16x16x32_bf16 v[128:131], v[96:99], v[36:39], v[128:131]
    v_mfma_f32_16x16x32_bf16 v[132:135], v[100:103], v[36:39], v[132:135]
    v_mfma_f32_16x16x32_bf16 v[136:139], v[104:107], v[36:39], v[136:139]
    v_mfma_f32_16x16x32_bf16 v[140:143], v[108:111], v[36:39], v[140:143]
    v_mfma_f32_16x16x32_bf16 v[144:147], v[112:115], v[36:39], v[144:147]
    v_mfma_f32_16x16x32_bf16 v[148:151], v[84:87], v[40:43], v[148:151]
    v_mfma_f32_16x16x32_bf16 v[152:155], v[88:91], v[40:43], v[152:155]
    v_mfma_f32_16x16x32_bf16 v[156:159], v[92:95], v[40:43], v[156:159]
    v_mfma_f32_16x16x32_bf16 v[160:163], v[96:99], v[40:43], v[160:163]
    v_mfma_f32_16x16x32_bf16 v[164:167], v[100:103], v[40:43], v[164:167]
    v_mfma_f32_16x16x32_bf16 v[168:171], v[104:107], v[40:43], v[168:171]
    v_mfma_f32_16x16x32_bf16 v[172:175], v[108:111], v[40:43], v[172:175]
    v_mfma_f32_16x16x32_bf16 v[176:179], v[112:115], v[40:43], v[176:179]
    s_waitcnt vmcnt(6)
    s_barrier
    v_add_u32 v16, s37, v13
    v_add_u32 v17, s37, v14
    v_add_u32 v18, s37, v15
    s_add_u32 s37, s37, 49152
    s_cmp_ge_u32 s37, 147456
    s_cselect_b32 s37, 0, s37
    ds_read_b128 v[20:23], v16 offset:0
    ds_read_b128 v[24:27], v16 offset:2048
    ds_read_b128 v[28:31], v16 offset:4096
    ds_read_b128 v[32:35], v16 offset:6144
    ds_read_b64_tr_b16 v[52:53], v17 offset:0
    ds_read_b64_tr_b16 v[54:55], v17 offset:512
    ds_read_b64_tr_b16 v[56:57], v18 offset:0
    ds_read_b64_tr_b16 v[58:59], v18 offset:512
    ds_read_b64_tr_b16 v[60:61], v17 offset:8192
    ds_read_b64_tr_b16 v[62:63], v17 offset:8704
    ds_read_b64_tr_b16 v[64:65], v18 offset:8192
    ds_read_b64_tr_b16 v[66:67], v18 offset:8704
    ds_read_b64_tr_b16 v[68:69], v17 offset:16384
    ds_read_b64_tr_b16 v[70:71], v17 offset:16896
    ds_read_b64_tr_b16 v[72:73], v18 offset:16384
    ds_read_b64_tr_b16 v[74:75], v18 offset:16896
    ds_read_b64_tr_b16 v[76:77], v17 offset:24576
    ds_read_b64_tr_b16 v[78:79], v17 offset:25088
    ds_read_b64_tr_b16 v[80:81], v18 offset:24576
    ds_read_b64_tr_b16 v[82:83], v18 offset:25088
    v_mfma_f32_16x16x32_bf16 v[180:183], v[84:87], v[44:47], v[180:183]
    v_mfma_f32_16x16x32_bf16 v[184:187], v[88:91], v[44:47], v[184:187]
    v_mfma_f32_16x16x32_bf16 v[188:191], v[92:95], v[44:47], v[188:191]
    v_mfma_f32_16x16x32_bf16 v[192:195], v[96:99], v[44:47], v[192:195]
    v_mfma_f32_16x16x32_bf16 v[196:199], v[100:103], v[44:47], v[196:199]
    v_mfma_f32_16x16x32_bf16 v[200:203], v[104:107], v[44:47], v[200:203]
    v_mfma_f32_16x16x32_bf16 v[204:207], v[108:111], v[44:47], v[204:207]
    v_mfma_f32_16x16x32_bf16 v[208:211], v[112:115], v[44:47], v[208:211]
    v_mfma_f32_16x16x32_bf16 v[212:215], v[84:87], v[48:51], v[212:215]
    v_mfma_f32_16x16x32_bf16 v[216:219], v[88:91], v[48:51], v[216:219]
    v_mfma_f32_16x16x32_bf16 v[220:223], v[92:95], v[48:51], v[220:223]
    v_mfma_f32_16x16x32_bf16 v[224:227], v[96:99], v[48:51], v[224:227]
    v_mfma_f32_16x16x32_bf16 v[228:231], v[100:103], v[48:51], v[228:231]
    v_mfma_f32_16x16x32_bf16 v[232:235], v[104:107], v[48:51], v[232:235]
    v_mfma_f32_16x16x32_bf16 v[236:239], v[108:111], v[48:51], v[236:239]
    v_mfma_f32_16x16x32_bf16 v[240:243], v[112:115], v[48:51], v[240:243]
    s_waitcnt lgkmcnt(0)
    v_mfma_f32_16x16x32_bf16 v[116:119], v[52:55], v[20:23], v[116:119]
    v_mfma_f32_16x16x32_bf16 v[120:123], v[56:59], v[20:23], v[120:123]
    v_mfma_f32_16x16x32_bf16 v[124:127], v[60:63], v[20:23], v[124:127]
    v_mfma_f32_16x16x32_bf16 v[128:131], v[64:67], v[20:23], v[128:131]
    v_mfma_f32_16x16x32_bf16 v[132:135], v[68:71], v[20:23], v[132:135]
    v_mfma_f32_16x16x32_bf16 v[136:139], v[72:75], v[20:23], v[136:139]
    v_mfma_f32_16x16x32_bf16 v[140:143], v[76:79], v[20:23], v[140:143]
    v_mfma_f32_16x16x32_bf16 v[144:147], v[80:83], v[20:23], v[144:147]
    v_mfma_f32_16x16x32_bf16 v[148:151], v[52:55], v[24:27], v[148:151]
    v_mfma_f32_16x16x32_bf16 v[152:155], v[56:59], v[24:27], v[152:155]
    v_mfma_f32_16x16x32_bf16 v[156:159], v[60:63], v[24:27], v[156:159]
    v_mfma_f32_16x16x32_bf16 v[160:163], v[64:67], v[24:27], v[160:163]
    v_mfma_f32_16x16x32_bf16 v[164:167], v[68:71], v[24:27], v[164:167]
    v_mfma_f32_16x16x32_bf16 v[168:171], v[72:75], v[24:27], v[168:171]
    v_mfma_f32_16x16x32_bf16 v[172:175], v[76:79], v[24:27], v[172:175]
    v_mfma_f32_16x16x32_bf16 v[176:179], v[80:83], v[24:27], v[176:179]
    s_waitcnt vmcnt(0)
    s_barrier
    v_add_u32 v16, s37, v13
    v_add_u32 v17, s37, v14
    v_add_u32 v18, s37, v15
    s_add_u32 s37, s37, 49152
    s_cmp_ge_u32 s37, 147456
    s_cselect_b32 s37, 0, s37
    ds_read_b128 v[36:39], v16 offset:0
    ds_read_b128 v[40:43], v16 offset:2048
    ds_read_b128 v[44:47], v16 offset:4096
    ds_read_b128 v[48:51], v16 offset:6144
    ds_read_b64_tr_b16 v[84:85], v17 offset:0
    ds_read_b64_tr_b16 v[86:87], v17 offset:512
    ds_read_b64_tr_b16 v[88:89], v18 offset:0
    ds_read_b64_tr_b16 v[90:91], v18 offset:512
    ds_read_b64_tr_b16 v[92:93], v17 offset:8192
    ds_read_b64_tr_b16 v[94:95], v17 offset:8704
    ds_read_b64_tr_b16 v[96:97], v18 offset:8192
    ds_read_b64_tr_b16 v[98:99], v18 offset:8704
    ds_read_b64_tr_b16 v[100:101], v17 offset:16384
    ds_read_b64_tr_b16 v[102:103], v17 offset:16896
    ds_read_b64_tr_b16 v[104:105], v18 offset:16384
    ds_read_b64_tr_b16 v[106:107], v18 offset:16896
    ds_read_b64_tr_b16 v[108:109], v17 offset:24576
    ds_read_b64_tr_b16 v[110:111], v17 offset:25088
    ds_read_b64_tr_b16 v[112:113], v18 offset:24576
    ds_read_b64_tr_b16 v[114:115], v18 offset:25088
    v_mfma_f32_16x16x32_bf16 v[180:183], v[52:55], v[28:31], v[180:183]
    v_mfma_f32_16x16x32_bf16 v[184:187], v[56:59], v[28:31], v[184:187]
    v_mfma_f32_16x16x32_bf16 v[188:191], v[60:63], v[28:31], v[188:191]
    v_mfma_f32_16x16x32_bf16 v[192:195], v[64:67], v[28:31], v[192:195]
    v_mfma_f32_16x16x32_bf16 v[196:199], v[68:71], v[28:31], v[196:199]
    v_mfma_f32_16x16x32_bf16 v[200:203], v[72:75], v[28:31], v[200:203]
    v_mfma_f32_16x16x32_bf16 v[204:207], v[76:79], v[28:31], v[204:207]
    v_mfma_f32_16x16x32_bf16 v[208:211], v[80:83], v[28:31], v[208:211]
    v_mfma_f32_16x16x32_bf16 v[212:215], v[52:55], v[32:35], v[212:215]
    v_mfma_f32_16x16x32_bf16 v[216:219], v[56:59], v[32:35], v[216:219]
    v_mfma_f32_16x16x32_bf16 v[220:223], v[60:63], v[32:35], v[220:223]
    v_mfma_f32_16x16x32_bf16 v[224:227], v[64:67], v[32:35], v[224:227]
    v_mfma_f32_16x16x32_bf16 v[228:231], v[68:71], v[32:35], v[228:231]
    v_mfma_f32_16x16x32_bf16 v[232:235], v[72:75], v[32:35], v[232:235]
    v_mfma_f32_16x16x32_bf16 v[236:239], v[76:79], v[32:35], v[236:239]
    v_mfma_f32_16x16x32_bf16 v[240:243], v[80:83], v[32:35], v[240:243]
    s_waitcnt lgkmcnt(0)
    v_mfma_f32_16x16x32_bf16 v[116:119], v[84:87], v[36:39], v[116:119]
    v_mfma_f32_16x16x32_bf16 v[120:123], v[88:91], v[36:39], v[120:123]
    v_mfma_f32_16x16x32_bf16 v[124:127], v[92:95], v[36:39], v[124:127]
    v_mfma_f32_16x16x32_bf16 v[128:131], v[96:99], v[36:39], v[128:131]
    v_mfma_f32_16x16x32_bf16 v[132:135], v[100:103], v[36:39], v[132:135]
    v_mfma_f32_16x16x32_bf16 v[136:139], v[104:107], v[36:39], v[136:139]
    v_mfma_f32_16x16x32_bf16 v[140:143], v[108:111], v[36:39], v[140:143]
    v_mfma_f32_16x16x32_bf16 v[144:147], v[112:115], v[36:39], v[144:147]
    v_mfma_f32_16x16x32_bf16 v[148:151], v[84:87], v[40:43], v[148:151]
    v_mfma_f32_16x16x32_bf16 v[152:155], v[88:91], v[40:43], v[152:155]
    v_mfma_f32_16x16x32_bf16 v[156:159], v[92:95], v[40:43], v[156:159]
    v_mfma_f32_16x16x32_bf16 v[160:163], v[96:99], v[40:43], v[160:163]
    v_mfma_f32_16x16x32_bf16 v[164:167], v[100:103], v[40:43], v[164:167]
    v_mfma_f32_16x16x32_bf16 v[168:171], v[104:107], v[40:43], v[168:171]
    v_mfma_f32_16x16x32_bf16 v[172:175], v[108:111], v[40:43], v[172:175]
    v_mfma_f32_16x16x32_bf16 v[176:179], v[112:115], v[40:43], v[176:179]
    v_mfma_f32_16x16x32_bf16 v[180:183], v[84:87], v[44:47], v[180:183]
    v_mfma_f32_16x16x32_bf16 v[184:187], v[88:91], v[44:47], v[184:187]
    v_mfma_f32_16x16x32_bf16 v[188:191], v[92:95], v[44:47], v[188:191]
    v_mfma_f32_16x16x32_bf16 v[192:195], v[96:99], v[44:47], v[192:195]
    v_mfma_f32_16x16x32_bf16 v[196:199], v[100:103], v[44:47], v[196:199]
    v_mfma_f32_16x16x32_bf16 v[200:203], v[104:107], v[44:47], v[200:203]
    v_mfma_f32_16x16x32_bf16 v[204:207], v[108:111], v[44:47], v[204:207]
    v_mfma_f32_16x16x32_bf16 v[208:211], v[112:115], v[44:47], v[208:211]
    v_mfma_f32_16x16x32_bf16 v[212:215], v[84:87], v[48:51], v[212:215]
    v_mfma_f32_16x16x32_bf16 v[216:219], v[88:91], v[48:51], v[216:219]
    v_mfma_f32_16x16x32_bf16 v[220:223], v[92:95], v[48:51], v[220:223]
    v_mfma_f32_16x16x32_bf16 v[224:227], v[96:99], v[48:51], v[224:227]
    v_mfma_f32_16x16x32_bf16 v[228:231], v[100:103], v[48:51], v[228:231]
    v_mfma_f32_16x16x32_bf16 v[232:235], v[104:107], v[48:51], v[232:235]
    v_mfma_f32_16x16x32_bf16 v[236:239], v[108:111], v[48:51], v[236:239]
    v_mfma_f32_16x16x32_bf16 v[240:243], v[112:115], v[48:51], v[240:243]
    s_waitcnt vmcnt(0) lgkmcnt(0)
    s_barrier
    s_xor_b32 s38, s26, 4
    s_mul_i32 s38, s38, 16384
    v_lshlrev_b32 v2, 4, v1
    v_add_u32 v2, s38, v2
    s_nop 7
    s_cmp_eq_u32 s27, 0
    s_cbranch_scc0 L_give1_mlp1_0_kernel
    ds_write_b128 v2, v[180:183] offset:0
    ds_write_b128 v2, v[184:187] offset:1024
    ds_write_b128 v2, v[188:191] offset:2048
    ds_write_b128 v2, v[192:195] offset:3072
    ds_write_b128 v2, v[196:199] offset:4096
    ds_write_b128 v2, v[200:203] offset:5120
    ds_write_b128 v2, v[204:207] offset:6144
    ds_write_b128 v2, v[208:211] offset:7168
    ds_write_b128 v2, v[212:215] offset:8192
    ds_write_b128 v2, v[216:219] offset:9216
    ds_write_b128 v2, v[220:223] offset:10240
    ds_write_b128 v2, v[224:227] offset:11264
    ds_write_b128 v2, v[228:231] offset:12288
    ds_write_b128 v2, v[232:235] offset:13312
    ds_write_b128 v2, v[236:239] offset:14336
    ds_write_b128 v2, v[240:243] offset:15360
    s_branch L_give_done_mlp1_0_kernel
L_give1_mlp1_0_kernel:
    ds_write_b128 v2, v[116:119] offset:0
    ds_write_b128 v2, v[120:123] offset:1024
    ds_write_b128 v2, v[124:127] offset:2048
    ds_write_b128 v2, v[128:131] offset:3072
    ds_write_b128 v2, v[132:135] offset:4096
    ds_write_b128 v2, v[136:139] offset:5120
    ds_write_b128 v2, v[140:143] offset:6144
    ds_write_b128 v2, v[144:147] offset:7168
    ds_write_b128 v2, v[148:151] offset:8192
    ds_write_b128 v2, v[152:155] offset:9216
    ds_write_b128 v2, v[156:159] offset:10240
    ds_write_b128 v2, v[160:163] offset:11264
    ds_write_b128 v2, v[164:167] offset:12288
    ds_write_b128 v2, v[168:171] offset:13312
    ds_write_b128 v2, v[172:175] offset:14336
    ds_write_b128 v2, v[176:179] offset:15360
L_give_done_mlp1_0_kernel:
    s_waitcnt lgkmcnt(0)
    s_barrier
    s_mul_i32 s38, s26, 16384
    v_lshlrev_b32 v2, 4, v1
    v_add_u32 v2, s38, v2
    s_mul_i32 s38, s27, 64
    s_cmp_eq_u32 s27, 0
    s_cbranch_scc0 L_keep1_mlp1_0_kernel
    ds_read_b128 v[20:23], v2 offset:0
    ds_read_b128 v[24:27], v2 offset:1024
    ds_read_b128 v[28:31], v2 offset:2048
    ds_read_b128 v[32:35], v2 offset:3072
    ds_read_b128 v[36:39], v2 offset:4096
    ds_read_b128 v[40:43], v2 offset:5120
    ds_read_b128 v[44:47], v2 offset:6144
    ds_read_b128 v[48:51], v2 offset:7168
    ds_read_b128 v[52:55], v2 offset:8192
    ds_read_b128 v[56:59], v2 offset:9216
    ds_read_b128 v[60:63], v2 offset:10240
    ds_read_b128 v[64:67], v2 offset:11264
    ds_read_b128 v[68:71], v2 offset:12288
    ds_read_b128 v[72:75], v2 offset:13312
    ds_read_b128 v[76:79], v2 offset:14336
    ds_read_b128 v[80:83], v2 offset:15360
    s_waitcnt lgkmcnt(0)
    v_add_f32 v20, v116, v20
    v_add_f32 v21, v117, v21
    v_add_f32 v22, v118, v22
    v_add_f32 v23, v119, v23
    v_add_f32 v24, v120, v24
    v_add_f32 v25, v121, v25
    v_add_f32 v26, v122, v26
    v_add_f32 v27, v123, v27
    v_add_f32 v28, v124, v28
    v_add_f32 v29, v125, v29
    v_add_f32 v30, v126, v30
    v_add_f32 v31, v127, v31
    v_add_f32 v32, v128, v32
    v_add_f32 v33, v129, v33
    v_add_f32 v34, v130, v34
    v_add_f32 v35, v131, v35
    v_add_f32 v36, v132, v36
    v_add_f32 v37, v133, v37
    v_add_f32 v38, v134, v38
    v_add_f32 v39, v135, v39
    v_add_f32 v40, v136, v40
    v_add_f32 v41, v137, v41
    v_add_f32 v42, v138, v42
    v_add_f32 v43, v139, v43
    v_add_f32 v44, v140, v44
    v_add_f32 v45, v141, v45
    v_add_f32 v46, v142, v46
    v_add_f32 v47, v143, v47
    v_add_f32 v48, v144, v48
    v_add_f32 v49, v145, v49
    v_add_f32 v50, v146, v50
    v_add_f32 v51, v147, v51
    v_add_f32 v52, v148, v52
    v_add_f32 v53, v149, v53
    v_add_f32 v54, v150, v54
    v_add_f32 v55, v151, v55
    v_add_f32 v56, v152, v56
    v_add_f32 v57, v153, v57
    v_add_f32 v58, v154, v58
    v_add_f32 v59, v155, v59
    v_add_f32 v60, v156, v60
    v_add_f32 v61, v157, v61
    v_add_f32 v62, v158, v62
    v_add_f32 v63, v159, v63
    v_add_f32 v64, v160, v64
    v_add_f32 v65, v161, v65
    v_add_f32 v66, v162, v66
    v_add_f32 v67, v163, v67
    v_add_f32 v68, v164, v68
    v_add_f32 v69, v165, v69
    v_add_f32 v70, v166, v70
    v_add_f32 v71, v167, v71
    v_add_f32 v72, v168, v72
    v_add_f32 v73, v169, v73
    v_add_f32 v74, v170, v74
    v_add_f32 v75, v171, v75
    v_add_f32 v76, v172, v76
    v_add_f32 v77, v173, v77
    v_add_f32 v78, v174, v78
    v_add_f32 v79, v175, v79
    v_add_f32 v80, v176, v80
    v_add_f32 v81, v177, v81
    v_add_f32 v82, v178, v82
    v_add_f32 v83, v179, v83
    s_branch L_keep_done_mlp1_0_kernel
L_keep1_mlp1_0_kernel:
    ds_read_b128 v[20:23], v2 offset:0
    ds_read_b128 v[24:27], v2 offset:1024
    ds_read_b128 v[28:31], v2 offset:2048
    ds_read_b128 v[32:35], v2 offset:3072
    ds_read_b128 v[36:39], v2 offset:4096
    ds_read_b128 v[40:43], v2 offset:5120
    ds_read_b128 v[44:47], v2 offset:6144
    ds_read_b128 v[48:51], v2 offset:7168
    ds_read_b128 v[52:55], v2 offset:8192
    ds_read_b128 v[56:59], v2 offset:9216
    ds_read_b128 v[60:63], v2 offset:10240
    ds_read_b128 v[64:67], v2 offset:11264
    ds_read_b128 v[68:71], v2 offset:12288
    ds_read_b128 v[72:75], v2 offset:13312
    ds_read_b128 v[76:79], v2 offset:14336
    ds_read_b128 v[80:83], v2 offset:15360
    s_waitcnt lgkmcnt(0)
    v_add_f32 v20, v180, v20
    v_add_f32 v21, v181, v21
    v_add_f32 v22, v182, v22
    v_add_f32 v23, v183, v23
    v_add_f32 v24, v184, v24
    v_add_f32 v25, v185, v25
    v_add_f32 v26, v186, v26
    v_add_f32 v27, v187, v27
    v_add_f32 v28, v188, v28
    v_add_f32 v29, v189, v29
    v_add_f32 v30, v190, v30
    v_add_f32 v31, v191, v31
    v_add_f32 v32, v192, v32
    v_add_f32 v33, v193, v33
    v_add_f32 v34, v194, v34
    v_add_f32 v35, v195, v35
    v_add_f32 v36, v196, v36
    v_add_f32 v37, v197, v37
    v_add_f32 v38, v198, v38
    v_add_f32 v39, v199, v39
    v_add_f32 v40, v200, v40
    v_add_f32 v41, v201, v41
    v_add_f32 v42, v202, v42
    v_add_f32 v43, v203, v43
    v_add_f32 v44, v204, v44
    v_add_f32 v45, v205, v45
    v_add_f32 v46, v206, v46
    v_add_f32 v47, v207, v47
    v_add_f32 v48, v208, v48
    v_add_f32 v49, v209, v49
    v_add_f32 v50, v210, v50
    v_add_f32 v51, v211, v51
    v_add_f32 v52, v212, v52
    v_add_f32 v53, v213, v53
    v_add_f32 v54, v214, v54
    v_add_f32 v55, v215, v55
    v_add_f32 v56, v216, v56
    v_add_f32 v57, v217, v57
    v_add_f32 v58, v218, v58
    v_add_f32 v59, v219, v59
    v_add_f32 v60, v220, v60
    v_add_f32 v61, v221, v61
    v_add_f32 v62, v222, v62
    v_add_f32 v63, v223, v63
    v_add_f32 v64, v224, v64
    v_add_f32 v65, v225, v65
    v_add_f32 v66, v226, v66
    v_add_f32 v67, v227, v67
    v_add_f32 v68, v228, v68
    v_add_f32 v69, v229, v69
    v_add_f32 v70, v230, v70
    v_add_f32 v71, v231, v71
    v_add_f32 v72, v232, v72
    v_add_f32 v73, v233, v73
    v_add_f32 v74, v234, v74
    v_add_f32 v75, v235, v75
    v_add_f32 v76, v236, v76
    v_add_f32 v77, v237, v77
    v_add_f32 v78, v238, v78
    v_add_f32 v79, v239, v79
    v_add_f32 v80, v240, v80
    v_add_f32 v81, v241, v81
    v_add_f32 v82, v242, v82
    v_add_f32 v83, v243, v83
L_keep_done_mlp1_0_kernel:
    s_add_u32 s12, s50, 25165824
    s_addc_u32 s13, s51, 0
    s_mov_b32 s14, 14680064
    s_mov_b32 s15, 0x00020000
    s_mov_b32 s20, s56
    s_mov_b32 s21, s57
    s_mov_b32 s22, 7168
    s_mov_b32 s23, 0x00020000
    s_mov_b32 s62, 0x3d372713
    s_mov_b32 s63, 0xc0135761
    v_and_b32 v2, 15, v1
    s_lshl_b32 s38, s24, 7
    s_lshl_b32 s39, s28, 6
    s_add_u32 s38, s38, s39
    s_lshl_b32 s39, s27, 5
    s_add_u32 s38, s38, s39
    v_add_u32 v2, s38, v2
    s_mov_b32 s38, 7168
    v_mul_lo_u32 v2, v2, s38
    v_lshrrev_b32 v3, 4, v1
    v_lshlrev_b32 v3, 3, v3
    s_lshl_b32 s38, s29, 6
    s_mul_i32 s39, s25, 512
    s_add_u32 s38, s38, s39
    v_add3_u32 v2, v2, v3, s38
    v_lshrrev_b32 v3, 4, v1
    v_lshlrev_b32 v3, 3, v3
    s_lshl_b32 s38, s29, 6
    s_mul_i32 s39, s25, 512
    s_add_u32 s38, s38, s39
    v_add_u32 v3, s38, v3
    buffer_load_dwordx2 v[84:85], v3, s[20:23], 0 offen offset:0
    buffer_load_dwordx2 v[86:87], v3, s[20:23], 0 offen offset:32
    buffer_load_dwordx2 v[88:89], v3, s[20:23], 0 offen offset:128
    buffer_load_dwordx2 v[90:91], v3, s[20:23], 0 offen offset:160
    buffer_load_dwordx2 v[92:93], v3, s[20:23], 0 offen offset:256
    buffer_load_dwordx2 v[94:95], v3, s[20:23], 0 offen offset:288
    buffer_load_dwordx2 v[96:97], v3, s[20:23], 0 offen offset:384
    buffer_load_dwordx2 v[98:99], v3, s[20:23], 0 offen offset:416
    s_waitcnt vmcnt(0)
    v_cvt_pk_bf16_f32 v4, v20, v21
    v_lshlrev_b32 v20, 16, v4
    v_and_b32 v21, 0xffff0000, v4
    v_cvt_pk_bf16_f32 v4, v22, v23
    v_lshlrev_b32 v22, 16, v4
    v_and_b32 v23, 0xffff0000, v4
    v_lshlrev_b32 v4, 16, v84
    v_add_f32 v20, v4, v20
    v_and_b32 v4, 0xffff0000, v84
    v_add_f32 v21, v4, v21
    v_lshlrev_b32 v4, 16, v85
    v_add_f32 v22, v4, v22
    v_and_b32 v4, 0xffff0000, v85
    v_add_f32 v23, v4, v23
    v_cvt_pk_bf16_f32 v4, v20, v21
    v_lshlrev_b32 v20, 16, v4
    v_and_b32 v21, 0xffff0000, v4
    v_cvt_pk_bf16_f32 v4, v22, v23
    v_lshlrev_b32 v22, 16, v4
    v_and_b32 v23, 0xffff0000, v4
    v_mul_f32 v100, v20, v20
    v_mul_f32 v101, v21, v21
    v_mul_f32 v102, v22, v22
    v_mul_f32 v103, v23, v23
    v_fma_f32 v100, v100, s62, 1.0
    v_fma_f32 v101, v101, s62, 1.0
    v_fma_f32 v102, v102, s62, 1.0
    v_fma_f32 v103, v103, s62, 1.0
    v_mul_f32 v100, v100, v20
    v_mul_f32 v101, v101, v21
    v_mul_f32 v102, v102, v22
    v_mul_f32 v103, v103, v23
    v_mul_f32 v100, s63, v100
    v_mul_f32 v101, s63, v101
    v_mul_f32 v102, s63, v102
    v_mul_f32 v103, s63, v103
    v_exp_f32 v100, v100
    v_exp_f32 v101, v101
    v_exp_f32 v102, v102
    v_exp_f32 v103, v103
    s_nop 0
    v_add_f32 v100, 1.0, v100
    v_add_f32 v101, 1.0, v101
    v_add_f32 v102, 1.0, v102
    v_add_f32 v103, 1.0, v103
    v_rcp_f32 v100, v100
    v_rcp_f32 v101, v101
    v_rcp_f32 v102, v102
    v_rcp_f32 v103, v103
    s_nop 0
    v_mul_f32 v20, v20, v100
    v_mul_f32 v21, v21, v101
    v_mul_f32 v22, v22, v102
    v_mul_f32 v23, v23, v103
    v_cvt_pk_bf16_f32 v4, v20, v21
    v_cvt_pk_bf16_f32 v5, v22, v23
    s_mov_b32 s39, 0
    buffer_store_dwordx2 v[4:5], v2, s[12:15], s39 offen offset:0
    v_cvt_pk_bf16_f32 v4, v24, v25
    v_lshlrev_b32 v24, 16, v4
    v_and_b32 v25, 0xffff0000, v4
    v_cvt_pk_bf16_f32 v4, v26, v27
    v_lshlrev_b32 v26, 16, v4
    v_and_b32 v27, 0xffff0000, v4
    v_lshlrev_b32 v4, 16, v86
    v_add_f32 v24, v4, v24
    v_and_b32 v4, 0xffff0000, v86
    v_add_f32 v25, v4, v25
    v_lshlrev_b32 v4, 16, v87
    v_add_f32 v26, v4, v26
    v_and_b32 v4, 0xffff0000, v87
    v_add_f32 v27, v4, v27
    v_cvt_pk_bf16_f32 v4, v24, v25
    v_lshlrev_b32 v24, 16, v4
    v_and_b32 v25, 0xffff0000, v4
    v_cvt_pk_bf16_f32 v4, v26, v27
    v_lshlrev_b32 v26, 16, v4
    v_and_b32 v27, 0xffff0000, v4
    v_mul_f32 v100, v24, v24
    v_mul_f32 v101, v25, v25
    v_mul_f32 v102, v26, v26
    v_mul_f32 v103, v27, v27
    v_fma_f32 v100, v100, s62, 1.0
    v_fma_f32 v101, v101, s62, 1.0
    v_fma_f32 v102, v102, s62, 1.0
    v_fma_f32 v103, v103, s62, 1.0
    v_mul_f32 v100, v100, v24
    v_mul_f32 v101, v101, v25
    v_mul_f32 v102, v102, v26
    v_mul_f32 v103, v103, v27
    v_mul_f32 v100, s63, v100
    v_mul_f32 v101, s63, v101
    v_mul_f32 v102, s63, v102
    v_mul_f32 v103, s63, v103
    v_exp_f32 v100, v100
    v_exp_f32 v101, v101
    v_exp_f32 v102, v102
    v_exp_f32 v103, v103
    s_nop 0
    v_add_f32 v100, 1.0, v100
    v_add_f32 v101, 1.0, v101
    v_add_f32 v102, 1.0, v102
    v_add_f32 v103, 1.0, v103
    v_rcp_f32 v100, v100
    v_rcp_f32 v101, v101
    v_rcp_f32 v102, v102
    v_rcp_f32 v103, v103
    s_nop 0
    v_mul_f32 v24, v24, v100
    v_mul_f32 v25, v25, v101
    v_mul_f32 v26, v26, v102
    v_mul_f32 v27, v27, v103
    v_cvt_pk_bf16_f32 v4, v24, v25
    v_cvt_pk_bf16_f32 v5, v26, v27
    s_mov_b32 s39, 0
    buffer_store_dwordx2 v[4:5], v2, s[12:15], s39 offen offset:32
    v_cvt_pk_bf16_f32 v4, v28, v29
    v_lshlrev_b32 v28, 16, v4
    v_and_b32 v29, 0xffff0000, v4
    v_cvt_pk_bf16_f32 v4, v30, v31
    v_lshlrev_b32 v30, 16, v4
    v_and_b32 v31, 0xffff0000, v4
    v_lshlrev_b32 v4, 16, v88
    v_add_f32 v28, v4, v28
    v_and_b32 v4, 0xffff0000, v88
    v_add_f32 v29, v4, v29
    v_lshlrev_b32 v4, 16, v89
    v_add_f32 v30, v4, v30
    v_and_b32 v4, 0xffff0000, v89
    v_add_f32 v31, v4, v31
    v_cvt_pk_bf16_f32 v4, v28, v29
    v_lshlrev_b32 v28, 16, v4
    v_and_b32 v29, 0xffff0000, v4
    v_cvt_pk_bf16_f32 v4, v30, v31
    v_lshlrev_b32 v30, 16, v4
    v_and_b32 v31, 0xffff0000, v4
    v_mul_f32 v100, v28, v28
    v_mul_f32 v101, v29, v29
    v_mul_f32 v102, v30, v30
    v_mul_f32 v103, v31, v31
    v_fma_f32 v100, v100, s62, 1.0
    v_fma_f32 v101, v101, s62, 1.0
    v_fma_f32 v102, v102, s62, 1.0
    v_fma_f32 v103, v103, s62, 1.0
    v_mul_f32 v100, v100, v28
    v_mul_f32 v101, v101, v29
    v_mul_f32 v102, v102, v30
    v_mul_f32 v103, v103, v31
    v_mul_f32 v100, s63, v100
    v_mul_f32 v101, s63, v101
    v_mul_f32 v102, s63, v102
    v_mul_f32 v103, s63, v103
    v_exp_f32 v100, v100
    v_exp_f32 v101, v101
    v_exp_f32 v102, v102
    v_exp_f32 v103, v103
    s_nop 0
    v_add_f32 v100, 1.0, v100
    v_add_f32 v101, 1.0, v101
    v_add_f32 v102, 1.0, v102
    v_add_f32 v103, 1.0, v103
    v_rcp_f32 v100, v100
    v_rcp_f32 v101, v101
    v_rcp_f32 v102, v102
    v_rcp_f32 v103, v103
    s_nop 0
    v_mul_f32 v28, v28, v100
    v_mul_f32 v29, v29, v101
    v_mul_f32 v30, v30, v102
    v_mul_f32 v31, v31, v103
    v_cvt_pk_bf16_f32 v4, v28, v29
    v_cvt_pk_bf16_f32 v5, v30, v31
    s_mov_b32 s39, 0
    buffer_store_dwordx2 v[4:5], v2, s[12:15], s39 offen offset:128
    v_cvt_pk_bf16_f32 v4, v32, v33
    v_lshlrev_b32 v32, 16, v4
    v_and_b32 v33, 0xffff0000, v4
    v_cvt_pk_bf16_f32 v4, v34, v35
    v_lshlrev_b32 v34, 16, v4
    v_and_b32 v35, 0xffff0000, v4
    v_lshlrev_b32 v4, 16, v90
    v_add_f32 v32, v4, v32
    v_and_b32 v4, 0xffff0000, v90
    v_add_f32 v33, v4, v33
    v_lshlrev_b32 v4, 16, v91
    v_add_f32 v34, v4, v34
    v_and_b32 v4, 0xffff0000, v91
    v_add_f32 v35, v4, v35
    v_cvt_pk_bf16_f32 v4, v32, v33
    v_lshlrev_b32 v32, 16, v4
    v_and_b32 v33, 0xffff0000, v4
    v_cvt_pk_bf16_f32 v4, v34, v35
    v_lshlrev_b32 v34, 16, v4
    v_and_b32 v35, 0xffff0000, v4
    v_mul_f32 v100, v32, v32
    v_mul_f32 v101, v33, v33
    v_mul_f32 v102, v34, v34
    v_mul_f32 v103, v35, v35
    v_fma_f32 v100, v100, s62, 1.0
    v_fma_f32 v101, v101, s62, 1.0
    v_fma_f32 v102, v102, s62, 1.0
    v_fma_f32 v103, v103, s62, 1.0
    v_mul_f32 v100, v100, v32
    v_mul_f32 v101, v101, v33
    v_mul_f32 v102, v102, v34
    v_mul_f32 v103, v103, v35
    v_mul_f32 v100, s63, v100
    v_mul_f32 v101, s63, v101
    v_mul_f32 v102, s63, v102
    v_mul_f32 v103, s63, v103
    v_exp_f32 v100, v100
    v_exp_f32 v101, v101
    v_exp_f32 v102, v102
    v_exp_f32 v103, v103
    s_nop 0
    v_add_f32 v100, 1.0, v100
    v_add_f32 v101, 1.0, v101
    v_add_f32 v102, 1.0, v102
    v_add_f32 v103, 1.0, v103
    v_rcp_f32 v100, v100
    v_rcp_f32 v101, v101
    v_rcp_f32 v102, v102
    v_rcp_f32 v103, v103
    s_nop 0
    v_mul_f32 v32, v32, v100
    v_mul_f32 v33, v33, v101
    v_mul_f32 v34, v34, v102
    v_mul_f32 v35, v35, v103
    v_cvt_pk_bf16_f32 v4, v32, v33
    v_cvt_pk_bf16_f32 v5, v34, v35
    s_mov_b32 s39, 0
    buffer_store_dwordx2 v[4:5], v2, s[12:15], s39 offen offset:160
    v_cvt_pk_bf16_f32 v4, v36, v37
    v_lshlrev_b32 v36, 16, v4
    v_and_b32 v37, 0xffff0000, v4
    v_cvt_pk_bf16_f32 v4, v38, v39
    v_lshlrev_b32 v38, 16, v4
    v_and_b32 v39, 0xffff0000, v4
    v_lshlrev_b32 v4, 16, v92
    v_add_f32 v36, v4, v36
    v_and_b32 v4, 0xffff0000, v92
    v_add_f32 v37, v4, v37
    v_lshlrev_b32 v4, 16, v93
    v_add_f32 v38, v4, v38
    v_and_b32 v4, 0xffff0000, v93
    v_add_f32 v39, v4, v39
    v_cvt_pk_bf16_f32 v4, v36, v37
    v_lshlrev_b32 v36, 16, v4
    v_and_b32 v37, 0xffff0000, v4
    v_cvt_pk_bf16_f32 v4, v38, v39
    v_lshlrev_b32 v38, 16, v4
    v_and_b32 v39, 0xffff0000, v4
    v_mul_f32 v100, v36, v36
    v_mul_f32 v101, v37, v37
    v_mul_f32 v102, v38, v38
    v_mul_f32 v103, v39, v39
    v_fma_f32 v100, v100, s62, 1.0
    v_fma_f32 v101, v101, s62, 1.0
    v_fma_f32 v102, v102, s62, 1.0
    v_fma_f32 v103, v103, s62, 1.0
    v_mul_f32 v100, v100, v36
    v_mul_f32 v101, v101, v37
    v_mul_f32 v102, v102, v38
    v_mul_f32 v103, v103, v39
    v_mul_f32 v100, s63, v100
    v_mul_f32 v101, s63, v101
    v_mul_f32 v102, s63, v102
    v_mul_f32 v103, s63, v103
    v_exp_f32 v100, v100
    v_exp_f32 v101, v101
    v_exp_f32 v102, v102
    v_exp_f32 v103, v103
    s_nop 0
    v_add_f32 v100, 1.0, v100
    v_add_f32 v101, 1.0, v101
    v_add_f32 v102, 1.0, v102
    v_add_f32 v103, 1.0, v103
    v_rcp_f32 v100, v100
    v_rcp_f32 v101, v101
    v_rcp_f32 v102, v102
    v_rcp_f32 v103, v103
    s_nop 0
    v_mul_f32 v36, v36, v100
    v_mul_f32 v37, v37, v101
    v_mul_f32 v38, v38, v102
    v_mul_f32 v39, v39, v103
    v_cvt_pk_bf16_f32 v4, v36, v37
    v_cvt_pk_bf16_f32 v5, v38, v39
    s_mov_b32 s39, 0
    buffer_store_dwordx2 v[4:5], v2, s[12:15], s39 offen offset:256
    v_cvt_pk_bf16_f32 v4, v40, v41
    v_lshlrev_b32 v40, 16, v4
    v_and_b32 v41, 0xffff0000, v4
    v_cvt_pk_bf16_f32 v4, v42, v43
    v_lshlrev_b32 v42, 16, v4
    v_and_b32 v43, 0xffff0000, v4
    v_lshlrev_b32 v4, 16, v94
    v_add_f32 v40, v4, v40
    v_and_b32 v4, 0xffff0000, v94
    v_add_f32 v41, v4, v41
    v_lshlrev_b32 v4, 16, v95
    v_add_f32 v42, v4, v42
    v_and_b32 v4, 0xffff0000, v95
    v_add_f32 v43, v4, v43
    v_cvt_pk_bf16_f32 v4, v40, v41
    v_lshlrev_b32 v40, 16, v4
    v_and_b32 v41, 0xffff0000, v4
    v_cvt_pk_bf16_f32 v4, v42, v43
    v_lshlrev_b32 v42, 16, v4
    v_and_b32 v43, 0xffff0000, v4
    v_mul_f32 v100, v40, v40
    v_mul_f32 v101, v41, v41
    v_mul_f32 v102, v42, v42
    v_mul_f32 v103, v43, v43
    v_fma_f32 v100, v100, s62, 1.0
    v_fma_f32 v101, v101, s62, 1.0
    v_fma_f32 v102, v102, s62, 1.0
    v_fma_f32 v103, v103, s62, 1.0
    v_mul_f32 v100, v100, v40
    v_mul_f32 v101, v101, v41
    v_mul_f32 v102, v102, v42
    v_mul_f32 v103, v103, v43
    v_mul_f32 v100, s63, v100
    v_mul_f32 v101, s63, v101
    v_mul_f32 v102, s63, v102
    v_mul_f32 v103, s63, v103
    v_exp_f32 v100, v100
    v_exp_f32 v101, v101
    v_exp_f32 v102, v102
    v_exp_f32 v103, v103
    s_nop 0
    v_add_f32 v100, 1.0, v100
    v_add_f32 v101, 1.0, v101
    v_add_f32 v102, 1.0, v102
    v_add_f32 v103, 1.0, v103
    v_rcp_f32 v100, v100
    v_rcp_f32 v101, v101
    v_rcp_f32 v102, v102
    v_rcp_f32 v103, v103
    s_nop 0
    v_mul_f32 v40, v40, v100
    v_mul_f32 v41, v41, v101
    v_mul_f32 v42, v42, v102
    v_mul_f32 v43, v43, v103
    v_cvt_pk_bf16_f32 v4, v40, v41
    v_cvt_pk_bf16_f32 v5, v42, v43
    s_mov_b32 s39, 0
    buffer_store_dwordx2 v[4:5], v2, s[12:15], s39 offen offset:288
    v_cvt_pk_bf16_f32 v4, v44, v45
    v_lshlrev_b32 v44, 16, v4
    v_and_b32 v45, 0xffff0000, v4
    v_cvt_pk_bf16_f32 v4, v46, v47
    v_lshlrev_b32 v46, 16, v4
    v_and_b32 v47, 0xffff0000, v4
    v_lshlrev_b32 v4, 16, v96
    v_add_f32 v44, v4, v44
    v_and_b32 v4, 0xffff0000, v96
    v_add_f32 v45, v4, v45
    v_lshlrev_b32 v4, 16, v97
    v_add_f32 v46, v4, v46
    v_and_b32 v4, 0xffff0000, v97
    v_add_f32 v47, v4, v47
    v_cvt_pk_bf16_f32 v4, v44, v45
    v_lshlrev_b32 v44, 16, v4
    v_and_b32 v45, 0xffff0000, v4
    v_cvt_pk_bf16_f32 v4, v46, v47
    v_lshlrev_b32 v46, 16, v4
    v_and_b32 v47, 0xffff0000, v4
    v_mul_f32 v100, v44, v44
    v_mul_f32 v101, v45, v45
    v_mul_f32 v102, v46, v46
    v_mul_f32 v103, v47, v47
    v_fma_f32 v100, v100, s62, 1.0
    v_fma_f32 v101, v101, s62, 1.0
    v_fma_f32 v102, v102, s62, 1.0
    v_fma_f32 v103, v103, s62, 1.0
    v_mul_f32 v100, v100, v44
    v_mul_f32 v101, v101, v45
    v_mul_f32 v102, v102, v46
    v_mul_f32 v103, v103, v47
    v_mul_f32 v100, s63, v100
    v_mul_f32 v101, s63, v101
    v_mul_f32 v102, s63, v102
    v_mul_f32 v103, s63, v103
    v_exp_f32 v100, v100
    v_exp_f32 v101, v101
    v_exp_f32 v102, v102
    v_exp_f32 v103, v103
    s_nop 0
    v_add_f32 v100, 1.0, v100
    v_add_f32 v101, 1.0, v101
    v_add_f32 v102, 1.0, v102
    v_add_f32 v103, 1.0, v103
    v_rcp_f32 v100, v100
    v_rcp_f32 v101, v101
    v_rcp_f32 v102, v102
    v_rcp_f32 v103, v103
    s_nop 0
    v_mul_f32 v44, v44, v100
    v_mul_f32 v45, v45, v101
    v_mul_f32 v46, v46, v102
    v_mul_f32 v47, v47, v103
    v_cvt_pk_bf16_f32 v4, v44, v45
    v_cvt_pk_bf16_f32 v5, v46, v47
    s_mov_b32 s39, 0
    buffer_store_dwordx2 v[4:5], v2, s[12:15], s39 offen offset:384
    v_cvt_pk_bf16_f32 v4, v48, v49
    v_lshlrev_b32 v48, 16, v4
    v_and_b32 v49, 0xffff0000, v4
    v_cvt_pk_bf16_f32 v4, v50, v51
    v_lshlrev_b32 v50, 16, v4
    v_and_b32 v51, 0xffff0000, v4
    v_lshlrev_b32 v4, 16, v98
    v_add_f32 v48, v4, v48
    v_and_b32 v4, 0xffff0000, v98
    v_add_f32 v49, v4, v49
    v_lshlrev_b32 v4, 16, v99
    v_add_f32 v50, v4, v50
    v_and_b32 v4, 0xffff0000, v99
    v_add_f32 v51, v4, v51
    v_cvt_pk_bf16_f32 v4, v48, v49
    v_lshlrev_b32 v48, 16, v4
    v_and_b32 v49, 0xffff0000, v4
    v_cvt_pk_bf16_f32 v4, v50, v51
    v_lshlrev_b32 v50, 16, v4
    v_and_b32 v51, 0xffff0000, v4
    v_mul_f32 v100, v48, v48
    v_mul_f32 v101, v49, v49
    v_mul_f32 v102, v50, v50
    v_mul_f32 v103, v51, v51
    v_fma_f32 v100, v100, s62, 1.0
    v_fma_f32 v101, v101, s62, 1.0
    v_fma_f32 v102, v102, s62, 1.0
    v_fma_f32 v103, v103, s62, 1.0
    v_mul_f32 v100, v100, v48
    v_mul_f32 v101, v101, v49
    v_mul_f32 v102, v102, v50
    v_mul_f32 v103, v103, v51
    v_mul_f32 v100, s63, v100
    v_mul_f32 v101, s63, v101
    v_mul_f32 v102, s63, v102
    v_mul_f32 v103, s63, v103
    v_exp_f32 v100, v100
    v_exp_f32 v101, v101
    v_exp_f32 v102, v102
    v_exp_f32 v103, v103
    s_nop 0
    v_add_f32 v100, 1.0, v100
    v_add_f32 v101, 1.0, v101
    v_add_f32 v102, 1.0, v102
    v_add_f32 v103, 1.0, v103
    v_rcp_f32 v100, v100
    v_rcp_f32 v101, v101
    v_rcp_f32 v102, v102
    v_rcp_f32 v103, v103
    s_nop 0
    v_mul_f32 v48, v48, v100
    v_mul_f32 v49, v49, v101
    v_mul_f32 v50, v50, v102
    v_mul_f32 v51, v51, v103
    v_cvt_pk_bf16_f32 v4, v48, v49
    v_cvt_pk_bf16_f32 v5, v50, v51
    s_mov_b32 s39, 0
    buffer_store_dwordx2 v[4:5], v2, s[12:15], s39 offen offset:416
    v_cvt_pk_bf16_f32 v4, v52, v53
    v_lshlrev_b32 v52, 16, v4
    v_and_b32 v53, 0xffff0000, v4
    v_cvt_pk_bf16_f32 v4, v54, v55
    v_lshlrev_b32 v54, 16, v4
    v_and_b32 v55, 0xffff0000, v4
    v_lshlrev_b32 v4, 16, v84
    v_add_f32 v52, v4, v52
    v_and_b32 v4, 0xffff0000, v84
    v_add_f32 v53, v4, v53
    v_lshlrev_b32 v4, 16, v85
    v_add_f32 v54, v4, v54
    v_and_b32 v4, 0xffff0000, v85
    v_add_f32 v55, v4, v55
    v_cvt_pk_bf16_f32 v4, v52, v53
    v_lshlrev_b32 v52, 16, v4
    v_and_b32 v53, 0xffff0000, v4
    v_cvt_pk_bf16_f32 v4, v54, v55
    v_lshlrev_b32 v54, 16, v4
    v_and_b32 v55, 0xffff0000, v4
    v_mul_f32 v100, v52, v52
    v_mul_f32 v101, v53, v53
    v_mul_f32 v102, v54, v54
    v_mul_f32 v103, v55, v55
    v_fma_f32 v100, v100, s62, 1.0
    v_fma_f32 v101, v101, s62, 1.0
    v_fma_f32 v102, v102, s62, 1.0
    v_fma_f32 v103, v103, s62, 1.0
    v_mul_f32 v100, v100, v52
    v_mul_f32 v101, v101, v53
    v_mul_f32 v102, v102, v54
    v_mul_f32 v103, v103, v55
    v_mul_f32 v100, s63, v100
    v_mul_f32 v101, s63, v101
    v_mul_f32 v102, s63, v102
    v_mul_f32 v103, s63, v103
    v_exp_f32 v100, v100
    v_exp_f32 v101, v101
    v_exp_f32 v102, v102
    v_exp_f32 v103, v103
    s_nop 0
    v_add_f32 v100, 1.0, v100
    v_add_f32 v101, 1.0, v101
    v_add_f32 v102, 1.0, v102
    v_add_f32 v103, 1.0, v103
    v_rcp_f32 v100, v100
    v_rcp_f32 v101, v101
    v_rcp_f32 v102, v102
    v_rcp_f32 v103, v103
    s_nop 0
    v_mul_f32 v52, v52, v100
    v_mul_f32 v53, v53, v101
    v_mul_f32 v54, v54, v102
    v_mul_f32 v55, v55, v103
    v_cvt_pk_bf16_f32 v4, v52, v53
    v_cvt_pk_bf16_f32 v5, v54, v55
    s_mov_b32 s39, 114688
    buffer_store_dwordx2 v[4:5], v2, s[12:15], s39 offen offset:0
    v_cvt_pk_bf16_f32 v4, v56, v57
    v_lshlrev_b32 v56, 16, v4
    v_and_b32 v57, 0xffff0000, v4
    v_cvt_pk_bf16_f32 v4, v58, v59
    v_lshlrev_b32 v58, 16, v4
    v_and_b32 v59, 0xffff0000, v4
    v_lshlrev_b32 v4, 16, v86
    v_add_f32 v56, v4, v56
    v_and_b32 v4, 0xffff0000, v86
    v_add_f32 v57, v4, v57
    v_lshlrev_b32 v4, 16, v87
    v_add_f32 v58, v4, v58
    v_and_b32 v4, 0xffff0000, v87
    v_add_f32 v59, v4, v59
    v_cvt_pk_bf16_f32 v4, v56, v57
    v_lshlrev_b32 v56, 16, v4
    v_and_b32 v57, 0xffff0000, v4
    v_cvt_pk_bf16_f32 v4, v58, v59
    v_lshlrev_b32 v58, 16, v4
    v_and_b32 v59, 0xffff0000, v4
    v_mul_f32 v100, v56, v56
    v_mul_f32 v101, v57, v57
    v_mul_f32 v102, v58, v58
    v_mul_f32 v103, v59, v59
    v_fma_f32 v100, v100, s62, 1.0
    v_fma_f32 v101, v101, s62, 1.0
    v_fma_f32 v102, v102, s62, 1.0
    v_fma_f32 v103, v103, s62, 1.0
    v_mul_f32 v100, v100, v56
    v_mul_f32 v101, v101, v57
    v_mul_f32 v102, v102, v58
    v_mul_f32 v103, v103, v59
    v_mul_f32 v100, s63, v100
    v_mul_f32 v101, s63, v101
    v_mul_f32 v102, s63, v102
    v_mul_f32 v103, s63, v103
    v_exp_f32 v100, v100
    v_exp_f32 v101, v101
    v_exp_f32 v102, v102
    v_exp_f32 v103, v103
    s_nop 0
    v_add_f32 v100, 1.0, v100
    v_add_f32 v101, 1.0, v101
    v_add_f32 v102, 1.0, v102
    v_add_f32 v103, 1.0, v103
    v_rcp_f32 v100, v100
    v_rcp_f32 v101, v101
    v_rcp_f32 v102, v102
    v_rcp_f32 v103, v103
    s_nop 0
    v_mul_f32 v56, v56, v100
    v_mul_f32 v57, v57, v101
    v_mul_f32 v58, v58, v102
    v_mul_f32 v59, v59, v103
    v_cvt_pk_bf16_f32 v4, v56, v57
    v_cvt_pk_bf16_f32 v5, v58, v59
    s_mov_b32 s39, 114688
    buffer_store_dwordx2 v[4:5], v2, s[12:15], s39 offen offset:32
    v_cvt_pk_bf16_f32 v4, v60, v61
    v_lshlrev_b32 v60, 16, v4
    v_and_b32 v61, 0xffff0000, v4
    v_cvt_pk_bf16_f32 v4, v62, v63
    v_lshlrev_b32 v62, 16, v4
    v_and_b32 v63, 0xffff0000, v4
    v_lshlrev_b32 v4, 16, v88
    v_add_f32 v60, v4, v60
    v_and_b32 v4, 0xffff0000, v88
    v_add_f32 v61, v4, v61
    v_lshlrev_b32 v4, 16, v89
    v_add_f32 v62, v4, v62
    v_and_b32 v4, 0xffff0000, v89
    v_add_f32 v63, v4, v63
    v_cvt_pk_bf16_f32 v4, v60, v61
    v_lshlrev_b32 v60, 16, v4
    v_and_b32 v61, 0xffff0000, v4
    v_cvt_pk_bf16_f32 v4, v62, v63
    v_lshlrev_b32 v62, 16, v4
    v_and_b32 v63, 0xffff0000, v4
    v_mul_f32 v100, v60, v60
    v_mul_f32 v101, v61, v61
    v_mul_f32 v102, v62, v62
    v_mul_f32 v103, v63, v63
    v_fma_f32 v100, v100, s62, 1.0
    v_fma_f32 v101, v101, s62, 1.0
    v_fma_f32 v102, v102, s62, 1.0
    v_fma_f32 v103, v103, s62, 1.0
    v_mul_f32 v100, v100, v60
    v_mul_f32 v101, v101, v61
    v_mul_f32 v102, v102, v62
    v_mul_f32 v103, v103, v63
    v_mul_f32 v100, s63, v100
    v_mul_f32 v101, s63, v101
    v_mul_f32 v102, s63, v102
    v_mul_f32 v103, s63, v103
    v_exp_f32 v100, v100
    v_exp_f32 v101, v101
    v_exp_f32 v102, v102
    v_exp_f32 v103, v103
    s_nop 0
    v_add_f32 v100, 1.0, v100
    v_add_f32 v101, 1.0, v101
    v_add_f32 v102, 1.0, v102
    v_add_f32 v103, 1.0, v103
    v_rcp_f32 v100, v100
    v_rcp_f32 v101, v101
    v_rcp_f32 v102, v102
    v_rcp_f32 v103, v103
    s_nop 0
    v_mul_f32 v60, v60, v100
    v_mul_f32 v61, v61, v101
    v_mul_f32 v62, v62, v102
    v_mul_f32 v63, v63, v103
    v_cvt_pk_bf16_f32 v4, v60, v61
    v_cvt_pk_bf16_f32 v5, v62, v63
    s_mov_b32 s39, 114688
    buffer_store_dwordx2 v[4:5], v2, s[12:15], s39 offen offset:128
    v_cvt_pk_bf16_f32 v4, v64, v65
    v_lshlrev_b32 v64, 16, v4
    v_and_b32 v65, 0xffff0000, v4
    v_cvt_pk_bf16_f32 v4, v66, v67
    v_lshlrev_b32 v66, 16, v4
    v_and_b32 v67, 0xffff0000, v4
    v_lshlrev_b32 v4, 16, v90
    v_add_f32 v64, v4, v64
    v_and_b32 v4, 0xffff0000, v90
    v_add_f32 v65, v4, v65
    v_lshlrev_b32 v4, 16, v91
    v_add_f32 v66, v4, v66
    v_and_b32 v4, 0xffff0000, v91
    v_add_f32 v67, v4, v67
    v_cvt_pk_bf16_f32 v4, v64, v65
    v_lshlrev_b32 v64, 16, v4
    v_and_b32 v65, 0xffff0000, v4
    v_cvt_pk_bf16_f32 v4, v66, v67
    v_lshlrev_b32 v66, 16, v4
    v_and_b32 v67, 0xffff0000, v4
    v_mul_f32 v100, v64, v64
    v_mul_f32 v101, v65, v65
    v_mul_f32 v102, v66, v66
    v_mul_f32 v103, v67, v67
    v_fma_f32 v100, v100, s62, 1.0
    v_fma_f32 v101, v101, s62, 1.0
    v_fma_f32 v102, v102, s62, 1.0
    v_fma_f32 v103, v103, s62, 1.0
    v_mul_f32 v100, v100, v64
    v_mul_f32 v101, v101, v65
    v_mul_f32 v102, v102, v66
    v_mul_f32 v103, v103, v67
    v_mul_f32 v100, s63, v100
    v_mul_f32 v101, s63, v101
    v_mul_f32 v102, s63, v102
    v_mul_f32 v103, s63, v103
    v_exp_f32 v100, v100
    v_exp_f32 v101, v101
    v_exp_f32 v102, v102
    v_exp_f32 v103, v103
    s_nop 0
    v_add_f32 v100, 1.0, v100
    v_add_f32 v101, 1.0, v101
    v_add_f32 v102, 1.0, v102
    v_add_f32 v103, 1.0, v103
    v_rcp_f32 v100, v100
    v_rcp_f32 v101, v101
    v_rcp_f32 v102, v102
    v_rcp_f32 v103, v103
    s_nop 0
    v_mul_f32 v64, v64, v100
    v_mul_f32 v65, v65, v101
    v_mul_f32 v66, v66, v102
    v_mul_f32 v67, v67, v103
    v_cvt_pk_bf16_f32 v4, v64, v65
    v_cvt_pk_bf16_f32 v5, v66, v67
    s_mov_b32 s39, 114688
    buffer_store_dwordx2 v[4:5], v2, s[12:15], s39 offen offset:160
    v_cvt_pk_bf16_f32 v4, v68, v69
    v_lshlrev_b32 v68, 16, v4
    v_and_b32 v69, 0xffff0000, v4
    v_cvt_pk_bf16_f32 v4, v70, v71
    v_lshlrev_b32 v70, 16, v4
    v_and_b32 v71, 0xffff0000, v4
    v_lshlrev_b32 v4, 16, v92
    v_add_f32 v68, v4, v68
    v_and_b32 v4, 0xffff0000, v92
    v_add_f32 v69, v4, v69
    v_lshlrev_b32 v4, 16, v93
    v_add_f32 v70, v4, v70
    v_and_b32 v4, 0xffff0000, v93
    v_add_f32 v71, v4, v71
    v_cvt_pk_bf16_f32 v4, v68, v69
    v_lshlrev_b32 v68, 16, v4
    v_and_b32 v69, 0xffff0000, v4
    v_cvt_pk_bf16_f32 v4, v70, v71
    v_lshlrev_b32 v70, 16, v4
    v_and_b32 v71, 0xffff0000, v4
    v_mul_f32 v100, v68, v68
    v_mul_f32 v101, v69, v69
    v_mul_f32 v102, v70, v70
    v_mul_f32 v103, v71, v71
    v_fma_f32 v100, v100, s62, 1.0
    v_fma_f32 v101, v101, s62, 1.0
    v_fma_f32 v102, v102, s62, 1.0
    v_fma_f32 v103, v103, s62, 1.0
    v_mul_f32 v100, v100, v68
    v_mul_f32 v101, v101, v69
    v_mul_f32 v102, v102, v70
    v_mul_f32 v103, v103, v71
    v_mul_f32 v100, s63, v100
    v_mul_f32 v101, s63, v101
    v_mul_f32 v102, s63, v102
    v_mul_f32 v103, s63, v103
    v_exp_f32 v100, v100
    v_exp_f32 v101, v101
    v_exp_f32 v102, v102
    v_exp_f32 v103, v103
    s_nop 0
    v_add_f32 v100, 1.0, v100
    v_add_f32 v101, 1.0, v101
    v_add_f32 v102, 1.0, v102
    v_add_f32 v103, 1.0, v103
    v_rcp_f32 v100, v100
    v_rcp_f32 v101, v101
    v_rcp_f32 v102, v102
    v_rcp_f32 v103, v103
    s_nop 0
    v_mul_f32 v68, v68, v100
    v_mul_f32 v69, v69, v101
    v_mul_f32 v70, v70, v102
    v_mul_f32 v71, v71, v103
    v_cvt_pk_bf16_f32 v4, v68, v69
    v_cvt_pk_bf16_f32 v5, v70, v71
    s_mov_b32 s39, 114688
    buffer_store_dwordx2 v[4:5], v2, s[12:15], s39 offen offset:256
    v_cvt_pk_bf16_f32 v4, v72, v73
    v_lshlrev_b32 v72, 16, v4
    v_and_b32 v73, 0xffff0000, v4
    v_cvt_pk_bf16_f32 v4, v74, v75
    v_lshlrev_b32 v74, 16, v4
    v_and_b32 v75, 0xffff0000, v4
    v_lshlrev_b32 v4, 16, v94
    v_add_f32 v72, v4, v72
    v_and_b32 v4, 0xffff0000, v94
    v_add_f32 v73, v4, v73
    v_lshlrev_b32 v4, 16, v95
    v_add_f32 v74, v4, v74
    v_and_b32 v4, 0xffff0000, v95
    v_add_f32 v75, v4, v75
    v_cvt_pk_bf16_f32 v4, v72, v73
    v_lshlrev_b32 v72, 16, v4
    v_and_b32 v73, 0xffff0000, v4
    v_cvt_pk_bf16_f32 v4, v74, v75
    v_lshlrev_b32 v74, 16, v4
    v_and_b32 v75, 0xffff0000, v4
    v_mul_f32 v100, v72, v72
    v_mul_f32 v101, v73, v73
    v_mul_f32 v102, v74, v74
    v_mul_f32 v103, v75, v75
    v_fma_f32 v100, v100, s62, 1.0
    v_fma_f32 v101, v101, s62, 1.0
    v_fma_f32 v102, v102, s62, 1.0
    v_fma_f32 v103, v103, s62, 1.0
    v_mul_f32 v100, v100, v72
    v_mul_f32 v101, v101, v73
    v_mul_f32 v102, v102, v74
    v_mul_f32 v103, v103, v75
    v_mul_f32 v100, s63, v100
    v_mul_f32 v101, s63, v101
    v_mul_f32 v102, s63, v102
    v_mul_f32 v103, s63, v103
    v_exp_f32 v100, v100
    v_exp_f32 v101, v101
    v_exp_f32 v102, v102
    v_exp_f32 v103, v103
    s_nop 0
    v_add_f32 v100, 1.0, v100
    v_add_f32 v101, 1.0, v101
    v_add_f32 v102, 1.0, v102
    v_add_f32 v103, 1.0, v103
    v_rcp_f32 v100, v100
    v_rcp_f32 v101, v101
    v_rcp_f32 v102, v102
    v_rcp_f32 v103, v103
    s_nop 0
    v_mul_f32 v72, v72, v100
    v_mul_f32 v73, v73, v101
    v_mul_f32 v74, v74, v102
    v_mul_f32 v75, v75, v103
    v_cvt_pk_bf16_f32 v4, v72, v73
    v_cvt_pk_bf16_f32 v5, v74, v75
    s_mov_b32 s39, 114688
    buffer_store_dwordx2 v[4:5], v2, s[12:15], s39 offen offset:288
    v_cvt_pk_bf16_f32 v4, v76, v77
    v_lshlrev_b32 v76, 16, v4
    v_and_b32 v77, 0xffff0000, v4
    v_cvt_pk_bf16_f32 v4, v78, v79
    v_lshlrev_b32 v78, 16, v4
    v_and_b32 v79, 0xffff0000, v4
    v_lshlrev_b32 v4, 16, v96
    v_add_f32 v76, v4, v76
    v_and_b32 v4, 0xffff0000, v96
    v_add_f32 v77, v4, v77
    v_lshlrev_b32 v4, 16, v97
    v_add_f32 v78, v4, v78
    v_and_b32 v4, 0xffff0000, v97
    v_add_f32 v79, v4, v79
    v_cvt_pk_bf16_f32 v4, v76, v77
    v_lshlrev_b32 v76, 16, v4
    v_and_b32 v77, 0xffff0000, v4
    v_cvt_pk_bf16_f32 v4, v78, v79
    v_lshlrev_b32 v78, 16, v4
    v_and_b32 v79, 0xffff0000, v4
    v_mul_f32 v100, v76, v76
    v_mul_f32 v101, v77, v77
    v_mul_f32 v102, v78, v78
    v_mul_f32 v103, v79, v79
    v_fma_f32 v100, v100, s62, 1.0
    v_fma_f32 v101, v101, s62, 1.0
    v_fma_f32 v102, v102, s62, 1.0
    v_fma_f32 v103, v103, s62, 1.0
    v_mul_f32 v100, v100, v76
    v_mul_f32 v101, v101, v77
    v_mul_f32 v102, v102, v78
    v_mul_f32 v103, v103, v79
    v_mul_f32 v100, s63, v100
    v_mul_f32 v101, s63, v101
    v_mul_f32 v102, s63, v102
    v_mul_f32 v103, s63, v103
    v_exp_f32 v100, v100
    v_exp_f32 v101, v101
    v_exp_f32 v102, v102
    v_exp_f32 v103, v103
    s_nop 0
    v_add_f32 v100, 1.0, v100
    v_add_f32 v101, 1.0, v101
    v_add_f32 v102, 1.0, v102
    v_add_f32 v103, 1.0, v103
    v_rcp_f32 v100, v100
    v_rcp_f32 v101, v101
    v_rcp_f32 v102, v102
    v_rcp_f32 v103, v103
    s_nop 0
    v_mul_f32 v76, v76, v100
    v_mul_f32 v77, v77, v101
    v_mul_f32 v78, v78, v102
    v_mul_f32 v79, v79, v103
    v_cvt_pk_bf16_f32 v4, v76, v77
    v_cvt_pk_bf16_f32 v5, v78, v79
    s_mov_b32 s39, 114688
    buffer_store_dwordx2 v[4:5], v2, s[12:15], s39 offen offset:384
    v_cvt_pk_bf16_f32 v4, v80, v81
    v_lshlrev_b32 v80, 16, v4
    v_and_b32 v81, 0xffff0000, v4
    v_cvt_pk_bf16_f32 v4, v82, v83
    v_lshlrev_b32 v82, 16, v4
    v_and_b32 v83, 0xffff0000, v4
    v_lshlrev_b32 v4, 16, v98
    v_add_f32 v80, v4, v80
    v_and_b32 v4, 0xffff0000, v98
    v_add_f32 v81, v4, v81
    v_lshlrev_b32 v4, 16, v99
    v_add_f32 v82, v4, v82
    v_and_b32 v4, 0xffff0000, v99
    v_add_f32 v83, v4, v83
    v_cvt_pk_bf16_f32 v4, v80, v81
    v_lshlrev_b32 v80, 16, v4
    v_and_b32 v81, 0xffff0000, v4
    v_cvt_pk_bf16_f32 v4, v82, v83
    v_lshlrev_b32 v82, 16, v4
    v_and_b32 v83, 0xffff0000, v4
    v_mul_f32 v100, v80, v80
    v_mul_f32 v101, v81, v81
    v_mul_f32 v102, v82, v82
    v_mul_f32 v103, v83, v83
    v_fma_f32 v100, v100, s62, 1.0
    v_fma_f32 v101, v101, s62, 1.0
    v_fma_f32 v102, v102, s62, 1.0
    v_fma_f32 v103, v103, s62, 1.0
    v_mul_f32 v100, v100, v80
    v_mul_f32 v101, v101, v81
    v_mul_f32 v102, v102, v82
    v_mul_f32 v103, v103, v83
    v_mul_f32 v100, s63, v100
    v_mul_f32 v101, s63, v101
    v_mul_f32 v102, s63, v102
    v_mul_f32 v103, s63, v103
    v_exp_f32 v100, v100
    v_exp_f32 v101, v101
    v_exp_f32 v102, v102
    v_exp_f32 v103, v103
    s_nop 0
    v_add_f32 v100, 1.0, v100
    v_add_f32 v101, 1.0, v101
    v_add_f32 v102, 1.0, v102
    v_add_f32 v103, 1.0, v103
    v_rcp_f32 v100, v100
    v_rcp_f32 v101, v101
    v_rcp_f32 v102, v102
    v_rcp_f32 v103, v103
    s_nop 0
    v_mul_f32 v80, v80, v100
    v_mul_f32 v81, v81, v101
    v_mul_f32 v82, v82, v102
    v_mul_f32 v83, v83, v103
    v_cvt_pk_bf16_f32 v4, v80, v81
    v_cvt_pk_bf16_f32 v5, v82, v83
    s_mov_b32 s39, 114688
    buffer_store_dwordx2 v[4:5], v2, s[12:15], s39 offen offset:416
    s_waitcnt vmcnt(0)
    s_waitcnt vmcnt(0)
L_end_mlp1_0_kernel:
    s_endpgm
.globl mlp2_0_kernel
.p2align 8
.type mlp2_0_kernel,@function
mlp2_0_kernel:
    s_cmp_ge_u32 s2, 256
    s_cbranch_scc1 L_end_mlp2_0_kernel
    s_load_dwordx2 s[40:41], s[0:1], 80
    s_load_dwordx2 s[42:43], s[0:1], 48
    s_load_dwordx2 s[50:51], s[0:1], 80
    s_load_dwordx2 s[52:53], s[0:1], 64
    s_load_dwordx2 s[56:57], s[0:1], 56
    v_and_b32 v1, 63, v0
    v_lshrrev_b32 v2, 6, v0
    s_and_b32 s24, s2, 15
    v_readfirstlane_b32 s26, v2
    s_lshr_b32 s25, s2, 4
    s_nop 1
    s_lshr_b32 s27, s26, 2
    s_and_b32 s28, s26, 1
    s_bfe_u32 s29, s26, 0x10001
    v_lshrrev_b32 v2, 3, v1
    v_and_b32 v3, 7, v1
    v_xor_b32 v3, v3, v2
    s_lshl_b32 s38, s26, 4
    s_lshl_b32 s39, s24, 7
    s_add_u32 s38, s38, s39
    v_add_u32 v4, s38, v2
    s_mov_b32 s38, 7168
    v_mul_lo_u32 v4, v4, s38
    v_lshlrev_b32 v3, 4, v3
    v_add_u32 v10, v4, v3
    v_add_u32 v11, 57344, v10
    v_lshrrev_b32 v2, 3, v1
    s_lshl_b32 s38, s26, 3
    v_add_u32 v2, s38, v2
    s_mov_b32 s38, 2048
    v_mul_lo_u32 v2, v2, s38
    v_bfe_u32 v3, v1, 1, 2
    v_bfe_u32 v4, v1, 4, 1
    s_and_b32 s38, s26, 1
    s_lshl_b32 s38, s38, 1
    v_or_b32 v4, s38, v4
    v_xor_b32 v3, v3, v4
    v_lshlrev_b32 v3, 5, v3
    v_and_b32 v4, 1, v1
    v_lshlrev_b32 v4, 4, v4
    v_add3_u32 v12, v2, v3, v4
    v_and_b32 v2, 15, v1
    s_lshl_b32 s38, s28, 6
    v_add_u32 v2, s38, v2
    v_lshlrev_b32 v2, 7, v2
    v_lshrrev_b32 v3, 4, v1
    s_lshl_b32 s38, s27, 2
    v_add_u32 v3, s38, v3
    v_and_b32 v4, 7, v1
    v_xor_b32 v3, v3, v4
    v_lshlrev_b32 v3, 4, v3
    v_add_u32 v13, v2, v3
    v_lshrrev_b32 v2, 4, v1
    v_lshlrev_b32 v2, 3, v2
    v_bfe_u32 v3, v1, 2, 2
    v_add_u32 v2, v2, v3
    v_lshlrev_b32 v2, 7, v2
    v_and_b32 v3, 3, v1
    v_lshlrev_b32 v3, 3, v3
    v_add_u32 v2, v2, v3
    s_lshl_b32 s38, s27, 12
    s_add_u32 s38, s38, 16384
    v_add_u32 v2, s38, v2
    v_bfe_u32 v3, v1, 3, 1
    v_bfe_u32 v4, v1, 4, 1
    v_lshlrev_b32 v4, 1, v4
    v_or_b32 v3, v3, v4
    s_lshl_b32 s38, s29, 1
    v_xor_b32 v4, s38, v3
    v_lshlrev_b32 v4, 5, v4
    v_add_u32 v14, v2, v4
    v_xor_b32 v4, 32, v4
    v_add_u32 v15, v2, v4
    s_waitcnt lgkmcnt(0)
    s_add_u32 s4, s40, 25165824
    s_addc_u32 s5, s41, 0
    s_mov_b32 s6, 14680064
    s_mov_b32 s7, 0x00020000
    s_mov_b32 s8, s42
    s_mov_b32 s9, s43
    s_mov_b32 s10, 7340032
    s_mov_b32 s11, 0x00020000
    s_mov_b32 s31, 0
    s_mul_i32 s32, s25, 128
    s_mov_b32 s36, 0
    s_lshl_b32 s44, s26, 11
    s_add_u32 s45, s44, 1024
    s_lshl_b32 s46, s26, 10
    s_add_u32 s46, s46, 16384
    s_add_u32 m0, s36, s44
    s_nop 0
    buffer_load_dwordx4 v10, s[4:7], s31 offen lds
    s_add_u32 m0, s36, s45
    s_nop 0
    buffer_load_dwordx4 v11, s[4:7], s31 offen lds
    s_add_u32 m0, s36, s46
    s_nop 0
    buffer_load_dwordx4 v12, s[8:11], s32 offen lds
    s_add_u32 s31, s31, 128
    s_add_u32 s32, s32, 131072
    s_add_u32 s36, s36, 24576
    s_cmp_ge_u32 s36, 147456
    s_cselect_b32 s36, 0, s36
    v_mov_b32 v68, 0
    v_mov_b32 v69, 0
    v_mov_b32 v70, 0
    v_mov_b32 v71, 0
    v_mov_b32 v72, 0
    v_mov_b32 v73, 0
    v_mov_b32 v74, 0
    v_mov_b32 v75, 0
    v_mov_b32 v76, 0
    v_mov_b32 v77, 0
    v_mov_b32 v78, 0
    v_mov_b32 v79, 0
    v_mov_b32 v80, 0
    v_mov_b32 v81, 0
    v_mov_b32 v82, 0
    v_mov_b32 v83, 0
    v_mov_b32 v84, 0
    v_mov_b32 v85, 0
    v_mov_b32 v86, 0
    v_mov_b32 v87, 0
    v_mov_b32 v88, 0
    v_mov_b32 v89, 0
    v_mov_b32 v90, 0
    v_mov_b32 v91, 0
    v_mov_b32 v92, 0
    v_mov_b32 v93, 0
    v_mov_b32 v94, 0
    v_mov_b32 v95, 0
    v_mov_b32 v96, 0
    v_mov_b32 v97, 0
    v_mov_b32 v98, 0
    v_mov_b32 v99, 0
    s_add_u32 m0, s36, s44
    s_nop 0
    buffer_load_dwordx4 v10, s[4:7], s31 offen lds
    s_add_u32 m0, s36, s45
    s_nop 0
    buffer_load_dwordx4 v11, s[4:7], s31 offen lds
    s_add_u32 m0, s36, s46
    s_nop 0
    buffer_load_dwordx4 v12, s[8:11], s32 offen lds
    s_add_u32 s31, s31, 128
    s_add_u32 s32, s32, 131072
    s_add_u32 s36, s36, 24576
    s_cmp_ge_u32 s36, 147456
    s_cselect_b32 s36, 0, s36
    s_add_u32 m0, s36, s44
    s_nop 0
    buffer_load_dwordx4 v10, s[4:7], s31 offen lds
    s_add_u32 m0, s36, s45
    s_nop 0
    buffer_load_dwordx4 v11, s[4:7], s31 offen lds
    s_add_u32 m0, s36, s46
    s_nop 0
    buffer_load_dwordx4 v12, s[8:11], s32 offen lds
    s_add_u32 s31, s31, 128
    s_add_u32 s32, s32, 131072
    s_add_u32 s36, s36, 24576
    s_cmp_ge_u32 s36, 147456
    s_cselect_b32 s36, 0, s36
    s_add_u32 m0, s36, s44
    s_nop 0
    buffer_load_dwordx4 v10, s[4:7], s31 offen lds
    s_add_u32 m0, s36, s45
    s_nop 0
    buffer_load_dwordx4 v11, s[4:7], s31 offen lds
    s_add_u32 m0, s36, s46
    s_nop 0
    buffer_load_dwordx4 v12, s[8:11], s32 offen lds
    s_add_u32 s31, s31, 128
    s_add_u32 s32, s32, 131072
    s_add_u32 s36, s36, 24576
    s_cmp_ge_u32 s36, 147456
    s_cselect_b32 s36, 0, s36
    s_add_u32 m0, s36, s44
    s_nop 0
    buffer_load_dwordx4 v10, s[4:7], s31 offen lds
    s_add_u32 m0, s36, s45
    s_nop 0
    buffer_load_dwordx4 v11, s[4:7], s31 offen lds
    s_add_u32 m0, s36, s46
    s_nop 0
    buffer_load_dwordx4 v12, s[8:11], s32 offen lds
    s_add_u32 s31, s31, 128
    s_add_u32 s32, s32, 131072
    s_add_u32 s36, s36, 24576
    s_cmp_ge_u32 s36, 147456
    s_cselect_b32 s36, 0, s36
    s_add_u32 m0, s36, s44
    s_nop 0
    buffer_load_dwordx4 v10, s[4:7], s31 offen lds
    s_add_u32 m0, s36, s45
    s_nop 0
    buffer_load_dwordx4 v11, s[4:7], s31 offen lds
    s_add_u32 m0, s36, s46
    s_nop 0
    buffer_load_dwordx4 v12, s[8:11], s32 offen lds
    s_add_u32 s31, s31, 128
    s_add_u32 s32, s32, 131072
    s_add_u32 s36, s36, 24576
    s_cmp_ge_u32 s36, 147456
    s_cselect_b32 s36, 0, s36
    s_mov_b32 s37, 0
    s_waitcnt vmcnt(15)
    s_barrier
    v_add_u32 v16, s37, v13
    v_add_u32 v17, s37, v14
    v_add_u32 v18, s37, v15
    s_add_u32 s37, s37, 24576
    s_cmp_ge_u32 s37, 147456
    s_cselect_b32 s37, 0, s37
    ds_read_b128 v[20:23], v16 offset:0
    ds_read_b128 v[24:27], v16 offset:2048
    ds_read_b128 v[28:31], v16 offset:4096
    ds_read_b128 v[32:35], v16 offset:6144
    ds_read_b64_tr_b16 v[52:53], v17 offset:0
    ds_read_b64_tr_b16 v[54:55], v17 offset:512
    ds_read_b64_tr_b16 v[56:57], v18 offset:0
    ds_read_b64_tr_b16 v[58:59], v18 offset:512
    s_mov_b32 s30, 25
L_loop_mlp2_0_kernel:
    s_waitcnt lgkmcnt(0)
    v_mfma_f32_16x16x32_bf16 v[68:71], v[52:55], v[20:23], v[68:71]
    v_mfma_f32_16x16x32_bf16 v[72:75], v[56:59], v[20:23], v[72:75]
    v_mfma_f32_16x16x32_bf16 v[76:79], v[52:55], v[24:27], v[76:79]
    v_mfma_f32_16x16x32_bf16 v[80:83], v[56:59], v[24:27], v[80:83]
    s_waitcnt vmcnt(12)
    s_barrier
    v_add_u32 v16, s37, v13
    v_add_u32 v17, s37, v14
    v_add_u32 v18, s37, v15
    s_add_u32 s37, s37, 24576
    s_cmp_ge_u32 s37, 147456
    s_cselect_b32 s37, 0, s37
    ds_read_b128 v[36:39], v16 offset:0
    ds_read_b128 v[40:43], v16 offset:2048
    ds_read_b128 v[44:47], v16 offset:4096
    ds_read_b128 v[48:51], v16 offset:6144
    ds_read_b64_tr_b16 v[60:61], v17 offset:0
    ds_read_b64_tr_b16 v[62:63], v17 offset:512
    ds_read_b64_tr_b16 v[64:65], v18 offset:0
    ds_read_b64_tr_b16 v[66:67], v18 offset:512
    s_add_u32 m0, s36, s44
    v_mfma_f32_16x16x32_bf16 v[84:87], v[52:55], v[28:31], v[84:87]
    buffer_load_dwordx4 v10, s[4:7], s31 offen lds
    s_add_u32 m0, s36, s45
    v_mfma_f32_16x16x32_bf16 v[88:91], v[56:59], v[28:31], v[88:91]
    buffer_load_dwordx4 v11, s[4:7], s31 offen lds
    s_add_u32 m0, s36, s46
    v_mfma_f32_16x16x32_bf16 v[92:95], v[52:55], v[32:35], v[92:95]
    buffer_load_dwordx4 v12, s[8:11], s32 offen lds
    v_mfma_f32_16x16x32_bf16 v[96:99], v[56:59], v[32:35], v[96:99]
    s_add_u32 s31, s31, 128
    s_add_u32 s32, s32, 131072
    s_add_u32 s36, s36, 24576
    s_cmp_ge_u32 s36, 147456
    s_cselect_b32 s36, 0, s36
    s_waitcnt lgkmcnt(0)
    v_mfma_f32_16x16x32_bf16 v[68:71], v[60:63], v[36:39], v[68:71]
    v_mfma_f32_16x16x32_bf16 v[72:75], v[64:67], v[36:39], v[72:75]
    v_mfma_f32_16x16x32_bf16 v[76:79], v[60:63], v[40:43], v[76:79]
    v_mfma_f32_16x16x32_bf16 v[80:83], v[64:67], v[40:43], v[80:83]
    s_waitcnt vmcnt(12)
    s_barrier
    v_add_u32 v16, s37, v13
    v_add_u32 v17, s37, v14
    v_add_u32 v18, s37, v15
    s_add_u32 s37, s37, 24576
    s_cmp_ge_u32 s37, 147456
    s_cselect_b32 s37, 0, s37
    ds_read_b128 v[20:23], v16 offset:0
    ds_read_b128 v[24:27], v16 offset:2048
    ds_read_b128 v[28:31], v16 offset:4096
    ds_read_b128 v[32:35], v16 offset:6144
    ds_read_b64_tr_b16 v[52:53], v17 offset:0
    ds_read_b64_tr_b16 v[54:55], v17 offset:512
    ds_read_b64_tr_b16 v[56:57], v18 offset:0
    ds_read_b64_tr_b16 v[58:59], v18 offset:512
    s_add_u32 m0, s36, s44
    v_mfma_f32_16x16x32_bf16 v[84:87], v[60:63], v[44:47], v[84:87]
    buffer_load_dwordx4 v10, s[4:7], s31 offen lds
    s_add_u32 m0, s36, s45
    v_mfma_f32_16x16x32_bf16 v[88:91], v[64:67], v[44:47], v[88:91]
    buffer_load_dwordx4 v11, s[4:7], s31 offen lds
    s_add_u32 m0, s36, s46
    v_mfma_f32_16x16x32_bf16 v[92:95], v[60:63], v[48:51], v[92:95]
    buffer_load_dwordx4 v12, s[8:11], s32 offen lds
    v_mfma_f32_16x16x32_bf16 v[96:99], v[64:67], v[48:51], v[96:99]
    s_add_u32 s31, s31, 128
    s_add_u32 s32, s32, 131072
    s_add_u32 s36, s36, 24576
    s_cmp_ge_u32 s36, 147456
    s_cselect_b32 s36, 0, s36
    s_sub_u32 s30, s30, 1
    s_cmp_lg_u32 s30, 0
    s_cbranch_scc1 L_loop_mlp2_0_kernel
    s_waitcnt lgkmcnt(0)
    v_mfma_f32_16x16x32_bf16 v[68:71], v[52:55], v[20:23], v[68:71]
    v_mfma_f32_16x16x32_bf16 v[72:75], v[56:59], v[20:23], v[72:75]
    v_mfma_f32_16x16x32_bf16 v[76:79], v[52:55], v[24:27], v[76:79]
    v_mfma_f32_16x16x32_bf16 v[80:83], v[56:59], v[24:27], v[80:83]
    s_waitcnt vmcnt(12)
    s_barrier
    v_add_u32 v16, s37, v13
    v_add_u32 v17, s37, v14
    v_add_u32 v18, s37, v15
    s_add_u32 s37, s37, 24576
    s_cmp_ge_u32 s37, 147456
    s_cselect_b32 s37, 0, s37
    ds_read_b128 v[36:39], v16 offset:0
    ds_read_b128 v[40:43], v16 offset:2048
    ds_read_b128 v[44:47], v16 offset:4096
    ds_read_b128 v[48:51], v16 offset:6144
    ds_read_b64_tr_b16 v[60:61], v17 offset:0
    ds_read_b64_tr_b16 v[62:63], v17 offset:512
    ds_read_b64_tr_b16 v[64:65], v18 offset:0
    ds_read_b64_tr_b16 v[66:67], v18 offset:512
    v_mfma_f32_16x16x32_bf16 v[84:87], v[52:55], v[28:31], v[84:87]
    v_mfma_f32_16x16x32_bf16 v[88:91], v[56:59], v[28:31], v[88:91]
    v_mfma_f32_16x16x32_bf16 v[92:95], v[52:55], v[32:35], v[92:95]
    v_mfma_f32_16x16x32_bf16 v[96:99], v[56:59], v[32:35], v[96:99]
    s_waitcnt lgkmcnt(0)
    v_mfma_f32_16x16x32_bf16 v[68:71], v[60:63], v[36:39], v[68:71]
    v_mfma_f32_16x16x32_bf16 v[72:75], v[64:67], v[36:39], v[72:75]
    v_mfma_f32_16x16x32_bf16 v[76:79], v[60:63], v[40:43], v[76:79]
    v_mfma_f32_16x16x32_bf16 v[80:83], v[64:67], v[40:43], v[80:83]
    s_waitcnt vmcnt(9)
    s_barrier
    v_add_u32 v16, s37, v13
    v_add_u32 v17, s37, v14
    v_add_u32 v18, s37, v15
    s_add_u32 s37, s37, 24576
    s_cmp_ge_u32 s37, 147456
    s_cselect_b32 s37, 0, s37
    ds_read_b128 v[20:23], v16 offset:0
    ds_read_b128 v[24:27], v16 offset:2048
    ds_read_b128 v[28:31], v16 offset:4096
    ds_read_b128 v[32:35], v16 offset:6144
    ds_read_b64_tr_b16 v[52:53], v17 offset:0
    ds_read_b64_tr_b16 v[54:55], v17 offset:512
    ds_read_b64_tr_b16 v[56:57], v18 offset:0
    ds_read_b64_tr_b16 v[58:59], v18 offset:512
    v_mfma_f32_16x16x32_bf16 v[84:87], v[60:63], v[44:47], v[84:87]
    v_mfma_f32_16x16x32_bf16 v[88:91], v[64:67], v[44:47], v[88:91]
    v_mfma_f32_16x16x32_bf16 v[92:95], v[60:63], v[48:51], v[92:95]
    v_mfma_f32_16x16x32_bf16 v[96:99], v[64:67], v[48:51], v[96:99]
    s_waitcnt lgkmcnt(0)
    v_mfma_f32_16x16x32_bf16 v[68:71], v[52:55], v[20:23], v[68:71]
    v_mfma_f32_16x16x32_bf16 v[72:75], v[56:59], v[20:23], v[72:75]
    v_mfma_f32_16x16x32_bf16 v[76:79], v[52:55], v[24:27], v[76:79]
    v_mfma_f32_16x16x32_bf16 v[80:83], v[56:59], v[24:27], v[80:83]
    s_waitcnt vmcnt(6)
    s_barrier
    v_add_u32 v16, s37, v13
    v_add_u32 v17, s37, v14
    v_add_u32 v18, s37, v15
    s_add_u32 s37, s37, 24576
    s_cmp_ge_u32 s37, 147456
    s_cselect_b32 s37, 0, s37
    ds_read_b128 v[36:39], v16 offset:0
    ds_read_b128 v[40:43], v16 offset:2048
    ds_read_b128 v[44:47], v16 offset:4096
    ds_read_b128 v[48:51], v16 offset:6144
    ds_read_b64_tr_b16 v[60:61], v17 offset:0
    ds_read_b64_tr_b16 v[62:63], v17 offset:512
    ds_read_b64_tr_b16 v[64:65], v18 offset:0
    ds_read_b64_tr_b16 v[66:67], v18 offset:512
    v_mfma_f32_16x16x32_bf16 v[84:87], v[52:55], v[28:31], v[84:87]
    v_mfma_f32_16x16x32_bf16 v[88:91], v[56:59], v[28:31], v[88:91]
    v_mfma_f32_16x16x32_bf16 v[92:95], v[52:55], v[32:35], v[92:95]
    v_mfma_f32_16x16x32_bf16 v[96:99], v[56:59], v[32:35], v[96:99]
    s_waitcnt lgkmcnt(0)
    v_mfma_f32_16x16x32_bf16 v[68:71], v[60:63], v[36:39], v[68:71]
    v_mfma_f32_16x16x32_bf16 v[72:75], v[64:67], v[36:39], v[72:75]
    v_mfma_f32_16x16x32_bf16 v[76:79], v[60:63], v[40:43], v[76:79]
    v_mfma_f32_16x16x32_bf16 v[80:83], v[64:67], v[40:43], v[80:83]
    s_waitcnt vmcnt(3)
    s_barrier
    v_add_u32 v16, s37, v13
    v_add_u32 v17, s37, v14
    v_add_u32 v18, s37, v15
    s_add_u32 s37, s37, 24576
    s_cmp_ge_u32 s37, 147456
    s_cselect_b32 s37, 0, s37
    ds_read_b128 v[20:23], v16 offset:0
    ds_read_b128 v[24:27], v16 offset:2048
    ds_read_b128 v[28:31], v16 offset:4096
    ds_read_b128 v[32:35], v16 offset:6144
    ds_read_b64_tr_b16 v[52:53], v17 offset:0
    ds_read_b64_tr_b16 v[54:55], v17 offset:512
    ds_read_b64_tr_b16 v[56:57], v18 offset:0
    ds_read_b64_tr_b16 v[58:59], v18 offset:512
    v_mfma_f32_16x16x32_bf16 v[84:87], v[60:63], v[44:47], v[84:87]
    v_mfma_f32_16x16x32_bf16 v[88:91], v[64:67], v[44:47], v[88:91]
    v_mfma_f32_16x16x32_bf16 v[92:95], v[60:63], v[48:51], v[92:95]
    v_mfma_f32_16x16x32_bf16 v[96:99], v[64:67], v[48:51], v[96:99]
    s_waitcnt lgkmcnt(0)
    v_mfma_f32_16x16x32_bf16 v[68:71], v[52:55], v[20:23], v[68:71]
    v_mfma_f32_16x16x32_bf16 v[72:75], v[56:59], v[20:23], v[72:75]
    v_mfma_f32_16x16x32_bf16 v[76:79], v[52:55], v[24:27], v[76:79]
    v_mfma_f32_16x16x32_bf16 v[80:83], v[56:59], v[24:27], v[80:83]
    s_waitcnt vmcnt(0)
    s_barrier
    v_add_u32 v16, s37, v13
    v_add_u32 v17, s37, v14
    v_add_u32 v18, s37, v15
    s_add_u32 s37, s37, 24576
    s_cmp_ge_u32 s37, 147456
    s_cselect_b32 s37, 0, s37
    ds_read_b128 v[36:39], v16 offset:0
    ds_read_b128 v[40:43], v16 offset:2048
    ds_read_b128 v[44:47], v16 offset:4096
    ds_read_b128 v[48:51], v16 offset:6144
    ds_read_b64_tr_b16 v[60:61], v17 offset:0
    ds_read_b64_tr_b16 v[62:63], v17 offset:512
    ds_read_b64_tr_b16 v[64:65], v18 offset:0
    ds_read_b64_tr_b16 v[66:67], v18 offset:512
    v_mfma_f32_16x16x32_bf16 v[84:87], v[52:55], v[28:31], v[84:87]
    v_mfma_f32_16x16x32_bf16 v[88:91], v[56:59], v[28:31], v[88:91]
    v_mfma_f32_16x16x32_bf16 v[92:95], v[52:55], v[32:35], v[92:95]
    v_mfma_f32_16x16x32_bf16 v[96:99], v[56:59], v[32:35], v[96:99]
    s_waitcnt lgkmcnt(0)
    v_mfma_f32_16x16x32_bf16 v[68:71], v[60:63], v[36:39], v[68:71]
    v_mfma_f32_16x16x32_bf16 v[72:75], v[64:67], v[36:39], v[72:75]
    v_mfma_f32_16x16x32_bf16 v[76:79], v[60:63], v[40:43], v[76:79]
    v_mfma_f32_16x16x32_bf16 v[80:83], v[64:67], v[40:43], v[80:83]
    v_mfma_f32_16x16x32_bf16 v[84:87], v[60:63], v[44:47], v[84:87]
    v_mfma_f32_16x16x32_bf16 v[88:91], v[64:67], v[44:47], v[88:91]
    v_mfma_f32_16x16x32_bf16 v[92:95], v[60:63], v[48:51], v[92:95]
    v_mfma_f32_16x16x32_bf16 v[96:99], v[64:67], v[48:51], v[96:99]
    s_waitcnt vmcnt(0) lgkmcnt(0)
    s_barrier
    s_xor_b32 s38, s26, 4
    s_mul_i32 s38, s38, 4096
    v_lshlrev_b32 v2, 4, v1
    v_add_u32 v2, s38, v2
    s_nop 7
    s_cmp_eq_u32 s27, 0
    s_cbranch_scc0 L_give1_mlp2_0_kernel
    ds_write_b128 v2, v[84:87] offset:0
    ds_write_b128 v2, v[88:91] offset:1024
    ds_write_b128 v2, v[92:95] offset:2048
    ds_write_b128 v2, v[96:99] offset:3072
    s_branch L_give_done_mlp2_0_kernel
L_give1_mlp2_0_kernel:
    ds_write_b128 v2, v[68:71] offset:0
    ds_write_b128 v2, v[72:75] offset:1024
    ds_write_b128 v2, v[76:79] offset:2048
    ds_write_b128 v2, v[80:83] offset:3072
L_give_done_mlp2_0_kernel:
    s_waitcnt lgkmcnt(0)
    s_barrier
    s_mul_i32 s38, s26, 4096
    v_lshlrev_b32 v2, 4, v1
    v_add_u32 v2, s38, v2
    s_mul_i32 s38, s27, 16
    s_cmp_eq_u32 s27, 0
    s_cbranch_scc0 L_keep1_mlp2_0_kernel
    ds_read_b128 v[20:23], v2 offset:0
    ds_read_b128 v[24:27], v2 offset:1024
    ds_read_b128 v[28:31], v2 offset:2048
    ds_read_b128 v[32:35], v2 offset:3072
    s_waitcnt lgkmcnt(0)
    v_add_f32 v20, v68, v20
    v_add_f32 v21, v69, v21
    v_add_f32 v22, v70, v22
    v_add_f32 v23, v71, v23
    v_add_f32 v24, v72, v24
    v_add_f32 v25, v73, v25
    v_add_f32 v26, v74, v26
    v_add_f32 v27, v75, v27
    v_add_f32 v28, v76, v28
    v_add_f32 v29, v77, v29
    v_add_f32 v30, v78, v30
    v_add_f32 v31, v79, v31
    v_add_f32 v32, v80, v32
    v_add_f32 v33, v81, v33
    v_add_f32 v34, v82, v34
    v_add_f32 v35, v83, v35
    s_branch L_keep_done_mlp2_0_kernel
L_keep1_mlp2_0_kernel:
    ds_read_b128 v[20:23], v2 offset:0
    ds_read_b128 v[24:27], v2 offset:1024
    ds_read_b128 v[28:31], v2 offset:2048
    ds_read_b128 v[32:35], v2 offset:3072
    s_waitcnt lgkmcnt(0)
    v_add_f32 v20, v84, v20
    v_add_f32 v21, v85, v21
    v_add_f32 v22, v86, v22
    v_add_f32 v23, v87, v23
    v_add_f32 v24, v88, v24
    v_add_f32 v25, v89, v25
    v_add_f32 v26, v90, v26
    v_add_f32 v27, v91, v27
    v_add_f32 v28, v92, v28
    v_add_f32 v29, v93, v29
    v_add_f32 v30, v94, v30
    v_add_f32 v31, v95, v31
    v_add_f32 v32, v96, v32
    v_add_f32 v33, v97, v33
    v_add_f32 v34, v98, v34
    v_add_f32 v35, v99, v35
L_keep_done_mlp2_0_kernel:
    s_add_u32 s12, s50, 16777216
    s_addc_u32 s13, s51, 0
    s_mov_b32 s14, 4194304
    s_mov_b32 s15, 0x00020000
    s_add_u32 s16, s50, 12582912
    s_addc_u32 s17, s51, 0
    s_mov_b32 s18, 4194304
    s_mov_b32 s19, 0x00020000
    v_and_b32 v2, 15, v1
    s_lshl_b32 s38, s24, 7
    s_lshl_b32 s39, s28, 6
    s_add_u32 s38, s38, s39
    s_lshl_b32 s39, s27, 5
    s_add_u32 s38, s38, s39
    v_add_u32 v2, s38, v2
    s_mov_b32 s38, 2048
    v_mul_lo_u32 v2, v2, s38
    v_lshrrev_b32 v3, 4, v1
    v_lshlrev_b32 v3, 3, v3
    s_lshl_b32 s38, s29, 6
    s_mul_i32 s39, s25, 128
    s_add_u32 s38, s38, s39
    v_add3_u32 v2, v2, v3, s38
    s_mov_b32 s20, s56
    s_mov_b32 s21, s57
    s_mov_b32 s22, 2048
    s_mov_b32 s23, 0x00020000
    v_lshrrev_b32 v3, 4, v1
    v_lshlrev_b32 v3, 3, v3
    s_lshl_b32 s38, s29, 6
    s_mul_i32 s39, s25, 128
    s_add_u32 s38, s38, s39
    v_add_u32 v3, s38, v3
    buffer_load_dwordx2 v[52:53], v3, s[20:23], 0 offen offset:0
    buffer_load_dwordx2 v[54:55], v3, s[20:23], 0 offen offset:32
    s_mov_b32 s39, 0
    buffer_load_dwordx2 v[36:37], v2, s[16:19], s39 offen offset:0
    s_mov_b32 s39, 0
    buffer_load_dwordx2 v[38:39], v2, s[16:19], s39 offen offset:32
    s_mov_b32 s39, 32768
    buffer_load_dwordx2 v[40:41], v2, s[16:19], s39 offen offset:0
    s_mov_b32 s39, 32768
    buffer_load_dwordx2 v[42:43], v2, s[16:19], s39 offen offset:32
    s_waitcnt vmcnt(0)
    v_cvt_pk_bf16_f32 v4, v20, v21
    v_lshlrev_b32 v20, 16, v4
    v_and_b32 v21, 0xffff0000, v4
    v_cvt_pk_bf16_f32 v4, v22, v23
    v_lshlrev_b32 v22, 16, v4
    v_and_b32 v23, 0xffff0000, v4
    v_lshlrev_b32 v4, 16, v52
    v_add_f32 v20, v4, v20
    v_and_b32 v4, 0xffff0000, v52
    v_add_f32 v21, v4, v21
    v_lshlrev_b32 v4, 16, v53
    v_add_f32 v22, v4, v22
    v_and_b32 v4, 0xffff0000, v53
    v_add_f32 v23, v4, v23
    v_cvt_pk_bf16_f32 v4, v20, v21
    v_lshlrev_b32 v20, 16, v4
    v_and_b32 v21, 0xffff0000, v4
    v_cvt_pk_bf16_f32 v4, v22, v23
    v_lshlrev_b32 v22, 16, v4
    v_and_b32 v23, 0xffff0000, v4
    v_lshlrev_b32 v4, 16, v36
    v_add_f32 v20, v4, v20
    v_and_b32 v4, 0xffff0000, v36
    v_add_f32 v21, v4, v21
    v_lshlrev_b32 v4, 16, v37
    v_add_f32 v22, v4, v22
    v_and_b32 v4, 0xffff0000, v37
    v_add_f32 v23, v4, v23
    v_cvt_pk_bf16_f32 v4, v20, v21
    v_cvt_pk_bf16_f32 v5, v22, v23
    s_mov_b32 s39, 0
    buffer_store_dwordx2 v[4:5], v2, s[12:15], s39 offen offset:0
    v_cvt_pk_bf16_f32 v4, v24, v25
    v_lshlrev_b32 v24, 16, v4
    v_and_b32 v25, 0xffff0000, v4
    v_cvt_pk_bf16_f32 v4, v26, v27
    v_lshlrev_b32 v26, 16, v4
    v_and_b32 v27, 0xffff0000, v4
    v_lshlrev_b32 v4, 16, v54
    v_add_f32 v24, v4, v24
    v_and_b32 v4, 0xffff0000, v54
    v_add_f32 v25, v4, v25
    v_lshlrev_b32 v4, 16, v55
    v_add_f32 v26, v4, v26
    v_and_b32 v4, 0xffff0000, v55
    v_add_f32 v27, v4, v27
    v_cvt_pk_bf16_f32 v4, v24, v25
    v_lshlrev_b32 v24, 16, v4
    v_and_b32 v25, 0xffff0000, v4
    v_cvt_pk_bf16_f32 v4, v26, v27
    v_lshlrev_b32 v26, 16, v4
    v_and_b32 v27, 0xffff0000, v4
    v_lshlrev_b32 v4, 16, v38
    v_add_f32 v24, v4, v24
    v_and_b32 v4, 0xffff0000, v38
    v_add_f32 v25, v4, v25
    v_lshlrev_b32 v4, 16, v39
    v_add_f32 v26, v4, v26
    v_and_b32 v4, 0xffff0000, v39
    v_add_f32 v27, v4, v27
    v_cvt_pk_bf16_f32 v4, v24, v25
    v_cvt_pk_bf16_f32 v5, v26, v27
    s_mov_b32 s39, 0
    buffer_store_dwordx2 v[4:5], v2, s[12:15], s39 offen offset:32
    v_cvt_pk_bf16_f32 v4, v28, v29
    v_lshlrev_b32 v28, 16, v4
    v_and_b32 v29, 0xffff0000, v4
    v_cvt_pk_bf16_f32 v4, v30, v31
    v_lshlrev_b32 v30, 16, v4
    v_and_b32 v31, 0xffff0000, v4
    v_lshlrev_b32 v4, 16, v52
    v_add_f32 v28, v4, v28
    v_and_b32 v4, 0xffff0000, v52
    v_add_f32 v29, v4, v29
    v_lshlrev_b32 v4, 16, v53
    v_add_f32 v30, v4, v30
    v_and_b32 v4, 0xffff0000, v53
    v_add_f32 v31, v4, v31
    v_cvt_pk_bf16_f32 v4, v28, v29
    v_lshlrev_b32 v28, 16, v4
    v_and_b32 v29, 0xffff0000, v4
    v_cvt_pk_bf16_f32 v4, v30, v31
    v_lshlrev_b32 v30, 16, v4
    v_and_b32 v31, 0xffff0000, v4
    v_lshlrev_b32 v4, 16, v40
    v_add_f32 v28, v4, v28
    v_and_b32 v4, 0xffff0000, v40
    v_add_f32 v29, v4, v29
    v_lshlrev_b32 v4, 16, v41
    v_add_f32 v30, v4, v30
    v_and_b32 v4, 0xffff0000, v41
    v_add_f32 v31, v4, v31
    v_cvt_pk_bf16_f32 v4, v28, v29
    v_cvt_pk_bf16_f32 v5, v30, v31
    s_mov_b32 s39, 32768
    buffer_store_dwordx2 v[4:5], v2, s[12:15], s39 offen offset:0
    v_cvt_pk_bf16_f32 v4, v32, v33
    v_lshlrev_b32 v32, 16, v4
    v_and_b32 v33, 0xffff0000, v4
    v_cvt_pk_bf16_f32 v4, v34, v35
    v_lshlrev_b32 v34, 16, v4
    v_and_b32 v35, 0xffff0000, v4
    v_lshlrev_b32 v4, 16, v54
    v_add_f32 v32, v4, v32
    v_and_b32 v4, 0xffff0000, v54
    v_add_f32 v33, v4, v33
    v_lshlrev_b32 v4, 16, v55
    v_add_f32 v34, v4, v34
    v_and_b32 v4, 0xffff0000, v55
    v_add_f32 v35, v4, v35
    v_cvt_pk_bf16_f32 v4, v32, v33
    v_lshlrev_b32 v32, 16, v4
    v_and_b32 v33, 0xffff0000, v4
    v_cvt_pk_bf16_f32 v4, v34, v35
    v_lshlrev_b32 v34, 16, v4
    v_and_b32 v35, 0xffff0000, v4
    v_lshlrev_b32 v4, 16, v42
    v_add_f32 v32, v4, v32
    v_and_b32 v4, 0xffff0000, v42
    v_add_f32 v33, v4, v33
    v_lshlrev_b32 v4, 16, v43
    v_add_f32 v34, v4, v34
    v_and_b32 v4, 0xffff0000, v43
    v_add_f32 v35, v4, v35
    v_cvt_pk_bf16_f32 v4, v32, v33
    v_cvt_pk_bf16_f32 v5, v34, v35
    s_mov_b32 s39, 32768
    buffer_store_dwordx2 v[4:5], v2, s[12:15], s39 offen offset:32
    s_waitcnt vmcnt(0)
    s_waitcnt vmcnt(0)
L_end_mlp2_0_kernel:
    s_endpgm
.globl ln1_1_kernel
.p2align 8
.type ln1_1_kernel,@function
ln1_1_kernel:
    s_cmp_ge_u32 s2, 512
    s_cbranch_scc1 L_end_ln1_1_kernel
    s_load_dwordx2 s[4:5], s[0:1], 80
    s_load_dwordx2 s[6:7], s[0:1], 80
    v_lshrrev_b32 v2, 6, v0
    v_and_b32 v1, 63, v0
    s_lshl_b32 s3, s2, 2
    v_add_u32 v2, s3, v2
    v_lshlrev_b32 v2, 11, v2
    v_lshlrev_b32 v3, 4, v1
    v_add_u32 v2, v2, v3
    s_waitcnt lgkmcnt(0)
    s_add_u32 s8, s4, 16777216
    s_addc_u32 s9, s5, 0
    s_mov_b32 s10, 4194304
    s_mov_b32 s11, 0x00020000
    s_add_u32 s12, s6, 0
    s_addc_u32 s13, s7, 0
    s_mov_b32 s14, 4194304
    s_mov_b32 s15, 0x00020000
    buffer_load_dwordx4 v[4:7], v2, s[8:11], 0 offen
    buffer_load_dwordx4 v[8:11], v2, s[8:11], 0 offen offset:1024
    s_waitcnt vmcnt(0)
    v_lshlrev_b32 v20, 16, v4
    v_and_b32 v21, 0xffff0000, v4
    v_lshlrev_b32 v22, 16, v5
    v_and_b32 v23, 0xffff0000, v5
    v_lshlrev_b32 v24, 16, v6
    v_and_b32 v25, 0xffff0000, v6
    v_lshlrev_b32 v26, 16, v7
    v_and_b32 v27, 0xffff0000, v7
    v_lshlrev_b32 v28, 16, v8
    v_and_b32 v29, 0xffff0000, v8
    v_lshlrev_b32 v30, 16, v9
    v_and_b32 v31, 0xffff0000, v9
    v_lshlrev_b32 v32, 16, v10
    v_and_b32 v33, 0xffff0000, v10
    v_lshlrev_b32 v34, 16, v11
    v_and_b32 v35, 0xffff0000, v11
    v_add_f32 v40, v20, v21
    v_add_f32 v40, v40, v22
    v_add_f32 v40, v40, v23
    v_add_f32 v40, v40, v24
    v_add_f32 v40, v40, v25
    v_add_f32 v40, v40, v26
    v_add_f32 v40, v40, v27
    v_add_f32 v40, v40, v28
    v_add_f32 v40, v40, v29
    v_add_f32 v40, v40, v30
    v_add_f32 v40, v40, v31
    v_add_f32 v40, v40, v32
    v_add_f32 v40, v40, v33
    v_add_f32 v40, v40, v34
    v_add_f32 v40, v40, v35
    s_nop 1
    v_add_f32_dpp v40, v40, v40 quad_perm:[1,0,3,2] row_mask:0xf bank_mask:0xf
    s_nop 1
    v_add_f32_dpp v40, v40, v40 quad_perm:[2,3,0,1] row_mask:0xf bank_mask:0xf
    s_nop 1
    v_add_f32_dpp v40, v40, v40 row_ror:4 row_mask:0xf bank_mask:0xf
    s_nop 1
    v_add_f32_dpp v40, v40, v40 row_ror:8 row_mask:0xf bank_mask:0xf
    v_mov_b32 v41, v40
    s_nop 1
    v_permlane16_swap_b32 v40, v41
    s_nop 1
    v_add_f32 v40, v40, v41
    v_mov_b32 v41, v40
    s_nop 1
    v_permlane32_swap_b32 v40, v41
    s_nop 1
    v_add_f32 v40, v40, v41
    v_mul_f32 v40, 0x3a800000, v40
    v_sub_f32 v42, v20, v40
    v_mul_f32 v43, v42, v42
    v_sub_f32 v42, v21, v40
    v_fmac_f32 v43, v42, v42
    v_sub_f32 v42, v22, v40
    v_fmac_f32 v43, v42, v42
    v_sub_f32 v42, v23, v40
    v_fmac_f32 v43, v42, v42
    v_sub_f32 v42, v24, v40
    v_fmac_f32 v43, v42, v42
    v_sub_f32 v42, v25, v40
    v_fmac_f32 v43, v42, v42
    v_sub_f32 v42, v26, v40
    v_fmac_f32 v43, v42, v42
    v_sub_f32 v42, v27, v40
    v_fmac_f32 v43, v42, v42
    v_sub_f32 v42, v28, v40
    v_fmac_f32 v43, v42, v42
    v_sub_f32 v42, v29, v40
    v_fmac_f32 v43, v42, v42
    v_sub_f32 v42, v30, v40
    v_fmac_f32 v43, v42, v42
    v_sub_f32 v42, v31, v40
    v_fmac_f32 v43, v42, v42
    v_sub_f32 v42, v32, v40
    v_fmac_f32 v43, v42, v42
    v_sub_f32 v42, v33, v40
    v_fmac_f32 v43, v42, v42
    v_sub_f32 v42, v34, v40
    v_fmac_f32 v43, v42, v42
    v_sub_f32 v42, v35, v40
    v_fmac_f32 v43, v42, v42
    s_nop 1
    v_add_f32_dpp v43, v43, v43 quad_perm:[1,0,3,2] row_mask:0xf bank_mask:0xf
    s_nop 1
    v_add_f32_dpp v43, v43, v43 quad_perm:[2,3,0,1] row_mask:0xf bank_mask:0xf
    s_nop 1
    v_add_f32_dpp v43, v43, v43 row_ror:4 row_mask:0xf bank_mask:0xf
    s_nop 1
    v_add_f32_dpp v43, v43, v43 row_ror:8 row_mask:0xf bank_mask:0xf
    v_mov_b32 v41, v43
    s_nop 1
    v_permlane16_swap_b32 v43, v41
    s_nop 1
    v_add_f32 v43, v43, v41
    v_mov_b32 v41, v43
    s_nop 1
    v_permlane32_swap_b32 v43, v41
    s_nop 1
    v_add_f32 v43, v43, v41
    v_mul_f32 v43, 0x3a800000, v43
    v_cvt_pk_bf16_f32 v41, v40, v43
    v_lshlrev_b32 v40, 16, v41
    v_and_b32 v43, 0xffff0000, v41
    v_add_f32 v43, 0x3727c5ac, v43
    v_mov_b32 v44, v43
    v_cvt_pk_bf16_f32 v41, v43, v44
    v_lshlrev_b32 v43, 16, v41
    v_and_b32 v44, 0xffff0000, v41
    v_sqrt_f32 v43, v43
    s_nop 0
    v_mov_b32 v44, v43
    v_cvt_pk_bf16_f32 v41, v43, v44
    v_lshlrev_b32 v43, 16, v41
    v_and_b32 v44, 0xffff0000, v41
    v_rcp_f32 v43, v43
    s_nop 0
    v_sub_f32 v20, v20, v40
    v_sub_f32 v21, v21, v40
    v_cvt_pk_bf16_f32 v41, v20, v21
    v_lshlrev_b32 v20, 16, v41
    v_and_b32 v21, 0xffff0000, v41
    v_mul_f32 v20, v20, v43
    v_mul_f32 v21, v21, v43
    v_sub_f32 v22, v22, v40
    v_sub_f32 v23, v23, v40
    v_cvt_pk_bf16_f32 v41, v22, v23
    v_lshlrev_b32 v22, 16, v41
    v_and_b32 v23, 0xffff0000, v41
    v_mul_f32 v22, v22, v43
    v_mul_f32 v23, v23, v43
    v_sub_f32 v24, v24, v40
    v_sub_f32 v25, v25, v40
    v_cvt_pk_bf16_f32 v41, v24, v25
    v_lshlrev_b32 v24, 16, v41
    v_and_b32 v25, 0xffff0000, v41
    v_mul_f32 v24, v24, v43
    v_mul_f32 v25, v25, v43
    v_sub_f32 v26, v26, v40
    v_sub_f32 v27, v27, v40
    v_cvt_pk_bf16_f32 v41, v26, v27
    v_lshlrev_b32 v26, 16, v41
    v_and_b32 v27, 0xffff0000, v41
    v_mul_f32 v26, v26, v43
    v_mul_f32 v27, v27, v43
    v_sub_f32 v28, v28, v40
    v_sub_f32 v29, v29, v40
    v_cvt_pk_bf16_f32 v41, v28, v29
    v_lshlrev_b32 v28, 16, v41
    v_and_b32 v29, 0xffff0000, v41
    v_mul_f32 v28, v28, v43
    v_mul_f32 v29, v29, v43
    v_sub_f32 v30, v30, v40
    v_sub_f32 v31, v31, v40
    v_cvt_pk_bf16_f32 v41, v30, v31
    v_lshlrev_b32 v30, 16, v41
    v_and_b32 v31, 0xffff0000, v41
    v_mul_f32 v30, v30, v43
    v_mul_f32 v31, v31, v43
    v_sub_f32 v32, v32, v40
    v_sub_f32 v33, v33, v40
    v_cvt_pk_bf16_f32 v41, v32, v33
    v_lshlrev_b32 v32, 16, v41
    v_and_b32 v33, 0xffff0000, v41
    v_mul_f32 v32, v32, v43
    v_mul_f32 v33, v33, v43
    v_sub_f32 v34, v34, v40
    v_sub_f32 v35, v35, v40
    v_cvt_pk_bf16_f32 v41, v34, v35
    v_lshlrev_b32 v34, 16, v41
    v_and_b32 v35, 0xffff0000, v41
    v_mul_f32 v34, v34, v43
    v_mul_f32 v35, v35, v43
    v_cvt_pk_bf16_f32 v4, v20, v21
    v_cvt_pk_bf16_f32 v5, v22, v23
    v_cvt_pk_bf16_f32 v6, v24, v25
    v_cvt_pk_bf16_f32 v7, v26, v27
    v_cvt_pk_bf16_f32 v8, v28, v29
    v_cvt_pk_bf16_f32 v9, v30, v31
    v_cvt_pk_bf16_f32 v10, v32, v33
    v_cvt_pk_bf16_f32 v11, v34, v35
    buffer_store_dwordx4 v[4:7], v2, s[12:15], 0 offen
    buffer_store_dwordx4 v[8:11], v2, s[12:15], 0 offen offset:1024
    s_waitcnt vmcnt(0)
L_end_ln1_1_kernel:
    s_endpgm
.globl qkv_1_kernel
.p2align 8
.type qkv_1_kernel,@function
qkv_1_kernel:
    s_cmp_ge_u32 s2, 256
    s_cbranch_scc1 L_end_qkv_1_kernel
    s_load_dwordx2 s[40:41], s[0:1], 80
    s_load_dwordx2 s[42:43], s[0:1], 8
    s_load_dwordx2 s[50:51], s[0:1], 80
    v_and_b32 v1, 63, v0
    v_lshrrev_b32 v2, 6, v0
    s_and_b32 s24, s2, 15
    v_readfirstlane_b32 s26, v2
    s_lshr_b32 s25, s2, 4
    s_nop 1
    s_lshr_b32 s27, s26, 2
    s_and_b32 s28, s26, 1
    s_bfe_u32 s29, s26, 0x10001
    v_lshrrev_b32 v2, 3, v1
    v_and_b32 v3, 7, v1
    v_xor_b32 v3, v3, v2
    s_lshl_b32 s38, s26, 4
    s_lshl_b32 s39, s24, 7
    s_add_u32 s38, s38, s39
    v_add_u32 v4, s38, v2
    s_mov_b32 s38, 2048
    v_mul_lo_u32 v4, v4, s38
    v_lshlrev_b32 v3, 4, v3
    v_add_u32 v10, v4, v3
    v_add_u32 v11, 16384, v10
    v_lshrrev_b32 v2, 3, v1
    s_lshl_b32 s38, s26, 3
    v_add_u32 v2, s38, v2
    s_mov_b32 s38, 6144
    v_mul_lo_u32 v2, v2, s38
    v_bfe_u32 v3, v1, 1, 2
    v_bfe_u32 v4, v1, 4, 1
    s_and_b32 s38, s26, 1
    s_lshl_b32 s38, s38, 1
    v_or_b32 v4, s38, v4
    v_xor_b32 v3, v3, v4
    v_lshlrev_b32 v3, 5, v3
    v_and_b32 v4, 1, v1
    v_lshlrev_b32 v4, 4, v4
    v_add3_u32 v12, v2, v3, v4
    v_and_b32 v2, 15, v1
    s_lshl_b32 s38, s28, 6
    v_add_u32 v2, s38, v2
    v_lshlrev_b32 v2, 7, v2
    v_lshrrev_b32 v3, 4, v1
    s_lshl_b32 s38, s27, 2
    v_add_u32 v3, s38, v3
    v_and_b32 v4, 7, v1
    v_xor_b32 v3, v3, v4
    v_lshlrev_b32 v3, 4, v3
    v_add_u32 v13, v2, v3
    v_lshrrev_b32 v2, 4, v1
    v_lshlrev_b32 v2, 3, v2
    v_bfe_u32 v3, v1, 2, 2
    v_add_u32 v2, v2, v3
    v_lshlrev_b32 v2, 7, v2
    v_and_b32 v3, 3, v1
    v_lshlrev_b32 v3, 3, v3
    v_add_u32 v2, v2, v3
    s_lshl_b32 s38, s27, 12
    s_add_u32 s38, s38, 16384
    v_add_u32 v2, s38, v2
    v_bfe_u32 v3, v1, 3, 1
    v_bfe_u32 v4, v1, 4, 1
    v_lshlrev_b32 v4, 1, v4
    v_or_b32 v3, v3, v4
    s_lshl_b32 s38, s29, 1
    v_xor_b32 v4, s38, v3
    v_lshlrev_b32 v4, 5, v4
    v_add_u32 v14, v2, v4
    v_xor_b32 v4, 32, v4
    v_add_u32 v15, v2, v4
    s_waitcnt lgkmcnt(0)
    s_mov_b32 s4, s40
    s_mov_b32 s5, s41
    s_mov_b32 s6, 4194304
    s_mov_b32 s7, 0x00020000
    s_mov_b32 s8, s42
    s_mov_b32 s9, s43
    s_mov_b32 s10, 6291456
    s_mov_b32 s11, 0x00020000
    s_mov_b32 s31, 0
    s_mul_i32 s32, s25, 128
    s_add_u32 s33, s32, 2048
    s_add_u32 s34, s32, 4096
    s_mov_b32 s36, 0
    s_lshl_b32 s44, s26, 11
    s_add_u32 s45, s44, 1024
    s_lshl_b32 s46, s26, 10
    s_add_u32 s46, s46, 16384
    s_add_u32 s47, s46, 8192
    s_add_u32 s48, s46, 16384
    s_add_u32 m0, s36, s44
    s_nop 0
    buffer_load_dwordx4 v10, s[4:7], s31 offen lds
    s_add_u32 m0, s36, s45
    s_nop 0
    buffer_load_dwordx4 v11, s[4:7], s31 offen lds
    s_add_u32 m0, s36, s46
    s_nop 0
    buffer_load_dwordx4 v12, s[8:11], s32 offen lds
    s_add_u32 m0, s36, s47
    s_nop 0
    buffer_load_dwordx4 v12, s[8:11], s33 offen lds
    s_add_u32 m0, s36, s48
    s_nop 0
    buffer_load_dwordx4 v12, s[8:11], s34 offen lds
    s_add_u32 s31, s31, 128
    s_add_u32 s32, s32, 393216
    s_add_u32 s33, s33, 393216
    s_add_u32 s34, s34, 393216
    s_add_u32 s36, s36, 40960
    s_cmp_ge_u32 s36, 122880
    s_cselect_b32 s36, 0, s36
    v_mov_b32 v100, 0
    v_mov_b32 v101, 0
    v_mov_b32 v102, 0
    v_mov_b32 v103, 0
    v_mov_b32 v104, 0
    v_mov_b32 v105, 0
    v_mov_b32 v106, 0
    v_mov_b32 v107, 0
    v_mov_b32 v108, 0
    v_mov_b32 v109, 0
    v_mov_b32 v110, 0
    v_mov_b32 v111, 0
    v_mov_b32 v112, 0
    v_mov_b32 v113, 0
    v_mov_b32 v114, 0
    v_mov_b32 v115, 0
    v_mov_b32 v116, 0
    v_mov_b32 v117, 0
    v_mov_b32 v118, 0
    v_mov_b32 v119, 0
    v_mov_b32 v120, 0
    v_mov_b32 v121, 0
    v_mov_b32 v122, 0
    v_mov_b32 v123, 0
    v_mov_b32 v124, 0
    v_mov_b32 v125, 0
    v_mov_b32 v126, 0
    v_mov_b32 v127, 0
    v_mov_b32 v128, 0
    v_mov_b32 v129, 0
    v_mov_b32 v130, 0
    v_mov_b32 v131, 0
    v_mov_b32 v132, 0
    v_mov_b32 v133, 0
    v_mov_b32 v134, 0
    v_mov_b32 v135, 0
    v_mov_b32 v136, 0
    v_mov_b32 v137, 0
    v_mov_b32 v138, 0
    v_mov_b32 v139, 0
    v_mov_b32 v140, 0
    v_mov_b32 v141, 0
    v_mov_b32 v142, 0
    v_mov_b32 v143, 0
    v_mov_b32 v144, 0
    v_mov_b32 v145, 0
    v_mov_b32 v146, 0
    v_mov_b32 v147, 0
    v_mov_b32 v148, 0
    v_mov_b32 v149, 0
    v_mov_b32 v150, 0
    v_mov_b32 v151, 0
    v_mov_b32 v152, 0
    v_mov_b32 v153, 0
    v_mov_b32 v154, 0
    v_mov_b32 v155, 0
    v_mov_b32 v156, 0
    v_mov_b32 v157, 0
    v_mov_b32 v158, 0
    v_mov_b32 v159, 0
    v_mov_b32 v160, 0
    v_mov_b32 v161, 0
    v_mov_b32 v162, 0
    v_mov_b32 v163, 0
    v_mov_b32 v164, 0
    v_mov_b32 v165, 0
    v_mov_b32 v166, 0
    v_mov_b32 v167, 0
    v_mov_b32 v168, 0
    v_mov_b32 v169, 0
    v_mov_b32 v170, 0
    v_mov_b32 v171, 0
    v_mov_b32 v172, 0
    v_mov_b32 v173, 0
    v_mov_b32 v174, 0
    v_mov_b32 v175, 0
    v_mov_b32 v176, 0
    v_mov_b32 v177, 0
    v_mov_b32 v178, 0
    v_mov_b32 v179, 0
    v_mov_b32 v180, 0
    v_mov_b32 v181, 0
    v_mov_b32 v182, 0
    v_mov_b32 v183, 0
    v_mov_b32 v184, 0
    v_mov_b32 v185, 0
    v_mov_b32 v186, 0
    v_mov_b32 v187, 0
    v_mov_b32 v188, 0
    v_mov_b32 v189, 0
    v_mov_b32 v190, 0
    v_mov_b32 v191, 0
    v_mov_b32 v192, 0
    v_mov_b32 v193, 0
    v_mov_b32 v194, 0
    v_mov_b32 v195, 0
    s_add_u32 m0, s36, s44
    s_nop 0
    buffer_load_dwordx4 v10, s[4:7], s31 offen lds
    s_add_u32 m0, s36, s45
    s_nop 0
    buffer_load_dwordx4 v11, s[4:7], s31 offen lds
    s_add_u32 m0, s36, s46
    s_nop 0
    buffer_load_dwordx4 v12, s[8:11], s32 offen lds
    s_add_u32 m0, s36, s47
    s_nop 0
    buffer_load_dwordx4 v12, s[8:11], s33 offen lds
    s_add_u32 m0, s36, s48
    s_nop 0
    buffer_load_dwordx4 v12, s[8:11], s34 offen lds
    s_add_u32 s31, s31, 128
    s_add_u32 s32, s32, 393216
    s_add_u32 s33, s33, 393216
    s_add_u32 s34, s34, 393216
    s_add_u32 s36, s36, 40960
    s_cmp_ge_u32 s36, 122880
    s_cselect_b32 s36, 0, s36
    s_add_u32 m0, s36, s44
    s_nop 0
    buffer_load_dwordx4 v10, s[4:7], s31 offen lds
    s_add_u32 m0, s36, s45
    s_nop 0
    buffer_load_dwordx4 v11, s[4:7], s31 offen lds
    s_add_u32 m0, s36, s46
    s_nop 0
    buffer_load_dwordx4 v12, s[8:11], s32 offen lds
    s_add_u32 m0, s36, s47
    s_nop 0
    buffer_load_dwordx4 v12, s[8:11], s33 offen lds
    s_add_u32 m0, s36, s48
    s_nop 0
    buffer_load_dwordx4 v12, s[8:11], s34 offen lds
    s_add_u32 s31, s31, 128
    s_add_u32 s32, s32, 393216
    s_add_u32 s33, s33, 393216
    s_add_u32 s34, s34, 393216
    s_add_u32 s36, s36, 40960
    s_cmp_ge_u32 s36, 122880
    s_cselect_b32 s36, 0, s36
    s_mov_b32 s37, 0
    s_waitcnt vmcnt(10)
    s_barrier
    v_add_u32 v16, s37, v13
    v_add_u32 v17, s37, v14
    v_add_u32 v18, s37, v15
    s_add_u32 s37, s37, 40960
    s_cmp_ge_u32 s37, 122880
    s_cselect_b32 s37, 0, s37
    ds_read_b128 v[20:23], v16 offset:0
    ds_read_b128 v[24:27], v16 offset:2048
    ds_read_b128 v[28:31], v16 offset:4096
    ds_read_b128 v[32:35], v16 offset:6144
    ds_read_b64_tr_b16 v[52:53], v17 offset:0
    ds_read_b64_tr_b16 v[54:55], v17 offset:512
    ds_read_b64_tr_b16 v[56:57], v18 offset:0
    ds_read_b64_tr_b16 v[58:59], v18 offset:512
    ds_read_b64_tr_b16 v[60:61], v17 offset:8192
    ds_read_b64_tr_b16 v[62:63], v17 offset:8704
    ds_read_b64_tr_b16 v[64:65], v18 offset:8192
    ds_read_b64_tr_b16 v[66:67], v18 offset:8704
    ds_read_b64_tr_b16 v[68:69], v17 offset:16384
    ds_read_b64_tr_b16 v[70:71], v17 offset:16896
    ds_read_b64_tr_b16 v[72:73], v18 offset:16384
    ds_read_b64_tr_b16 v[74:75], v18 offset:16896
    s_mov_b32 s30, 6
L_loop_qkv_1_kernel:
    s_waitcnt lgkmcnt(0)
    v_mfma_f32_16x16x32_bf16 v[100:103], v[52:55], v[20:23], v[100:103]
    v_mfma_f32_16x16x32_bf16 v[104:107], v[56:59], v[20:23], v[104:107]
    v_mfma_f32_16x16x32_bf16 v[108:111], v[20:23], v[60:63], v[108:111]
    v_mfma_f32_16x16x32_bf16 v[112:115], v[20:23], v[64:67], v[112:115]
    v_mfma_f32_16x16x32_bf16 v[116:119], v[20:23], v[68:71], v[116:119]
    v_mfma_f32_16x16x32_bf16 v[120:123], v[20:23], v[72:75], v[120:123]
    v_mfma_f32_16x16x32_bf16 v[124:127], v[52:55], v[24:27], v[124:127]
    v_mfma_f32_16x16x32_bf16 v[128:131], v[56:59], v[24:27], v[128:131]
    v_mfma_f32_16x16x32_bf16 v[132:135], v[24:27], v[60:63], v[132:135]
    v_mfma_f32_16x16x32_bf16 v[136:139], v[24:27], v[64:67], v[136:139]
    v_mfma_f32_16x16x32_bf16 v[140:143], v[24:27], v[68:71], v[140:143]
    v_mfma_f32_16x16x32_bf16 v[144:147], v[24:27], v[72:75], v[144:147]
    s_waitcnt vmcnt(5)
    s_barrier
    v_add_u32 v16, s37, v13
    v_add_u32 v17, s37, v14
    v_add_u32 v18, s37, v15
    s_add_u32 s37, s37, 40960
    s_cmp_ge_u32 s37, 122880
    s_cselect_b32 s37, 0, s37
    ds_read_b128 v[36:39], v16 offset:0
    ds_read_b128 v[40:43], v16 offset:2048
    ds_read_b128 v[44:47], v16 offset:4096
    ds_read_b128 v[48:51], v16 offset:6144
    ds_read_b64_tr_b16 v[76:77], v17 offset:0
    ds_read_b64_tr_b16 v[78:79], v17 offset:512
    ds_read_b64_tr_b16 v[80:81], v18 offset:0
    ds_read_b64_tr_b16 v[82:83], v18 offset:512
    ds_read_b64_tr_b16 v[84:85], v17 offset:8192
    ds_read_b64_tr_b16 v[86:87], v17 offset:8704
    ds_read_b64_tr_b16 v[88:89], v18 offset:8192
    ds_read_b64_tr_b16 v[90:91], v18 offset:8704
    ds_read_b64_tr_b16 v[92:93], v17 offset:16384
    ds_read_b64_tr_b16 v[94:95], v17 offset:16896
    ds_read_b64_tr_b16 v[96:97], v18 offset:16384
    ds_read_b64_tr_b16 v[98:99], v18 offset:16896
    s_add_u32 m0, s36, s44
    v_mfma_f32_16x16x32_bf16 v[148:151], v[52:55], v[28:31], v[148:151]
    buffer_load_dwordx4 v10, s[4:7], s31 offen lds
    v_mfma_f32_16x16x32_bf16 v[152:155], v[56:59], v[28:31], v[152:155]
    s_add_u32 m0, s36, s45
    v_mfma_f32_16x16x32_bf16 v[156:159], v[28:31], v[60:63], v[156:159]
    buffer_load_dwordx4 v11, s[4:7], s31 offen lds
    v_mfma_f32_16x16x32_bf16 v[160:163], v[28:31], v[64:67], v[160:163]
    s_add_u32 m0, s36, s46
    v_mfma_f32_16x16x32_bf16 v[164:167], v[28:31], v[68:71], v[164:167]
    buffer_load_dwordx4 v12, s[8:11], s32 offen lds
    v_mfma_f32_16x16x32_bf16 v[168:171], v[28:31], v[72:75], v[168:171]
    s_add_u32 m0, s36, s47
    v_mfma_f32_16x16x32_bf16 v[172:175], v[52:55], v[32:35], v[172:175]
    buffer_load_dwordx4 v12, s[8:11], s33 offen lds
    v_mfma_f32_16x16x32_bf16 v[176:179], v[56:59], v[32:35], v[176:179]
    s_add_u32 m0, s36, s48
    v_mfma_f32_16x16x32_bf16 v[180:183], v[32:35], v[60:63], v[180:183]
    buffer_load_dwordx4 v12, s[8:11], s34 offen lds
    v_mfma_f32_16x16x32_bf16 v[184:187], v[32:35], v[64:67], v[184:187]
    v_mfma_f32_16x16x32_bf16 v[188:191], v[32:35], v[68:71], v[188:191]
    v_mfma_f32_16x16x32_bf16 v[192:195], v[32:35], v[72:75], v[192:195]
    s_add_u32 s31, s31, 128
    s_add_u32 s32, s32, 393216
    s_add_u32 s33, s33, 393216
    s_add_u32 s34, s34, 393216
    s_add_u32 s36, s36, 40960
    s_cmp_ge_u32 s36, 122880
    s_cselect_b32 s36, 0, s36
    s_waitcnt lgkmcnt(0)
    v_mfma_f32_16x16x32_bf16 v[100:103], v[76:79], v[36:39], v[100:103]
    v_mfma_f32_16x16x32_bf16 v[104:107], v[80:83], v[36:39], v[104:107]
    v_mfma_f32_16x16x32_bf16 v[108:111], v[36:39], v[84:87], v[108:111]
    v_mfma_f32_16x16x32_bf16 v[112:115], v[36:39], v[88:91], v[112:115]
    v_mfma_f32_16x16x32_bf16 v[116:119], v[36:39], v[92:95], v[116:119]
    v_mfma_f32_16x16x32_bf16 v[120:123], v[36:39], v[96:99], v[120:123]
    v_mfma_f32_16x16x32_bf16 v[124:127], v[76:79], v[40:43], v[124:127]
    v_mfma_f32_16x16x32_bf16 v[128:131], v[80:83], v[40:43], v[128:131]
    v_mfma_f32_16x16x32_bf16 v[132:135], v[40:43], v[84:87], v[132:135]
    v_mfma_f32_16x16x32_bf16 v[136:139], v[40:43], v[88:91], v[136:139]
    v_mfma_f32_16x16x32_bf16 v[140:143], v[40:43], v[92:95], v[140:143]
    v_mfma_f32_16x16x32_bf16 v[144:147], v[40:43], v[96:99], v[144:147]
    s_waitcnt vmcnt(5)
    s_barrier
    v_add_u32 v16, s37, v13
    v_add_u32 v17, s37, v14
    v_add_u32 v18, s37, v15
    s_add_u32 s37, s37, 40960
    s_cmp_ge_u32 s37, 122880
    s_cselect_b32 s37, 0, s37
    ds_read_b128 v[20:23], v16 offset:0
    ds_read_b128 v[24:27], v16 offset:2048
    ds_read_b128 v[28:31], v16 offset:4096
    ds_read_b128 v[32:35], v16 offset:6144
    ds_read_b64_tr_b16 v[52:53], v17 offset:0
    ds_read_b64_tr_b16 v[54:55], v17 offset:512
    ds_read_b64_tr_b16 v[56:57], v18 offset:0
    ds_read_b64_tr_b16 v[58:59], v18 offset:512
    ds_read_b64_tr_b16 v[60:61], v17 offset:8192
    ds_read_b64_tr_b16 v[62:63], v17 offset:8704
    ds_read_b64_tr_b16 v[64:65], v18 offset:8192
    ds_read_b64_tr_b16 v[66:67], v18 offset:8704
    ds_read_b64_tr_b16 v[68:69], v17 offset:16384
    ds_read_b64_tr_b16 v[70:71], v17 offset:16896
    ds_read_b64_tr_b16 v[72:73], v18 offset:16384
    ds_read_b64_tr_b16 v[74:75], v18 offset:16896
    s_add_u32 m0, s36, s44
    v_mfma_f32_16x16x32_bf16 v[148:151], v[76:79], v[44:47], v[148:151]
    buffer_load_dwordx4 v10, s[4:7], s31 offen lds
    v_mfma_f32_16x16x32_bf16 v[152:155], v[80:83], v[44:47], v[152:155]
    s_add_u32 m0, s36, s45
    v_mfma_f32_16x16x32_bf16 v[156:159], v[44:47], v[84:87], v[156:159]
    buffer_load_dwordx4 v11, s[4:7], s31 offen lds
    v_mfma_f32_16x16x32_bf16 v[160:163], v[44:47], v[88:91], v[160:163]
    s_add_u32 m0, s36, s46
    v_mfma_f32_16x16x32_bf16 v[164:167], v[44:47], v[92:95], v[164:167]
    buffer_load_dwordx4 v12, s[8:11], s32 offen lds
    v_mfma_f32_16x16x32_bf16 v[168:171], v[44:47], v[96:99], v[168:171]
    s_add_u32 m0, s36, s47
    v_mfma_f32_16x16x32_bf16 v[172:175], v[76:79], v[48:51], v[172:175]
    buffer_load_dwordx4 v12, s[8:11], s33 offen lds
    v_mfma_f32_16x16x32_bf16 v[176:179], v[80:83], v[48:51], v[176:179]
    s_add_u32 m0, s36, s48
    v_mfma_f32_16x16x32_bf16 v[180:183], v[48:51], v[84:87], v[180:183]
    buffer_load_dwordx4 v12, s[8:11], s34 offen lds
    v_mfma_f32_16x16x32_bf16 v[184:187], v[48:51], v[88:91], v[184:187]
    v_mfma_f32_16x16x32_bf16 v[188:191], v[48:51], v[92:95], v[188:191]
    v_mfma_f32_16x16x32_bf16 v[192:195], v[48:51], v[96:99], v[192:195]
    s_add_u32 s31, s31, 128
    s_add_u32 s32, s32, 393216
    s_add_u32 s33, s33, 393216
    s_add_u32 s34, s34, 393216
    s_add_u32 s36, s36, 40960
    s_cmp_ge_u32 s36, 122880
    s_cselect_b32 s36, 0, s36
    s_sub_u32 s30, s30, 1
    s_cmp_lg_u32 s30, 0
    s_cbranch_scc1 L_loop_qkv_1_kernel
    s_waitcnt lgkmcnt(0)
    v_mfma_f32_16x16x32_bf16 v[100:103], v[52:55], v[20:23], v[100:103]
    v_mfma_f32_16x16x32_bf16 v[104:107], v[56:59], v[20:23], v[104:107]
    v_mfma_f32_16x16x32_bf16 v[108:111], v[20:23], v[60:63], v[108:111]
    v_mfma_f32_16x16x32_bf16 v[112:115], v[20:23], v[64:67], v[112:115]
    v_mfma_f32_16x16x32_bf16 v[116:119], v[20:23], v[68:71], v[116:119]
    v_mfma_f32_16x16x32_bf16 v[120:123], v[20:23], v[72:75], v[120:123]
    v_mfma_f32_16x16x32_bf16 v[124:127], v[52:55], v[24:27], v[124:127]
    v_mfma_f32_16x16x32_bf16 v[128:131], v[56:59], v[24:27], v[128:131]
    v_mfma_f32_16x16x32_bf16 v[132:135], v[24:27], v[60:63], v[132:135]
    v_mfma_f32_16x16x32_bf16 v[136:139], v[24:27], v[64:67], v[136:139]
    v_mfma_f32_16x16x32_bf16 v[140:143], v[24:27], v[68:71], v[140:143]
    v_mfma_f32_16x16x32_bf16 v[144:147], v[24:27], v[72:75], v[144:147]
    s_waitcnt vmcnt(5)
    s_barrier
    v_add_u32 v16, s37, v13
    v_add_u32 v17, s37, v14
    v_add_u32 v18, s37, v15
    s_add_u32 s37, s37, 40960
    s_cmp_ge_u32 s37, 122880
    s_cselect_b32 s37, 0, s37
    ds_read_b128 v[36:39], v16 offset:0
    ds_read_b128 v[40:43], v16 offset:2048
    ds_read_b128 v[44:47], v16 offset:4096
    ds_read_b128 v[48:51], v16 offset:6144
    ds_read_b64_tr_b16 v[76:77], v17 offset:0
    ds_read_b64_tr_b16 v[78:79], v17 offset:512
    ds_read_b64_tr_b16 v[80:81], v18 offset:0
    ds_read_b64_tr_b16 v[82:83], v18 offset:512
    ds_read_b64_tr_b16 v[84:85], v17 offset:8192
    ds_read_b64_tr_b16 v[86:87], v17 offset:8704
    ds_read_b64_tr_b16 v[88:89], v18 offset:8192
    ds_read_b64_tr_b16 v[90:91], v18 offset:8704
    ds_read_b64_tr_b16 v[92:93], v17 offset:16384
    ds_read_b64_tr_b16 v[94:95], v17 offset:16896
    ds_read_b64_tr_b16 v[96:97], v18 offset:16384
    ds_read_b64_tr_b16 v[98:99], v18 offset:16896
    s_add_u32 m0, s36, s44
    v_mfma_f32_16x16x32_bf16 v[148:151], v[52:55], v[28:31], v[148:151]
    buffer_load_dwordx4 v10, s[4:7], s31 offen lds
    v_mfma_f32_16x16x32_bf16 v[152:155], v[56:59], v[28:31], v[152:155]
    s_add_u32 m0, s36, s45
    v_mfma_f32_16x16x32_bf16 v[156:159], v[28:31], v[60:63], v[156:159]
    buffer_load_dwordx4 v11, s[4:7], s31 offen lds
    v_mfma_f32_16x16x32_bf16 v[160:163], v[28:31], v[64:67], v[160:163]
    s_add_u32 m0, s36, s46
    v_mfma_f32_16x16x32_bf16 v[164:167], v[28:31], v[68:71], v[164:167]
    buffer_load_dwordx4 v12, s[8:11], s32 offen lds
    v_mfma_f32_16x16x32_bf16 v[168:171], v[28:31], v[72:75], v[168:171]
    s_add_u32 m0, s36, s47
    v_mfma_f32_16x16x32_bf16 v[172:175], v[52:55], v[32:35], v[172:175]
    buffer_load_dwordx4 v12, s[8:11], s33 offen lds
    v_mfma_f32_16x16x32_bf16 v[176:179], v[56:59], v[32:35], v[176:179]
    s_add_u32 m0, s36, s48
    v_mfma_f32_16x16x32_bf16 v[180:183], v[32:35], v[60:63], v[180:183]
    buffer_load_dwordx4 v12, s[8:11], s34 offen lds
    v_mfma_f32_16x16x32_bf16 v[184:187], v[32:35], v[64:67], v[184:187]
    v_mfma_f32_16x16x32_bf16 v[188:191], v[32:35], v[68:71], v[188:191]
    v_mfma_f32_16x16x32_bf16 v[192:195], v[32:35], v[72:75], v[192:195]
    s_add_u32 s31, s31, 128
    s_add_u32 s32, s32, 393216
    s_add_u32 s33, s33, 393216
    s_add_u32 s34, s34, 393216
    s_add_u32 s36, s36, 40960
    s_cmp_ge_u32 s36, 122880
    s_cselect_b32 s36, 0, s36
    s_waitcnt lgkmcnt(0)
    v_mfma_f32_16x16x32_bf16 v[100:103], v[76:79], v[36:39], v[100:103]
    v_mfma_f32_16x16x32_bf16 v[104:107], v[80:83], v[36:39], v[104:107]
    v_mfma_f32_16x16x32_bf16 v[108:111], v[36:39], v[84:87], v[108:111]
    v_mfma_f32_16x16x32_bf16 v[112:115], v[36:39], v[88:91], v[112:115]
    v_mfma_f32_16x16x32_bf16 v[116:119], v[36:39], v[92:95], v[116:119]
    v_mfma_f32_16x16x32_bf16 v[120:123], v[36:39], v[96:99], v[120:123]
    v_mfma_f32_16x16x32_bf16 v[124:127], v[76:79], v[40:43], v[124:127]
    v_mfma_f32_16x16x32_bf16 v[128:131], v[80:83], v[40:43], v[128:131]
    v_mfma_f32_16x16x32_bf16 v[132:135], v[40:43], v[84:87], v[132:135]
    v_mfma_f32_16x16x32_bf16 v[136:139], v[40:43], v[88:91], v[136:139]
    v_mfma_f32_16x16x32_bf16 v[140:143], v[40:43], v[92:95], v[140:143]
    v_mfma_f32_16x16x32_bf16 v[144:147], v[40:43], v[96:99], v[144:147]
    s_waitcnt vmcnt(5)
    s_barrier
    v_add_u32 v16, s37, v13
    v_add_u32 v17, s37, v14
    v_add_u32 v18, s37, v15
    s_add_u32 s37, s37, 40960
    s_cmp_ge_u32 s37, 122880
    s_cselect_b32 s37, 0, s37
    ds_read_b128 v[20:23], v16 offset:0
    ds_read_b128 v[24:27], v16 offset:2048
    ds_read_b128 v[28:31], v16 offset:4096
    ds_read_b128 v[32:35], v16 offset:6144
    ds_read_b64_tr_b16 v[52:53], v17 offset:0
    ds_read_b64_tr_b16 v[54:55], v17 offset:512
    ds_read_b64_tr_b16 v[56:57], v18 offset:0
    ds_read_b64_tr_b16 v[58:59], v18 offset:512
    ds_read_b64_tr_b16 v[60:61], v17 offset:8192
    ds_read_b64_tr_b16 v[62:63], v17 offset:8704
    ds_read_b64_tr_b16 v[64:65], v18 offset:8192
    ds_read_b64_tr_b16 v[66:67], v18 offset:8704
    ds_read_b64_tr_b16 v[68:69], v17 offset:16384
    ds_read_b64_tr_b16 v[70:71], v17 offset:16896
    ds_read_b64_tr_b16 v[72:73], v18 offset:16384
    ds_read_b64_tr_b16 v[74:75], v18 offset:16896
    v_mfma_f32_16x16x32_bf16 v[148:151], v[76:79], v[44:47], v[148:151]
    v_mfma_f32_16x16x32_bf16 v[152:155], v[80:83], v[44:47], v[152:155]
    v_mfma_f32_16x16x32_bf16 v[156:159], v[44:47], v[84:87], v[156:159]
    v_mfma_f32_16x16x32_bf16 v[160:163], v[44:47], v[88:91], v[160:163]
    v_mfma_f32_16x16x32_bf16 v[164:167], v[44:47], v[92:95], v[164:167]
    v_mfma_f32_16x16x32_bf16 v[168:171], v[44:47], v[96:99], v[168:171]
    v_mfma_f32_16x16x32_bf16 v[172:175], v[76:79], v[48:51], v[172:175]
    v_mfma_f32_16x16x32_bf16 v[176:179], v[80:83], v[48:51], v[176:179]
    v_mfma_f32_16x16x32_bf16 v[180:183], v[48:51], v[84:87], v[180:183]
    v_mfma_f32_16x16x32_bf16 v[184:187], v[48:51], v[88:91], v[184:187]
    v_mfma_f32_16x16x32_bf16 v[188:191], v[48:51], v[92:95], v[188:191]
    v_mfma_f32_16x16x32_bf16 v[192:195], v[48:51], v[96:99], v[192:195]
    s_waitcnt lgkmcnt(0)
    v_mfma_f32_16x16x32_bf16 v[100:103], v[52:55], v[20:23], v[100:103]
    v_mfma_f32_16x16x32_bf16 v[104:107], v[56:59], v[20:23], v[104:107]
    v_mfma_f32_16x16x32_bf16 v[108:111], v[20:23], v[60:63], v[108:111]
    v_mfma_f32_16x16x32_bf16 v[112:115], v[20:23], v[64:67], v[112:115]
    v_mfma_f32_16x16x32_bf16 v[116:119], v[20:23], v[68:71], v[116:119]
    v_mfma_f32_16x16x32_bf16 v[120:123], v[20:23], v[72:75], v[120:123]
    v_mfma_f32_16x16x32_bf16 v[124:127], v[52:55], v[24:27], v[124:127]
    v_mfma_f32_16x16x32_bf16 v[128:131], v[56:59], v[24:27], v[128:131]
    v_mfma_f32_16x16x32_bf16 v[132:135], v[24:27], v[60:63], v[132:135]
    v_mfma_f32_16x16x32_bf16 v[136:139], v[24:27], v[64:67], v[136:139]
    v_mfma_f32_16x16x32_bf16 v[140:143], v[24:27], v[68:71], v[140:143]
    v_mfma_f32_16x16x32_bf16 v[144:147], v[24:27], v[72:75], v[144:147]
    s_waitcnt vmcnt(0)
    s_barrier
    v_add_u32 v16, s37, v13
    v_add_u32 v17, s37, v14
    v_add_u32 v18, s37, v15
    s_add_u32 s37, s37, 40960
    s_cmp_ge_u32 s37, 122880
    s_cselect_b32 s37, 0, s37
    ds_read_b128 v[36:39], v16 offset:0
    ds_read_b128 v[40:43], v16 offset:2048
    ds_read_b128 v[44:47], v16 offset:4096
    ds_read_b128 v[48:51], v16 offset:6144
    ds_read_b64_tr_b16 v[76:77], v17 offset:0
    ds_read_b64_tr_b16 v[78:79], v17 offset:512
    ds_read_b64_tr_b16 v[80:81], v18 offset:0
    ds_read_b64_tr_b16 v[82:83], v18 offset:512
    ds_read_b64_tr_b16 v[84:85], v17 offset:8192
    ds_read_b64_tr_b16 v[86:87], v17 offset:8704
    ds_read_b64_tr_b16 v[88:89], v18 offset:8192
    ds_read_b64_tr_b16 v[90:91], v18 offset:8704
    ds_read_b64_tr_b16 v[92:93], v17 offset:16384
    ds_read_b64_tr_b16 v[94:95], v17 offset:16896
    ds_read_b64_tr_b16 v[96:97], v18 offset:16384
    ds_read_b64_tr_b16 v[98:99], v18 offset:16896
    v_mfma_f32_16x16x32_bf16 v[148:151], v[52:55], v[28:31], v[148:151]
    v_mfma_f32_16x16x32_bf16 v[152:155], v[56:59], v[28:31], v[152:155]
    v_mfma_f32_16x16x32_bf16 v[156:159], v[28:31], v[60:63], v[156:159]
    v_mfma_f32_16x16x32_bf16 v[160:163], v[28:31], v[64:67], v[160:163]
    v_mfma_f32_16x16x32_bf16 v[164:167], v[28:31], v[68:71], v[164:167]
    v_mfma_f32_16x16x32_bf16 v[168:171], v[28:31], v[72:75], v[168:171]
    v_mfma_f32_16x16x32_bf16 v[172:175], v[52:55], v[32:35], v[172:175]
    v_mfma_f32_16x16x32_bf16 v[176:179], v[56:59], v[32:35], v[176:179]
    v_mfma_f32_16x16x32_bf16 v[180:183], v[32:35], v[60:63], v[180:183]
    v_mfma_f32_16x16x32_bf16 v[184:187], v[32:35], v[64:67], v[184:187]
    v_mfma_f32_16x16x32_bf16 v[188:191], v[32:35], v[68:71], v[188:191]
    v_mfma_f32_16x16x32_bf16 v[192:195], v[32:35], v[72:75], v[192:195]
    s_waitcnt lgkmcnt(0)
    v_mfma_f32_16x16x32_bf16 v[100:103], v[76:79], v[36:39], v[100:103]
    v_mfma_f32_16x16x32_bf16 v[104:107], v[80:83], v[36:39], v[104:107]
    v_mfma_f32_16x16x32_bf16 v[108:111], v[36:39], v[84:87], v[108:111]
    v_mfma_f32_16x16x32_bf16 v[112:115], v[36:39], v[88:91], v[112:115]
    v_mfma_f32_16x16x32_bf16 v[116:119], v[36:39], v[92:95], v[116:119]
    v_mfma_f32_16x16x32_bf16 v[120:123], v[36:39], v[96:99], v[120:123]
    v_mfma_f32_16x16x32_bf16 v[124:127], v[76:79], v[40:43], v[124:127]
    v_mfma_f32_16x16x32_bf16 v[128:131], v[80:83], v[40:43], v[128:131]
    v_mfma_f32_16x16x32_bf16 v[132:135], v[40:43], v[84:87], v[132:135]
    v_mfma_f32_16x16x32_bf16 v[136:139], v[40:43], v[88:91], v[136:139]
    v_mfma_f32_16x16x32_bf16 v[140:143], v[40:43], v[92:95], v[140:143]
    v_mfma_f32_16x16x32_bf16 v[144:147], v[40:43], v[96:99], v[144:147]
    v_mfma_f32_16x16x32_bf16 v[148:151], v[76:79], v[44:47], v[148:151]
    v_mfma_f32_16x16x32_bf16 v[152:155], v[80:83], v[44:47], v[152:155]
    v_mfma_f32_16x16x32_bf16 v[156:159], v[44:47], v[84:87], v[156:159]
    v_mfma_f32_16x16x32_bf16 v[160:163], v[44:47], v[88:91], v[160:163]
    v_mfma_f32_16x16x32_bf16 v[164:167], v[44:47], v[92:95], v[164:167]
    v_mfma_f32_16x16x32_bf16 v[168:171], v[44:47], v[96:99], v[168:171]
    v_mfma_f32_16x16x32_bf16 v[172:175], v[76:79], v[48:51], v[172:175]
    v_mfma_f32_16x16x32_bf16 v[176:179], v[80:83], v[48:51], v[176:179]
    v_mfma_f32_16x16x32_bf16 v[180:183], v[48:51], v[84:87], v[180:183]
    v_mfma_f32_16x16x32_bf16 v[184:187], v[48:51], v[88:91], v[184:187]
    v_mfma_f32_16x16x32_bf16 v[188:191], v[48:51], v[92:95], v[188:191]
    v_mfma_f32_16x16x32_bf16 v[192:195], v[48:51], v[96:99], v[192:195]
    s_waitcnt vmcnt(0) lgkmcnt(0)
    s_barrier
    s_xor_b32 s38, s26, 4
    s_mul_i32 s38, s38, 12288
    v_lshlrev_b32 v2, 4, v1
    v_add_u32 v2, s38, v2
    s_nop 7
    s_cmp_eq_u32 s27, 0
    s_cbranch_scc0 L_give1_qkv_1_kernel
    ds_write_b128 v2, v[148:151] offset:0
    ds_write_b128 v2, v[152:155] offset:1024
    ds_write_b128 v2, v[156:159] offset:2048
    ds_write_b128 v2, v[160:163] offset:3072
    ds_write_b128 v2, v[164:167] offset:4096
    ds_write_b128 v2, v[168:171] offset:5120
    ds_write_b128 v2, v[172:175] offset:6144
    ds_write_b128 v2, v[176:179] offset:7168
    ds_write_b128 v2, v[180:183] offset:8192
    ds_write_b128 v2, v[184:187] offset:9216
    ds_write_b128 v2, v[188:191] offset:10240
    ds_write_b128 v2, v[192:195] offset:11264
    s_branch L_give_done_qkv_1_kernel
L_give1_qkv_1_kernel:
    ds_write_b128 v2, v[100:103] offset:0
    ds_write_b128 v2, v[104:107] offset:1024
    ds_write_b128 v2, v[108:111] offset:2048
    ds_write_b128 v2, v[112:115] offset:3072
    ds_write_b128 v2, v[116:119] offset:4096
    ds_write_b128 v2, v[120:123] offset:5120
    ds_write_b128 v2, v[124:127] offset:6144
    ds_write_b128 v2, v[128:131] offset:7168
    ds_write_b128 v2, v[132:135] offset:8192
    ds_write_b128 v2, v[136:139] offset:9216
    ds_write_b128 v2, v[140:143] offset:10240
    ds_write_b128 v2, v[144:147] offset:11264
L_give_done_qkv_1_kernel:
    s_waitcnt lgkmcnt(0)
    s_barrier
    s_mul_i32 s38, s26, 12288
    v_lshlrev_b32 v2, 4, v1
    v_add_u32 v2, s38, v2
    s_mul_i32 s38, s27, 48
    s_cmp_eq_u32 s27, 0
    s_cbranch_scc0 L_keep1_qkv_1_kernel
    ds_read_b128 v[20:23], v2 offset:0
    ds_read_b128 v[24:27], v2 offset:1024
    ds_read_b128 v[28:31], v2 offset:2048
    ds_read_b128 v[32:35], v2 offset:3072
    ds_read_b128 v[36:39], v2 offset:4096
    ds_read_b128 v[40:43], v2 offset:5120
    ds_read_b128 v[44:47], v2 offset:6144
    ds_read_b128 v[48:51], v2 offset:7168
    ds_read_b128 v[52:55], v2 offset:8192
    ds_read_b128 v[56:59], v2 offset:9216
    ds_read_b128 v[60:63], v2 offset:10240
    ds_read_b128 v[64:67], v2 offset:11264
    s_waitcnt lgkmcnt(0)
    v_add_f32 v20, v100, v20
    v_add_f32 v21, v101, v21
    v_add_f32 v22, v102, v22
    v_add_f32 v23, v103, v23
    v_add_f32 v24, v104, v24
    v_add_f32 v25, v105, v25
    v_add_f32 v26, v106, v26
    v_add_f32 v27, v107, v27
    v_add_f32 v28, v108, v28
    v_add_f32 v29, v109, v29
    v_add_f32 v30, v110, v30
    v_add_f32 v31, v111, v31
    v_add_f32 v32, v112, v32
    v_add_f32 v33, v113, v33
    v_add_f32 v34, v114, v34
    v_add_f32 v35, v115, v35
    v_add_f32 v36, v116, v36
    v_add_f32 v37, v117, v37
    v_add_f32 v38, v118, v38
    v_add_f32 v39, v119, v39
    v_add_f32 v40, v120, v40
    v_add_f32 v41, v121, v41
    v_add_f32 v42, v122, v42
    v_add_f32 v43, v123, v43
    v_add_f32 v44, v124, v44
    v_add_f32 v45, v125, v45
    v_add_f32 v46, v126, v46
    v_add_f32 v47, v127, v47
    v_add_f32 v48, v128, v48
    v_add_f32 v49, v129, v49
    v_add_f32 v50, v130, v50
    v_add_f32 v51, v131, v51
    v_add_f32 v52, v132, v52
    v_add_f32 v53, v133, v53
    v_add_f32 v54, v134, v54
    v_add_f32 v55, v135, v55
    v_add_f32 v56, v136, v56
    v_add_f32 v57, v137, v57
    v_add_f32 v58, v138, v58
    v_add_f32 v59, v139, v59
    v_add_f32 v60, v140, v60
    v_add_f32 v61, v141, v61
    v_add_f32 v62, v142, v62
    v_add_f32 v63, v143, v63
    v_add_f32 v64, v144, v64
    v_add_f32 v65, v145, v65
    v_add_f32 v66, v146, v66
    v_add_f32 v67, v147, v67
    s_branch L_keep_done_qkv_1_kernel
L_keep1_qkv_1_kernel:
    ds_read_b128 v[20:23], v2 offset:0
    ds_read_b128 v[24:27], v2 offset:1024
    ds_read_b128 v[28:31], v2 offset:2048
    ds_read_b128 v[32:35], v2 offset:3072
    ds_read_b128 v[36:39], v2 offset:4096
    ds_read_b128 v[40:43], v2 offset:5120
    ds_read_b128 v[44:47], v2 offset:6144
    ds_read_b128 v[48:51], v2 offset:7168
    ds_read_b128 v[52:55], v2 offset:8192
    ds_read_b128 v[56:59], v2 offset:9216
    ds_read_b128 v[60:63], v2 offset:10240
    ds_read_b128 v[64:67], v2 offset:11264
    s_waitcnt lgkmcnt(0)
    v_add_f32 v20, v148, v20
    v_add_f32 v21, v149, v21
    v_add_f32 v22, v150, v22
    v_add_f32 v23, v151, v23
    v_add_f32 v24, v152, v24
    v_add_f32 v25, v153, v25
    v_add_f32 v26, v154, v26
    v_add_f32 v27, v155, v27
    v_add_f32 v28, v156, v28
    v_add_f32 v29, v157, v29
    v_add_f32 v30, v158, v30
    v_add_f32 v31, v159, v31
    v_add_f32 v32, v160, v32
    v_add_f32 v33, v161, v33
    v_add_f32 v34, v162, v34
    v_add_f32 v35, v163, v35
    v_add_f32 v36, v164, v36
    v_add_f32 v37, v165, v37
    v_add_f32 v38, v166, v38
    v_add_f32 v39, v167, v39
    v_add_f32 v40, v168, v40
    v_add_f32 v41, v169, v41
    v_add_f32 v42, v170, v42
    v_add_f32 v43, v171, v43
    v_add_f32 v44, v172, v44
    v_add_f32 v45, v173, v45
    v_add_f32 v46, v174, v46
    v_add_f32 v47, v175, v47
    v_add_f32 v48, v176, v48
    v_add_f32 v49, v177, v49
    v_add_f32 v50, v178, v50
    v_add_f32 v51, v179, v51
    v_add_f32 v52, v180, v52
    v_add_f32 v53, v181, v53
    v_add_f32 v54, v182, v54
    v_add_f32 v55, v183, v55
    v_add_f32 v56, v184, v56
    v_add_f32 v57, v185, v57
    v_add_f32 v58, v186, v58
    v_add_f32 v59, v187, v59
    v_add_f32 v60, v188, v60
    v_add_f32 v61, v189, v61
    v_add_f32 v62, v190, v62
    v_add_f32 v63, v191, v63
    v_add_f32 v64, v192, v64
    v_add_f32 v65, v193, v65
    v_add_f32 v66, v194, v66
    v_add_f32 v67, v195, v67
L_keep_done_qkv_1_kernel:
    s_add_u32 s12, s50, 4194304
    s_addc_u32 s13, s51, 0
    s_mov_b32 s14, 4194304
    s_mov_b32 s15, 0x00020000
    v_and_b32 v2, 15, v1
    s_lshl_b32 s38, s24, 7
    s_lshl_b32 s39, s28, 6
    s_add_u32 s38, s38, s39
    s_lshl_b32 s39, s27, 5
    s_add_u32 s38, s38, s39
    v_add_u32 v2, s38, v2
    v_lshlrev_b32 v2, 11, v2
    v_lshrrev_b32 v3, 4, v1
    v_lshlrev_b32 v3, 3, v3
    s_lshl_b32 s38, s25, 1
    s_add_u32 s38, s38, s29
    s_lshl_b32 s38, s38, 6
    v_add3_u32 v2, v2, v3, s38
    v_cvt_pk_bf16_f32 v68, v20, v21
    v_lshlrev_b32 v20, 16, v68
    v_and_b32 v21, 0xffff0000, v68
    v_cvt_pk_bf16_f32 v68, v22, v23
    v_lshlrev_b32 v22, 16, v68
    v_and_b32 v23, 0xffff0000, v68
    v_mul_f32 v68, 0x3fb8aa3b, v20
    v_mul_f32 v69, 0x3fb8aa3b, v21
    v_mul_f32 v70, 0x3fb8aa3b, v22
    v_mul_f32 v71, 0x3fb8aa3b, v23
    v_exp_f32 v68, v68
    v_exp_f32 v69, v69
    v_exp_f32 v70, v70
    v_exp_f32 v71, v71
    v_cmp_lt_f32 vcc, 0, v20
    v_add_f32 v20, 1.0, v20
    s_nop 0
    v_cndmask_b32 v20, v68, v20, vcc
    v_cmp_lt_f32 vcc, 0, v21
    v_add_f32 v21, 1.0, v21
    s_nop 0
    v_cndmask_b32 v21, v69, v21, vcc
    v_cmp_lt_f32 vcc, 0, v22
    v_add_f32 v22, 1.0, v22
    s_nop 0
    v_cndmask_b32 v22, v70, v22, vcc
    v_cmp_lt_f32 vcc, 0, v23
    v_add_f32 v23, 1.0, v23
    s_nop 0
    v_cndmask_b32 v23, v71, v23, vcc
    v_cvt_pk_bf16_f32 v68, v20, v21
    v_lshlrev_b32 v20, 16, v68
    v_and_b32 v21, 0xffff0000, v68
    v_cvt_pk_bf16_f32 v68, v22, v23
    v_lshlrev_b32 v22, 16, v68
    v_and_b32 v23, 0xffff0000, v68
    v_add_f32 v20, 0x358637bd, v20
    v_add_f32 v21, 0x358637bd, v21
    v_add_f32 v22, 0x358637bd, v22
    v_add_f32 v23, 0x358637bd, v23
    v_cvt_pk_bf16_f32 v4, v20, v21
    v_cvt_pk_bf16_f32 v5, v22, v23
    s_mov_b32 s39, 0
    buffer_store_dwordx2 v[4:5], v2, s[12:15], s39 offen offset:0
    v_cvt_pk_bf16_f32 v68, v24, v25
    v_lshlrev_b32 v24, 16, v68
    v_and_b32 v25, 0xffff0000, v68
    v_cvt_pk_bf16_f32 v68, v26, v27
    v_lshlrev_b32 v26, 16, v68
    v_and_b32 v27, 0xffff0000, v68
    v_mul_f32 v68, 0x3fb8aa3b, v24
    v_mul_f32 v69, 0x3fb8aa3b, v25
    v_mul_f32 v70, 0x3fb8aa3b, v26
    v_mul_f32 v71, 0x3fb8aa3b, v27
    v_exp_f32 v68, v68
    v_exp_f32 v69, v69
    v_exp_f32 v70, v70
    v_exp_f32 v71, v71
    v_cmp_lt_f32 vcc, 0, v24
    v_add_f32 v24, 1.0, v24
    s_nop 0
    v_cndmask_b32 v24, v68, v24, vcc
    v_cmp_lt_f32 vcc, 0, v25
    v_add_f32 v25, 1.0, v25
    s_nop 0
    v_cndmask_b32 v25, v69, v25, vcc
    v_cmp_lt_f32 vcc, 0, v26
    v_add_f32 v26, 1.0, v26
    s_nop 0
    v_cndmask_b32 v26, v70, v26, vcc
    v_cmp_lt_f32 vcc, 0, v27
    v_add_f32 v27, 1.0, v27
    s_nop 0
    v_cndmask_b32 v27, v71, v27, vcc
    v_cvt_pk_bf16_f32 v68, v24, v25
    v_lshlrev_b32 v24, 16, v68
    v_and_b32 v25, 0xffff0000, v68
    v_cvt_pk_bf16_f32 v68, v26, v27
    v_lshlrev_b32 v26, 16, v68
    v_and_b32 v27, 0xffff0000, v68
    v_add_f32 v24, 0x358637bd, v24
    v_add_f32 v25, 0x358637bd, v25
    v_add_f32 v26, 0x358637bd, v26
    v_add_f32 v27, 0x358637bd, v27
    v_cvt_pk_bf16_f32 v4, v24, v25
    v_cvt_pk_bf16_f32 v5, v26, v27
    s_mov_b32 s39, 0
    buffer_store_dwordx2 v[4:5], v2, s[12:15], s39 offen offset:32
    v_cvt_pk_bf16_f32 v68, v44, v45
    v_lshlrev_b32 v44, 16, v68
    v_and_b32 v45, 0xffff0000, v68
    v_cvt_pk_bf16_f32 v68, v46, v47
    v_lshlrev_b32 v46, 16, v68
    v_and_b32 v47, 0xffff0000, v68
    v_mul_f32 v68, 0x3fb8aa3b, v44
    v_mul_f32 v69, 0x3fb8aa3b, v45
    v_mul_f32 v70, 0x3fb8aa3b, v46
    v_mul_f32 v71, 0x3fb8aa3b, v47
    v_exp_f32 v68, v68
    v_exp_f32 v69, v69
    v_exp_f32 v70, v70
    v_exp_f32 v71, v71
    v_cmp_lt_f32 vcc, 0, v44
    v_add_f32 v44, 1.0, v44
    s_nop 0
    v_cndmask_b32 v44, v68, v44, vcc
    v_cmp_lt_f32 vcc, 0, v45
    v_add_f32 v45, 1.0, v45
    s_nop 0
    v_cndmask_b32 v45, v69, v45, vcc
    v_cmp_lt_f32 vcc, 0, v46
    v_add_f32 v46, 1.0, v46
    s_nop 0
    v_cndmask_b32 v46, v70, v46, vcc
    v_cmp_lt_f32 vcc, 0, v47
    v_add_f32 v47, 1.0, v47
    s_nop 0
    v_cndmask_b32 v47, v71, v47, vcc
    v_cvt_pk_bf16_f32 v68, v44, v45
    v_lshlrev_b32 v44, 16, v68
    v_and_b32 v45, 0xffff0000, v68
    v_cvt_pk_bf16_f32 v68, v46, v47
    v_lshlrev_b32 v46, 16, v68
    v_and_b32 v47, 0xffff0000, v68
    v_add_f32 v44, 0x358637bd, v44
    v_add_f32 v45, 0x358637bd, v45
    v_add_f32 v46, 0x358637bd, v46
    v_add_f32 v47, 0x358637bd, v47
    v_cvt_pk_bf16_f32 v4, v44, v45
    v_cvt_pk_bf16_f32 v5, v46, v47
    s_mov_b32 s39, 32768
    buffer_store_dwordx2 v[4:5], v2, s[12:15], s39 offen offset:0
    v_cvt_pk_bf16_f32 v68, v48, v49
    v_lshlrev_b32 v48, 16, v68
    v_and_b32 v49, 0xffff0000, v68
    v_cvt_pk_bf16_f32 v68, v50, v51
    v_lshlrev_b32 v50, 16, v68
    v_and_b32 v51, 0xffff0000, v68
    v_mul_f32 v68, 0x3fb8aa3b, v48
    v_mul_f32 v69, 0x3fb8aa3b, v49
    v_mul_f32 v70, 0x3fb8aa3b, v50
    v_mul_f32 v71, 0x3fb8aa3b, v51
    v_exp_f32 v68, v68
    v_exp_f32 v69, v69
    v_exp_f32 v70, v70
    v_exp_f32 v71, v71
    v_cmp_lt_f32 vcc, 0, v48
    v_add_f32 v48, 1.0, v48
    s_nop 0
    v_cndmask_b32 v48, v68, v48, vcc
    v_cmp_lt_f32 vcc, 0, v49
    v_add_f32 v49, 1.0, v49
    s_nop 0
    v_cndmask_b32 v49, v69, v49, vcc
    v_cmp_lt_f32 vcc, 0, v50
    v_add_f32 v50, 1.0, v50
    s_nop 0
    v_cndmask_b32 v50, v70, v50, vcc
    v_cmp_lt_f32 vcc, 0, v51
    v_add_f32 v51, 1.0, v51
    s_nop 0
    v_cndmask_b32 v51, v71, v51, vcc
    v_cvt_pk_bf16_f32 v68, v48, v49
    v_lshlrev_b32 v48, 16, v68
    v_and_b32 v49, 0xffff0000, v68
    v_cvt_pk_bf16_f32 v68, v50, v51
    v_lshlrev_b32 v50, 16, v68
    v_and_b32 v51, 0xffff0000, v68
    v_add_f32 v48, 0x358637bd, v48
    v_add_f32 v49, 0x358637bd, v49
    v_add_f32 v50, 0x358637bd, v50
    v_add_f32 v51, 0x358637bd, v51
    v_cvt_pk_bf16_f32 v4, v48, v49
    v_cvt_pk_bf16_f32 v5, v50, v51
    s_mov_b32 s39, 32768
    buffer_store_dwordx2 v[4:5], v2, s[12:15], s39 offen offset:32
    v_cvt_pk_bf16_f32 v68, v28, v29
    v_lshlrev_b32 v28, 16, v68
    v_and_b32 v29, 0xffff0000, v68
    v_cvt_pk_bf16_f32 v68, v30, v31
    v_lshlrev_b32 v30, 16, v68
    v_and_b32 v31, 0xffff0000, v68
    v_mul_f32 v68, 0x3fb8aa3b, v28
    v_mul_f32 v69, 0x3fb8aa3b, v29
    v_mul_f32 v70, 0x3fb8aa3b, v30
    v_mul_f32 v71, 0x3fb8aa3b, v31
    v_exp_f32 v68, v68
    v_exp_f32 v69, v69
    v_exp_f32 v70, v70
    v_exp_f32 v71, v71
    v_cmp_lt_f32 vcc, 0, v28
    v_add_f32 v28, 1.0, v28
    s_nop 0
    v_cndmask_b32 v28, v68, v28, vcc
    v_cmp_lt_f32 vcc, 0, v29
    v_add_f32 v29, 1.0, v29
    s_nop 0
    v_cndmask_b32 v29, v69, v29, vcc
    v_cmp_lt_f32 vcc, 0, v30
    v_add_f32 v30, 1.0, v30
    s_nop 0
    v_cndmask_b32 v30, v70, v30, vcc
    v_cmp_lt_f32 vcc, 0, v31
    v_add_f32 v31, 1.0, v31
    s_nop 0
    v_cndmask_b32 v31, v71, v31, vcc
    v_cvt_pk_bf16_f32 v68, v28, v29
    v_lshlrev_b32 v28, 16, v68
    v_and_b32 v29, 0xffff0000, v68
    v_cvt_pk_bf16_f32 v68, v30, v31
    v_lshlrev_b32 v30, 16, v68
    v_and_b32 v31, 0xffff0000, v68
    v_add_f32 v28, 0x358637bd, v28
    v_add_f32 v29, 0x358637bd, v29
    v_add_f32 v30, 0x358637bd, v30
    v_add_f32 v31, 0x358637bd, v31
    v_cvt_pk_bf16_f32 v76, v28, v29
    v_cvt_pk_bf16_f32 v77, v30, v31
    v_cvt_pk_bf16_f32 v84, v36, v37
    v_cvt_pk_bf16_f32 v85, v38, v39
    v_cvt_pk_bf16_f32 v68, v52, v53
    v_lshlrev_b32 v52, 16, v68
    v_and_b32 v53, 0xffff0000, v68
    v_cvt_pk_bf16_f32 v68, v54, v55
    v_lshlrev_b32 v54, 16, v68
    v_and_b32 v55, 0xffff0000, v68
    v_mul_f32 v68, 0x3fb8aa3b, v52
    v_mul_f32 v69, 0x3fb8aa3b, v53
    v_mul_f32 v70, 0x3fb8aa3b, v54
    v_mul_f32 v71, 0x3fb8aa3b, v55
    v_exp_f32 v68, v68
    v_exp_f32 v69, v69
    v_exp_f32 v70, v70
    v_exp_f32 v71, v71
    v_cmp_lt_f32 vcc, 0, v52
    v_add_f32 v52, 1.0, v52
    s_nop 0
    v_cndmask_b32 v52, v68, v52, vcc
    v_cmp_lt_f32 vcc, 0, v53
    v_add_f32 v53, 1.0, v53
    s_nop 0
    v_cndmask_b32 v53, v69, v53, vcc
    v_cmp_lt_f32 vcc, 0, v54
    v_add_f32 v54, 1.0, v54
    s_nop 0
    v_cndmask_b32 v54, v70, v54, vcc
    v_cmp_lt_f32 vcc, 0, v55
    v_add_f32 v55, 1.0, v55
    s_nop 0
    v_cndmask_b32 v55, v71, v55, vcc
    v_cvt_pk_bf16_f32 v68, v52, v53
    v_lshlrev_b32 v52, 16, v68
    v_and_b32 v53, 0xffff0000, v68
    v_cvt_pk_bf16_f32 v68, v54, v55
    v_lshlrev_b32 v54, 16, v68
    v_and_b32 v55, 0xffff0000, v68
    v_add_f32 v52, 0x358637bd, v52
    v_add_f32 v53, 0x358637bd, v53
    v_add_f32 v54, 0x358637bd, v54
    v_add_f32 v55, 0x358637bd, v55
    v_cvt_pk_bf16_f32 v78, v52, v53
    v_cvt_pk_bf16_f32 v79, v54, v55
    v_cvt_pk_bf16_f32 v86, v60, v61
    v_cvt_pk_bf16_f32 v87, v62, v63
    v_cvt_pk_bf16_f32 v68, v32, v33
    v_lshlrev_b32 v32, 16, v68
    v_and_b32 v33, 0xffff0000, v68
    v_cvt_pk_bf16_f32 v68, v34, v35
    v_lshlrev_b32 v34, 16, v68
    v_and_b32 v35, 0xffff0000, v68
    v_mul_f32 v68, 0x3fb8aa3b, v32
    v_mul_f32 v69, 0x3fb8aa3b, v33
    v_mul_f32 v70, 0x3fb8aa3b, v34
    v_mul_f32 v71, 0x3fb8aa3b, v35
    v_exp_f32 v68, v68
    v_exp_f32 v69, v69
    v_exp_f32 v70, v70
    v_exp_f32 v71, v71
    v_cmp_lt_f32 vcc, 0, v32
    v_add_f32 v32, 1.0, v32
    s_nop 0
    v_cndmask_b32 v32, v68, v32, vcc
    v_cmp_lt_f32 vcc, 0, v33
    v_add_f32 v33, 1.0, v33
    s_nop 0
    v_cndmask_b32 v33, v69, v33, vcc
    v_cmp_lt_f32 vcc, 0, v34
    v_add_f32 v34, 1.0, v34
    s_nop 0
    v_cndmask_b32 v34, v70, v34, vcc
    v_cmp_lt_f32 vcc, 0, v35
    v_add_f32 v35, 1.0, v35
    s_nop 0
    v_cndmask_b32 v35, v71, v35, vcc
    v_cvt_pk_bf16_f32 v68, v32, v33
    v_lshlrev_b32 v32, 16, v68
    v_and_b32 v33, 0xffff0000, v68
    v_cvt_pk_bf16_f32 v68, v34, v35
    v_lshlrev_b32 v34, 16, v68
    v_and_b32 v35, 0xffff0000, v68
    v_add_f32 v32, 0x358637bd, v32
    v_add_f32 v33, 0x358637bd, v33
    v_add_f32 v34, 0x358637bd, v34
    v_add_f32 v35, 0x358637bd, v35
    v_cvt_pk_bf16_f32 v80, v32, v33
    v_cvt_pk_bf16_f32 v81, v34, v35
    v_cvt_pk_bf16_f32 v88, v40, v41
    v_cvt_pk_bf16_f32 v89, v42, v43
    v_cvt_pk_bf16_f32 v68, v56, v57
    v_lshlrev_b32 v56, 16, v68
    v_and_b32 v57, 0xffff0000, v68
    v_cvt_pk_bf16_f32 v68, v58, v59
    v_lshlrev_b32 v58, 16, v68
    v_and_b32 v59, 0xffff0000, v68
    v_mul_f32 v68, 0x3fb8aa3b, v56
    v_mul_f32 v69, 0x3fb8aa3b, v57
    v_mul_f32 v70, 0x3fb8aa3b, v58
    v_mul_f32 v71, 0x3fb8aa3b, v59
    v_exp_f32 v68, v68
    v_exp_f32 v69, v69
    v_exp_f32 v70, v70
    v_exp_f32 v71, v71
    v_cmp_lt_f32 vcc, 0, v56
    v_add_f32 v56, 1.0, v56
    s_nop 0
    v_cndmask_b32 v56, v68, v56, vcc
    v_cmp_lt_f32 vcc, 0, v57
    v_add_f32 v57, 1.0, v57
    s_nop 0
    v_cndmask_b32 v57, v69, v57, vcc
    v_cmp_lt_f32 vcc, 0, v58
    v_add_f32 v58, 1.0, v58
    s_nop 0
    v_cndmask_b32 v58, v70, v58, vcc
    v_cmp_lt_f32 vcc, 0, v59
    v_add_f32 v59, 1.0, v59
    s_nop 0
    v_cndmask_b32 v59, v71, v59, vcc
    v_cvt_pk_bf16_f32 v68, v56, v57
    v_lshlrev_b32 v56, 16, v68
    v_and_b32 v57, 0xffff0000, v68
    v_cvt_pk_bf16_f32 v68, v58, v59
    v_lshlrev_b32 v58, 16, v68
    v_and_b32 v59, 0xffff0000, v68
    v_add_f32 v56, 0x358637bd, v56
    v_add_f32 v57, 0x358637bd, v57
    v_add_f32 v58, 0x358637bd, v58
    v_add_f32 v59, 0x358637bd, v59
    v_cvt_pk_bf16_f32 v82, v56, v57
    v_cvt_pk_bf16_f32 v83, v58, v59
    v_cvt_pk_bf16_f32 v90, v64, v65
    v_cvt_pk_bf16_f32 v91, v66, v67
    v_mov_b32 v92, 0x3f803f80
    v_mov_b32 v93, 0x3f803f80
    v_mov_b32 v94, 0x3f803f80
    v_mov_b32 v95, 0x3f803f80
    v_mov_b32 v96, 0
    v_mov_b32 v97, 0
    v_mov_b32 v98, 0
    v_mov_b32 v99, 0
    v_mov_b32 v100, 0
    v_mov_b32 v101, 0
    v_mov_b32 v102, 0
    v_mov_b32 v103, 0
    v_mov_b32 v104, 0
    v_mov_b32 v105, 0
    v_mov_b32 v106, 0
    v_mov_b32 v107, 0
    v_mov_b32 v108, 0
    v_mov_b32 v109, 0
    v_mov_b32 v110, 0
    v_mov_b32 v111, 0
    v_mov_b32 v112, 0
    v_mov_b32 v113, 0
    v_mov_b32 v114, 0
    v_mov_b32 v115, 0
    v_mov_b32 v116, 0
    v_mov_b32 v117, 0
    v_mov_b32 v118, 0
    v_mov_b32 v119, 0
    s_nop 1
    v_mfma_f32_16x16x32_bf16 v[96:99], v[76:79], v[84:87], v[96:99]
    v_mfma_f32_16x16x32_bf16 v[100:103], v[76:79], v[88:91], v[100:103]
    v_mfma_f32_16x16x32_bf16 v[112:115], v[76:79], v[92:95], v[112:115]
    v_mfma_f32_16x16x32_bf16 v[104:107], v[80:83], v[84:87], v[104:107]
    v_mfma_f32_16x16x32_bf16 v[108:111], v[80:83], v[88:91], v[108:111]
    v_mfma_f32_16x16x32_bf16 v[116:119], v[80:83], v[92:95], v[116:119]
    s_barrier
    s_mul_i32 s38, s26, 6144
    v_lshlrev_b32 v3, 4, v1
    v_add_u32 v3, s38, v3
    s_nop 7
    ds_write_b128 v3, v[96:99] offset:0
    ds_write_b128 v3, v[100:103] offset:1024
    ds_write_b128 v3, v[104:107] offset:2048
    ds_write_b128 v3, v[108:111] offset:3072
    ds_write_b128 v3, v[112:115] offset:4096
    ds_write_b128 v3, v[116:119] offset:5120
    s_waitcnt lgkmcnt(0)
    s_barrier
    s_lshl_b32 s38, s28, 1
    s_add_u32 s38, s38, s27
    s_lshl_b32 s39, s29, 1
    s_mul_i32 s39, s39, 6144
    s_lshl_b32 s40, s38, 10
    s_add_u32 s39, s39, s40
    v_lshlrev_b32 v3, 4, v1
    v_add_u32 v3, s39, v3
    s_add_u32 s16, s50, 42078208
    s_addc_u32 s17, s51, 0
    s_mov_b32 s18, 135168
    s_mov_b32 s19, 0x00020000
    s_lshl_b32 s40, s25, 1
    s_add_u32 s40, s40, s29
    s_mul_i32 s40, s40, 4224
    v_lshrrev_b32 v4, 4, v1
    v_lshlrev_b32 v4, 9, v4
    v_and_b32 v5, 15, v1
    v_lshlrev_b32 v5, 2, v5
    v_add_u32 v4, v4, v5
    s_lshr_b32 s41, s38, 1
    s_lshl_b32 s41, s41, 11
    s_add_u32 s40, s40, s41
    s_and_b32 s41, s38, 1
    s_lshl_b32 s41, s41, 6
    s_add_u32 s41, s40, s41
    v_add_u32 v4, s41, v4
    ds_read_b128 v[96:99], v3 offset:0
    ds_read_b128 v[100:103], v3 offset:6144
    ds_read_b128 v[104:107], v3 offset:24576
    ds_read_b128 v[108:111], v3 offset:30720
    s_waitcnt lgkmcnt(0)
    v_add_f32 v96, v96, v100
    v_add_f32 v104, v104, v108
    v_add_f32 v96, v96, v104
    v_add_f32 v97, v97, v101
    v_add_f32 v105, v105, v109
    v_add_f32 v97, v97, v105
    v_add_f32 v98, v98, v102
    v_add_f32 v106, v106, v110
    v_add_f32 v98, v98, v106
    v_add_f32 v99, v99, v103
    v_add_f32 v107, v107, v111
    v_add_f32 v99, v99, v107
    buffer_atomic_add_f32 v96, v4, s[16:19], 0 offen offset:0
    buffer_atomic_add_f32 v97, v4, s[16:19], 0 offen offset:128
    buffer_atomic_add_f32 v98, v4, s[16:19], 0 offen offset:256
    buffer_atomic_add_f32 v99, v4, s[16:19], 0 offen offset:384
    s_cmp_ge_u32 s38, 2
    s_cbranch_scc1 L_at_done_qkv_1_kernel
    ds_read_b128 v[96:99], v3 offset:4096
    ds_read_b128 v[100:103], v3 offset:10240
    ds_read_b128 v[104:107], v3 offset:28672
    ds_read_b128 v[108:111], v3 offset:34816
    s_lshl_b32 s41, s38, 6
    s_add_u32 s41, s41, s40
    s_add_u32 s41, s41, 4096
    v_lshrrev_b32 v4, 4, v1
    v_lshlrev_b32 v4, 4, v4
    v_add_u32 v4, s41, v4
    s_waitcnt lgkmcnt(0)
    v_add_f32 v96, v96, v100
    v_add_f32 v104, v104, v108
    v_add_f32 v96, v96, v104
    v_add_f32 v97, v97, v101
    v_add_f32 v105, v105, v109
    v_add_f32 v97, v97, v105
    v_add_f32 v98, v98, v102
    v_add_f32 v106, v106, v110
    v_add_f32 v98, v98, v106
    v_add_f32 v99, v99, v103
    v_add_f32 v107, v107, v111
    v_add_f32 v99, v99, v107
    v_and_b32 v5, 15, v1
    v_cmp_eq_u32 vcc, 0, v5
    s_and_saveexec_b64 s[42:43], vcc
    buffer_atomic_add_f32 v96, v4, s[16:19], 0 offen offset:0
    buffer_atomic_add_f32 v97, v4, s[16:19], 0 offen offset:4
    buffer_atomic_add_f32 v98, v4, s[16:19], 0 offen offset:8
    buffer_atomic_add_f32 v99, v4, s[16:19], 0 offen offset:12
    s_mov_b64 exec, s[42:43]
L_at_done_qkv_1_kernel:
    s_waitcnt vmcnt(0)
    s_waitcnt vmcnt(0)
L_end_qkv_1_kernel:
    s_endpgm
.globl o_1_kernel
.p2align 8
.type o_1_kernel,@function
o_1_kernel:
    s_cmp_ge_u32 s2, 256
    s_cbranch_scc1 L_end_o_1_kernel
    s_load_dwordx2 s[6:7], s[0:1], 80
    v_lshrrev_b32 v2, 6, v0
    v_and_b32 v1, 63, v0
    s_nop 0
    v_readfirstlane_b32 s3, v2
    s_lshl_b32 s4, s2, 2
    s_add_u32 s4, s4, s3
    s_and_b32 s5, s4, 31
    s_lshr_b32 s4, s4, 5
    s_waitcnt lgkmcnt(0)
    s_add_u32 s8, s6, 4194304
    s_addc_u32 s9, s7, 0
    s_mov_b32 s10, 4194304
    s_mov_b32 s11, 0x00020000
    s_add_u32 s12, s6, 8388608
    s_addc_u32 s13, s7, 0
    s_mov_b32 s14, 4194304
    s_mov_b32 s15, 0x00020000
    s_add_u32 s16, s6, 42078208
    s_addc_u32 s17, s7, 0
    s_mov_b32 s18, 135168
    s_mov_b32 s19, 0x00020000
    v_and_b32 v2, 15, v1
    s_lshl_b32 s20, s4, 6
    v_add_u32 v2, s20, v2
    v_lshlrev_b32 v2, 11, v2
    v_lshrrev_b32 v3, 4, v1
    v_lshlrev_b32 v4, 4, v3
    s_lshl_b32 s20, s5, 6
    v_add3_u32 v2, v2, v4, s20
    s_mov_b32 s21, 0
    buffer_load_dwordx4 v[20:23], v2, s[8:11], s21 offen
    s_mov_b32 s21, 32768
    buffer_load_dwordx4 v[24:27], v2, s[8:11], s21 offen
    s_mov_b32 s21, 65536
    buffer_load_dwordx4 v[28:31], v2, s[8:11], s21 offen
    s_mov_b32 s21, 98304
    buffer_load_dwordx4 v[32:35], v2, s[8:11], s21 offen
    s_mul_i32 s20, s5, 4224
    v_lshlrev_b32 v4, 10, v3
    v_and_b32 v5, 15, v1
    v_lshlrev_b32 v5, 2, v5
    v_add3_u32 v4, v4, v5, s20
    buffer_load_dword v40, v4, s[16:19], 0 offen offset:0
    buffer_load_dword v41, v4, s[16:19], 0 offen offset:128
    buffer_load_dword v42, v4, s[16:19], 0 offen offset:256
    buffer_load_dword v43, v4, s[16:19], 0 offen offset:384
    buffer_load_dword v44, v4, s[16:19], 0 offen offset:512
    buffer_load_dword v45, v4, s[16:19], 0 offen offset:640
    buffer_load_dword v46, v4, s[16:19], 0 offen offset:768
    buffer_load_dword v47, v4, s[16:19], 0 offen offset:896
    buffer_load_dword v48, v4, s[16:19], 0 offen offset:64
    buffer_load_dword v49, v4, s[16:19], 0 offen offset:192
    buffer_load_dword v50, v4, s[16:19], 0 offen offset:320
    buffer_load_dword v51, v4, s[16:19], 0 offen offset:448
    buffer_load_dword v52, v4, s[16:19], 0 offen offset:576
    buffer_load_dword v53, v4, s[16:19], 0 offen offset:704
    buffer_load_dword v54, v4, s[16:19], 0 offen offset:832
    buffer_load_dword v55, v4, s[16:19], 0 offen offset:960
    v_lshlrev_b32 v5, 5, v3
    v_add_u32 v5, s20, v5
    v_add_u32 v5, 0x1000, v5
    buffer_load_dword v56, v5, s[16:19], 0 offen offset:0
    buffer_load_dword v57, v5, s[16:19], 0 offen offset:4
    buffer_load_dword v58, v5, s[16:19], 0 offen offset:8
    buffer_load_dword v59, v5, s[16:19], 0 offen offset:12
    buffer_load_dword v60, v5, s[16:19], 0 offen offset:16
    buffer_load_dword v61, v5, s[16:19], 0 offen offset:20
    buffer_load_dword v62, v5, s[16:19], 0 offen offset:24
    buffer_load_dword v63, v5, s[16:19], 0 offen offset:28
    v_accvgpr_write_b32 a0, 0
    v_accvgpr_write_b32 a1, 0
    v_accvgpr_write_b32 a2, 0
    v_accvgpr_write_b32 a3, 0
    v_accvgpr_write_b32 a4, 0
    v_accvgpr_write_b32 a5, 0
    v_accvgpr_write_b32 a6, 0
    v_accvgpr_write_b32 a7, 0
    v_accvgpr_write_b32 a8, 0
    v_accvgpr_write_b32 a9, 0
    v_accvgpr_write_b32 a10, 0
    v_accvgpr_write_b32 a11, 0
    v_accvgpr_write_b32 a12, 0
    v_accvgpr_write_b32 a13, 0
    v_accvgpr_write_b32 a14, 0
    v_accvgpr_write_b32 a15, 0
    v_accvgpr_write_b32 a16, 0
    v_accvgpr_write_b32 a17, 0
    v_accvgpr_write_b32 a18, 0
    v_accvgpr_write_b32 a19, 0
    v_accvgpr_write_b32 a20, 0
    v_accvgpr_write_b32 a21, 0
    v_accvgpr_write_b32 a22, 0
    v_accvgpr_write_b32 a23, 0
    v_accvgpr_write_b32 a24, 0
    v_accvgpr_write_b32 a25, 0
    v_accvgpr_write_b32 a26, 0
    v_accvgpr_write_b32 a27, 0
    v_accvgpr_write_b32 a28, 0
    v_accvgpr_write_b32 a29, 0
    v_accvgpr_write_b32 a30, 0
    v_accvgpr_write_b32 a31, 0
    v_accvgpr_write_b32 a32, 0
    v_accvgpr_write_b32 a33, 0
    v_accvgpr_write_b32 a34, 0
    v_accvgpr_write_b32 a35, 0
    v_accvgpr_write_b32 a36, 0
    v_accvgpr_write_b32 a37, 0
    v_accvgpr_write_b32 a38, 0
    v_accvgpr_write_b32 a39, 0
    v_accvgpr_write_b32 a40, 0
    v_accvgpr_write_b32 a41, 0
    v_accvgpr_write_b32 a42, 0
    v_accvgpr_write_b32 a43, 0
    v_accvgpr_write_b32 a44, 0
    v_accvgpr_write_b32 a45, 0
    v_accvgpr_write_b32 a46, 0
    v_accvgpr_write_b32 a47, 0
    s_waitcnt vmcnt(0)
    v_cvt_pk_bf16_f32 v64, v40, v41
    v_cvt_pk_bf16_f32 v65, v42, v43
    v_cvt_pk_bf16_f32 v66, v44, v45
    v_cvt_pk_bf16_f32 v67, v46, v47
    v_cvt_pk_bf16_f32 v68, v48, v49
    v_cvt_pk_bf16_f32 v69, v50, v51
    v_cvt_pk_bf16_f32 v70, v52, v53
    v_cvt_pk_bf16_f32 v71, v54, v55
    v_cvt_pk_bf16_f32 v72, v56, v57
    v_cvt_pk_bf16_f32 v73, v58, v59
    v_cvt_pk_bf16_f32 v74, v60, v61
    v_cvt_pk_bf16_f32 v75, v62, v63
    s_nop 1
    v_mfma_f32_16x16x32_bf16 a[0:3], v[64:67], v[20:23], a[0:3]
    v_mfma_f32_16x16x32_bf16 a[4:7], v[68:71], v[20:23], a[4:7]
    v_mfma_f32_16x16x32_bf16 a[8:11], v[72:75], v[20:23], a[8:11]
    v_mfma_f32_16x16x32_bf16 a[12:15], v[64:67], v[24:27], a[12:15]
    v_mfma_f32_16x16x32_bf16 a[16:19], v[68:71], v[24:27], a[16:19]
    v_mfma_f32_16x16x32_bf16 a[20:23], v[72:75], v[24:27], a[20:23]
    v_mfma_f32_16x16x32_bf16 a[24:27], v[64:67], v[28:31], a[24:27]
    v_mfma_f32_16x16x32_bf16 a[28:31], v[68:71], v[28:31], a[28:31]
    v_mfma_f32_16x16x32_bf16 a[32:35], v[72:75], v[28:31], a[32:35]
    v_mfma_f32_16x16x32_bf16 a[36:39], v[64:67], v[32:35], a[36:39]
    v_mfma_f32_16x16x32_bf16 a[40:43], v[68:71], v[32:35], a[40:43]
    v_mfma_f32_16x16x32_bf16 a[44:47], v[72:75], v[32:35], a[44:47]
    s_nop 7
    s_nop 7
    v_lshlrev_b32 v4, 3, v3
    v_and_b32 v2, 15, v1
    s_lshl_b32 s20, s4, 6
    v_add_u32 v2, s20, v2
    v_lshlrev_b32 v2, 11, v2
    s_lshl_b32 s20, s5, 6
    v_add3_u32 v2, v2, v4, s20
    v_accvgpr_read_b32 v40, a8
    s_nop 0
    v_mov_b32 v41, v40
    v_cvt_pk_bf16_f32 v42, v40, v41
    v_lshlrev_b32 v40, 16, v42
    v_and_b32 v41, 0xffff0000, v42
    v_add_f32 v40, 0x358637bd, v40
    v_mov_b32 v41, v40
    v_cvt_pk_bf16_f32 v42, v40, v41
    v_lshlrev_b32 v40, 16, v42
    v_and_b32 v41, 0xffff0000, v42
    v_rcp_f32 v40, v40
    v_accvgpr_read_b32 v44, a0
    v_accvgpr_read_b32 v45, a1
    v_accvgpr_read_b32 v46, a2
    v_accvgpr_read_b32 v47, a3
    s_nop 0
    v_cvt_pk_bf16_f32 v42, v44, v45
    v_lshlrev_b32 v44, 16, v42
    v_and_b32 v45, 0xffff0000, v42
    v_cvt_pk_bf16_f32 v42, v46, v47
    v_lshlrev_b32 v46, 16, v42
    v_and_b32 v47, 0xffff0000, v42
    v_mul_f32 v44, v44, v40
    v_mul_f32 v45, v45, v40
    v_mul_f32 v46, v46, v40
    v_mul_f32 v47, v47, v40
    v_cvt_pk_bf16_f32 v48, v44, v45
    v_cvt_pk_bf16_f32 v49, v46, v47
    s_mov_b32 s21, 0
    buffer_store_dwordx2 v[48:49], v2, s[12:15], s21 offen offset:0
    v_accvgpr_read_b32 v44, a4
    v_accvgpr_read_b32 v45, a5
    v_accvgpr_read_b32 v46, a6
    v_accvgpr_read_b32 v47, a7
    s_nop 0
    v_cvt_pk_bf16_f32 v42, v44, v45
    v_lshlrev_b32 v44, 16, v42
    v_and_b32 v45, 0xffff0000, v42
    v_cvt_pk_bf16_f32 v42, v46, v47
    v_lshlrev_b32 v46, 16, v42
    v_and_b32 v47, 0xffff0000, v42
    v_mul_f32 v44, v44, v40
    v_mul_f32 v45, v45, v40
    v_mul_f32 v46, v46, v40
    v_mul_f32 v47, v47, v40
    v_cvt_pk_bf16_f32 v48, v44, v45
    v_cvt_pk_bf16_f32 v49, v46, v47
    s_mov_b32 s21, 0
    buffer_store_dwordx2 v[48:49], v2, s[12:15], s21 offen offset:32
    v_accvgpr_read_b32 v40, a20
    s_nop 0
    v_mov_b32 v41, v40
    v_cvt_pk_bf16_f32 v42, v40, v41
    v_lshlrev_b32 v40, 16, v42
    v_and_b32 v41, 0xffff0000, v42
    v_add_f32 v40, 0x358637bd, v40
    v_mov_b32 v41, v40
    v_cvt_pk_bf16_f32 v42, v40, v41
    v_lshlrev_b32 v40, 16, v42
    v_and_b32 v41, 0xffff0000, v42
    v_rcp_f32 v40, v40
    v_accvgpr_read_b32 v44, a12
    v_accvgpr_read_b32 v45, a13
    v_accvgpr_read_b32 v46, a14
    v_accvgpr_read_b32 v47, a15
    s_nop 0
    v_cvt_pk_bf16_f32 v42, v44, v45
    v_lshlrev_b32 v44, 16, v42
    v_and_b32 v45, 0xffff0000, v42
    v_cvt_pk_bf16_f32 v42, v46, v47
    v_lshlrev_b32 v46, 16, v42
    v_and_b32 v47, 0xffff0000, v42
    v_mul_f32 v44, v44, v40
    v_mul_f32 v45, v45, v40
    v_mul_f32 v46, v46, v40
    v_mul_f32 v47, v47, v40
    v_cvt_pk_bf16_f32 v48, v44, v45
    v_cvt_pk_bf16_f32 v49, v46, v47
    s_mov_b32 s21, 32768
    buffer_store_dwordx2 v[48:49], v2, s[12:15], s21 offen offset:0
    v_accvgpr_read_b32 v44, a16
    v_accvgpr_read_b32 v45, a17
    v_accvgpr_read_b32 v46, a18
    v_accvgpr_read_b32 v47, a19
    s_nop 0
    v_cvt_pk_bf16_f32 v42, v44, v45
    v_lshlrev_b32 v44, 16, v42
    v_and_b32 v45, 0xffff0000, v42
    v_cvt_pk_bf16_f32 v42, v46, v47
    v_lshlrev_b32 v46, 16, v42
    v_and_b32 v47, 0xffff0000, v42
    v_mul_f32 v44, v44, v40
    v_mul_f32 v45, v45, v40
    v_mul_f32 v46, v46, v40
    v_mul_f32 v47, v47, v40
    v_cvt_pk_bf16_f32 v48, v44, v45
    v_cvt_pk_bf16_f32 v49, v46, v47
    s_mov_b32 s21, 32768
    buffer_store_dwordx2 v[48:49], v2, s[12:15], s21 offen offset:32
    v_accvgpr_read_b32 v40, a32
    s_nop 0
    v_mov_b32 v41, v40
    v_cvt_pk_bf16_f32 v42, v40, v41
    v_lshlrev_b32 v40, 16, v42
    v_and_b32 v41, 0xffff0000, v42
    v_add_f32 v40, 0x358637bd, v40
    v_mov_b32 v41, v40
    v_cvt_pk_bf16_f32 v42, v40, v41
    v_lshlrev_b32 v40, 16, v42
    v_and_b32 v41, 0xffff0000, v42
    v_rcp_f32 v40, v40
    v_accvgpr_read_b32 v44, a24
    v_accvgpr_read_b32 v45, a25
    v_accvgpr_read_b32 v46, a26
    v_accvgpr_read_b32 v47, a27
    s_nop 0
    v_cvt_pk_bf16_f32 v42, v44, v45
    v_lshlrev_b32 v44, 16, v42
    v_and_b32 v45, 0xffff0000, v42
    v_cvt_pk_bf16_f32 v42, v46, v47
    v_lshlrev_b32 v46, 16, v42
    v_and_b32 v47, 0xffff0000, v42
    v_mul_f32 v44, v44, v40
    v_mul_f32 v45, v45, v40
    v_mul_f32 v46, v46, v40
    v_mul_f32 v47, v47, v40
    v_cvt_pk_bf16_f32 v48, v44, v45
    v_cvt_pk_bf16_f32 v49, v46, v47
    s_mov_b32 s21, 65536
    buffer_store_dwordx2 v[48:49], v2, s[12:15], s21 offen offset:0
    v_accvgpr_read_b32 v44, a28
    v_accvgpr_read_b32 v45, a29
    v_accvgpr_read_b32 v46, a30
    v_accvgpr_read_b32 v47, a31
    s_nop 0
    v_cvt_pk_bf16_f32 v42, v44, v45
    v_lshlrev_b32 v44, 16, v42
    v_and_b32 v45, 0xffff0000, v42
    v_cvt_pk_bf16_f32 v42, v46, v47
    v_lshlrev_b32 v46, 16, v42
    v_and_b32 v47, 0xffff0000, v42
    v_mul_f32 v44, v44, v40
    v_mul_f32 v45, v45, v40
    v_mul_f32 v46, v46, v40
    v_mul_f32 v47, v47, v40
    v_cvt_pk_bf16_f32 v48, v44, v45
    v_cvt_pk_bf16_f32 v49, v46, v47
    s_mov_b32 s21, 65536
    buffer_store_dwordx2 v[48:49], v2, s[12:15], s21 offen offset:32
    v_accvgpr_read_b32 v40, a44
    s_nop 0
    v_mov_b32 v41, v40
    v_cvt_pk_bf16_f32 v42, v40, v41
    v_lshlrev_b32 v40, 16, v42
    v_and_b32 v41, 0xffff0000, v42
    v_add_f32 v40, 0x358637bd, v40
    v_mov_b32 v41, v40
    v_cvt_pk_bf16_f32 v42, v40, v41
    v_lshlrev_b32 v40, 16, v42
    v_and_b32 v41, 0xffff0000, v42
    v_rcp_f32 v40, v40
    v_accvgpr_read_b32 v44, a36
    v_accvgpr_read_b32 v45, a37
    v_accvgpr_read_b32 v46, a38
    v_accvgpr_read_b32 v47, a39
    s_nop 0
    v_cvt_pk_bf16_f32 v42, v44, v45
    v_lshlrev_b32 v44, 16, v42
    v_and_b32 v45, 0xffff0000, v42
    v_cvt_pk_bf16_f32 v42, v46, v47
    v_lshlrev_b32 v46, 16, v42
    v_and_b32 v47, 0xffff0000, v42
    v_mul_f32 v44, v44, v40
    v_mul_f32 v45, v45, v40
    v_mul_f32 v46, v46, v40
    v_mul_f32 v47, v47, v40
    v_cvt_pk_bf16_f32 v48, v44, v45
    v_cvt_pk_bf16_f32 v49, v46, v47
    s_mov_b32 s21, 98304
    buffer_store_dwordx2 v[48:49], v2, s[12:15], s21 offen offset:0
    v_accvgpr_read_b32 v44, a40
    v_accvgpr_read_b32 v45, a41
    v_accvgpr_read_b32 v46, a42
    v_accvgpr_read_b32 v47, a43
    s_nop 0
    v_cvt_pk_bf16_f32 v42, v44, v45
    v_lshlrev_b32 v44, 16, v42
    v_and_b32 v45, 0xffff0000, v42
    v_cvt_pk_bf16_f32 v42, v46, v47
    v_lshlrev_b32 v46, 16, v42
    v_and_b32 v47, 0xffff0000, v42
    v_mul_f32 v44, v44, v40
    v_mul_f32 v45, v45, v40
    v_mul_f32 v46, v46, v40
    v_mul_f32 v47, v47, v40
    v_cvt_pk_bf16_f32 v48, v44, v45
    v_cvt_pk_bf16_f32 v49, v46, v47
    s_mov_b32 s21, 98304
    buffer_store_dwordx2 v[48:49], v2, s[12:15], s21 offen offset:32
    s_waitcnt vmcnt(0)
L_end_o_1_kernel:
    s_endpgm
.globl proj_1_kernel
.p2align 8
.type proj_1_kernel,@function
proj_1_kernel:
    s_cmp_ge_u32 s2, 256
    s_cbranch_scc1 L_end_proj_1_kernel
    s_load_dwordx2 s[40:41], s[0:1], 80
    s_load_dwordx2 s[42:43], s[0:1], 16
    s_load_dwordx2 s[50:51], s[0:1], 80
    v_and_b32 v1, 63, v0
    v_lshrrev_b32 v2, 6, v0
    s_and_b32 s24, s2, 15
    v_readfirstlane_b32 s26, v2
    s_lshr_b32 s25, s2, 4
    s_nop 1
    s_lshr_b32 s27, s26, 2
    s_and_b32 s28, s26, 1
    s_bfe_u32 s29, s26, 0x10001
    v_lshrrev_b32 v2, 3, v1
    v_and_b32 v3, 7, v1
    v_xor_b32 v3, v3, v2
    s_lshl_b32 s38, s26, 4
    s_lshl_b32 s39, s24, 7
    s_add_u32 s38, s38, s39
    v_add_u32 v4, s38, v2
    s_mov_b32 s38, 2048
    v_mul_lo_u32 v4, v4, s38
    v_lshlrev_b32 v3, 4, v3
    v_add_u32 v10, v4, v3
    v_add_u32 v11, 16384, v10
    v_lshrrev_b32 v2, 3, v1
    s_lshl_b32 s38, s26, 3
    v_add_u32 v2, s38, v2
    s_mov_b32 s38, 2048
    v_mul_lo_u32 v2, v2, s38
    v_bfe_u32 v3, v1, 1, 2
    v_bfe_u32 v4, v1, 4, 1
    s_and_b32 s38, s26, 1
    s_lshl_b32 s38, s38, 1
    v_or_b32 v4, s38, v4
    v_xor_b32 v3, v3, v4
    v_lshlrev_b32 v3, 5, v3
    v_and_b32 v4, 1, v1
    v_lshlrev_b32 v4, 4, v4
    v_add3_u32 v12, v2, v3, v4
    v_and_b32 v2, 15, v1
    s_lshl_b32 s38, s28, 6
    v_add_u32 v2, s38, v2
    v_lshlrev_b32 v2, 7, v2
    v_lshrrev_b32 v3, 4, v1
    s_lshl_b32 s38, s27, 2
    v_add_u32 v3, s38, v3
    v_and_b32 v4, 7, v1
    v_xor_b32 v3, v3, v4
    v_lshlrev_b32 v3, 4, v3
    v_add_u32 v13, v2, v3
    v_lshrrev_b32 v2, 4, v1
    v_lshlrev_b32 v2, 3, v2
    v_bfe_u32 v3, v1, 2, 2
    v_add_u32 v2, v2, v3
    v_lshlrev_b32 v2, 7, v2
    v_and_b32 v3, 3, v1
    v_lshlrev_b32 v3, 3, v3
    v_add_u32 v2, v2, v3
    s_lshl_b32 s38, s27, 12
    s_add_u32 s38, s38, 16384
    v_add_u32 v2, s38, v2
    v_bfe_u32 v3, v1, 3, 1
    v_bfe_u32 v4, v1, 4, 1
    v_lshlrev_b32 v4, 1, v4
    v_or_b32 v3, v3, v4
    s_lshl_b32 s38, s29, 1
    v_xor_b32 v4, s38, v3
    v_lshlrev_b32 v4, 5, v4
    v_add_u32 v14, v2, v4
    v_xor_b32 v4, 32, v4
    v_add_u32 v15, v2, v4
    s_waitcnt lgkmcnt(0)
    s_add_u32 s4, s40, 8388608
    s_addc_u32 s5, s41, 0
    s_mov_b32 s6, 4194304
    s_mov_b32 s7, 0x00020000
    s_mov_b32 s8, s42
    s_mov_b32 s9, s43
    s_mov_b32 s10, 2097152
    s_mov_b32 s11, 0x00020000
    s_mov_b32 s31, 0
    s_mul_i32 s32, s25, 128
    s_mov_b32 s36, 0
    s_lshl_b32 s44, s26, 11
    s_add_u32 s45, s44, 1024
    s_lshl_b32 s46, s26, 10
    s_add_u32 s46, s46, 16384
    s_add_u32 m0, s36, s44
    s_nop 0
    buffer_load_dwordx4 v10, s[4:7], s31 offen lds
    s_add_u32 m0, s36, s45
    s_nop 0
    buffer_load_dwordx4 v11, s[4:7], s31 offen lds
    s_add_u32 m0, s36, s46
    s_nop 0
    buffer_load_dwordx4 v12, s[8:11], s32 offen lds
    s_add_u32 s31, s31, 128
    s_add_u32 s32, s32, 131072
    s_add_u32 s36, s36, 24576
    s_cmp_ge_u32 s36, 147456
    s_cselect_b32 s36, 0, s36
    v_mov_b32 v68, 0
    v_mov_b32 v69, 0
    v_mov_b32 v70, 0
    v_mov_b32 v71, 0
    v_mov_b32 v72, 0
    v_mov_b32 v73, 0
    v_mov_b32 v74, 0
    v_mov_b32 v75, 0
    v_mov_b32 v76, 0
    v_mov_b32 v77, 0
    v_mov_b32 v78, 0
    v_mov_b32 v79, 0
    v_mov_b32 v80, 0
    v_mov_b32 v81, 0
    v_mov_b32 v82, 0
    v_mov_b32 v83, 0
    v_mov_b32 v84, 0
    v_mov_b32 v85, 0
    v_mov_b32 v86, 0
    v_mov_b32 v87, 0
    v_mov_b32 v88, 0
    v_mov_b32 v89, 0
    v_mov_b32 v90, 0
    v_mov_b32 v91, 0
    v_mov_b32 v92, 0
    v_mov_b32 v93, 0
    v_mov_b32 v94, 0
    v_mov_b32 v95, 0
    v_mov_b32 v96, 0
    v_mov_b32 v97, 0
    v_mov_b32 v98, 0
    v_mov_b32 v99, 0
    s_add_u32 m0, s36, s44
    s_nop 0
    buffer_load_dwordx4 v10, s[4:7], s31 offen lds
    s_add_u32 m0, s36, s45
    s_nop 0
    buffer_load_dwordx4 v11, s[4:7], s31 offen lds
    s_add_u32 m0, s36, s46
    s_nop 0
    buffer_load_dwordx4 v12, s[8:11], s32 offen lds
    s_add_u32 s31, s31, 128
    s_add_u32 s32, s32, 131072
    s_add_u32 s36, s36, 24576
    s_cmp_ge_u32 s36, 147456
    s_cselect_b32 s36, 0, s36
    s_add_u32 m0, s36, s44
    s_nop 0
    buffer_load_dwordx4 v10, s[4:7], s31 offen lds
    s_add_u32 m0, s36, s45
    s_nop 0
    buffer_load_dwordx4 v11, s[4:7], s31 offen lds
    s_add_u32 m0, s36, s46
    s_nop 0
    buffer_load_dwordx4 v12, s[8:11], s32 offen lds
    s_add_u32 s31, s31, 128
    s_add_u32 s32, s32, 131072
    s_add_u32 s36, s36, 24576
    s_cmp_ge_u32 s36, 147456
    s_cselect_b32 s36, 0, s36
    s_add_u32 m0, s36, s44
    s_nop 0
    buffer_load_dwordx4 v10, s[4:7], s31 offen lds
    s_add_u32 m0, s36, s45
    s_nop 0
    buffer_load_dwordx4 v11, s[4:7], s31 offen lds
    s_add_u32 m0, s36, s46
    s_nop 0
    buffer_load_dwordx4 v12, s[8:11], s32 offen lds
    s_add_u32 s31, s31, 128
    s_add_u32 s32, s32, 131072
    s_add_u32 s36, s36, 24576
    s_cmp_ge_u32 s36, 147456
    s_cselect_b32 s36, 0, s36
    s_add_u32 m0, s36, s44
    s_nop 0
    buffer_load_dwordx4 v10, s[4:7], s31 offen lds
    s_add_u32 m0, s36, s45
    s_nop 0
    buffer_load_dwordx4 v11, s[4:7], s31 offen lds
    s_add_u32 m0, s36, s46
    s_nop 0
    buffer_load_dwordx4 v12, s[8:11], s32 offen lds
    s_add_u32 s31, s31, 128
    s_add_u32 s32, s32, 131072
    s_add_u32 s36, s36, 24576
    s_cmp_ge_u32 s36, 147456
    s_cselect_b32 s36, 0, s36
    s_add_u32 m0, s36, s44
    s_nop 0
    buffer_load_dwordx4 v10, s[4:7], s31 offen lds
    s_add_u32 m0, s36, s45
    s_nop 0
    buffer_load_dwordx4 v11, s[4:7], s31 offen lds
    s_add_u32 m0, s36, s46
    s_nop 0
    buffer_load_dwordx4 v12, s[8:11], s32 offen lds
    s_add_u32 s31, s31, 128
    s_add_u32 s32, s32, 131072
    s_add_u32 s36, s36, 24576
    s_cmp_ge_u32 s36, 147456
    s_cselect_b32 s36, 0, s36
    s_mov_b32 s37, 0
    s_waitcnt vmcnt(15)
    s_barrier
    v_add_u32 v16, s37, v13
    v_add_u32 v17, s37, v14
    v_add_u32 v18, s37, v15
    s_add_u32 s37, s37, 24576
    s_cmp_ge_u32 s37, 147456
    s_cselect_b32 s37, 0, s37
    ds_read_b128 v[20:23], v16 offset:0
    ds_read_b128 v[24:27], v16 offset:2048
    ds_read_b128 v[28:31], v16 offset:4096
    ds_read_b128 v[32:35], v16 offset:6144
    ds_read_b64_tr_b16 v[52:53], v17 offset:0
    ds_read_b64_tr_b16 v[54:55], v17 offset:512
    ds_read_b64_tr_b16 v[56:57], v18 offset:0
    ds_read_b64_tr_b16 v[58:59], v18 offset:512
    s_mov_b32 s30, 5
L_loop_proj_1_kernel:
    s_waitcnt lgkmcnt(0)
    v_mfma_f32_16x16x32_bf16 v[68:71], v[52:55], v[20:23], v[68:71]
    v_mfma_f32_16x16x32_bf16 v[72:75], v[56:59], v[20:23], v[72:75]
    v_mfma_f32_16x16x32_bf16 v[76:79], v[52:55], v[24:27], v[76:79]
    v_mfma_f32_16x16x32_bf16 v[80:83], v[56:59], v[24:27], v[80:83]
    s_waitcnt vmcnt(12)
    s_barrier
    v_add_u32 v16, s37, v13
    v_add_u32 v17, s37, v14
    v_add_u32 v18, s37, v15
    s_add_u32 s37, s37, 24576
    s_cmp_ge_u32 s37, 147456
    s_cselect_b32 s37, 0, s37
    ds_read_b128 v[36:39], v16 offset:0
    ds_read_b128 v[40:43], v16 offset:2048
    ds_read_b128 v[44:47], v16 offset:4096
    ds_read_b128 v[48:51], v16 offset:6144
    ds_read_b64_tr_b16 v[60:61], v17 offset:0
    ds_read_b64_tr_b16 v[62:63], v17 offset:512
    ds_read_b64_tr_b16 v[64:65], v18 offset:0
    ds_read_b64_tr_b16 v[66:67], v18 offset:512
    s_add_u32 m0, s36, s44
    v_mfma_f32_16x16x32_bf16 v[84:87], v[52:55], v[28:31], v[84:87]
    buffer_load_dwordx4 v10, s[4:7], s31 offen lds
    s_add_u32 m0, s36, s45
    v_mfma_f32_16x16x32_bf16 v[88:91], v[56:59], v[28:31], v[88:91]
    buffer_load_dwordx4 v11, s[4:7], s31 offen lds
    s_add_u32 m0, s36, s46
    v_mfma_f32_16x16x32_bf16 v[92:95], v[52:55], v[32:35], v[92:95]
    buffer_load_dwordx4 v12, s[8:11], s32 offen lds
    v_mfma_f32_16x16x32_bf16 v[96:99], v[56:59], v[32:35], v[96:99]
    s_add_u32 s31, s31, 128
    s_add_u32 s32, s32, 131072
    s_add_u32 s36, s36, 24576
    s_cmp_ge_u32 s36, 147456
    s_cselect_b32 s36, 0, s36
    s_waitcnt lgkmcnt(0)
    v_mfma_f32_16x16x32_bf16 v[68:71], v[60:63], v[36:39], v[68:71]
    v_mfma_f32_16x16x32_bf16 v[72:75], v[64:67], v[36:39], v[72:75]
    v_mfma_f32_16x16x32_bf16 v[76:79], v[60:63], v[40:43], v[76:79]
    v_mfma_f32_16x16x32_bf16 v[80:83], v[64:67], v[40:43], v[80:83]
    s_waitcnt vmcnt(12)
    s_barrier
    v_add_u32 v16, s37, v13
    v_add_u32 v17, s37, v14
    v_add_u32 v18, s37, v15
    s_add_u32 s37, s37, 24576
    s_cmp_ge_u32 s37, 147456
    s_cselect_b32 s37, 0, s37
    ds_read_b128 v[20:23], v16 offset:0
    ds_read_b128 v[24:27], v16 offset:2048
    ds_read_b128 v[28:31], v16 offset:4096
    ds_read_b128 v[32:35], v16 offset:6144
    ds_read_b64_tr_b16 v[52:53], v17 offset:0
    ds_read_b64_tr_b16 v[54:55], v17 offset:512
    ds_read_b64_tr_b16 v[56:57], v18 offset:0
    ds_read_b64_tr_b16 v[58:59], v18 offset:512
    s_add_u32 m0, s36, s44
    v_mfma_f32_16x16x32_bf16 v[84:87], v[60:63], v[44:47], v[84:87]
    buffer_load_dwordx4 v10, s[4:7], s31 offen lds
    s_add_u32 m0, s36, s45
    v_mfma_f32_16x16x32_bf16 v[88:91], v[64:67], v[44:47], v[88:91]
    buffer_load_dwordx4 v11, s[4:7], s31 offen lds
    s_add_u32 m0, s36, s46
    v_mfma_f32_16x16x32_bf16 v[92:95], v[60:63], v[48:51], v[92:95]
    buffer_load_dwordx4 v12, s[8:11], s32 offen lds
    v_mfma_f32_16x16x32_bf16 v[96:99], v[64:67], v[48:51], v[96:99]
    s_add_u32 s31, s31, 128
    s_add_u32 s32, s32, 131072
    s_add_u32 s36, s36, 24576
    s_cmp_ge_u32 s36, 147456
    s_cselect_b32 s36, 0, s36
    s_sub_u32 s30, s30, 1
    s_cmp_lg_u32 s30, 0
    s_cbranch_scc1 L_loop_proj_1_kernel
    s_waitcnt lgkmcnt(0)
    v_mfma_f32_16x16x32_bf16 v[68:71], v[52:55], v[20:23], v[68:71]
    v_mfma_f32_16x16x32_bf16 v[72:75], v[56:59], v[20:23], v[72:75]
    v_mfma_f32_16x16x32_bf16 v[76:79], v[52:55], v[24:27], v[76:79]
    v_mfma_f32_16x16x32_bf16 v[80:83], v[56:59], v[24:27], v[80:83]
    s_waitcnt vmcnt(12)
    s_barrier
    v_add_u32 v16, s37, v13
    v_add_u32 v17, s37, v14
    v_add_u32 v18, s37, v15
    s_add_u32 s37, s37, 24576
    s_cmp_ge_u32 s37, 147456
    s_cselect_b32 s37, 0, s37
    ds_read_b128 v[36:39], v16 offset:0
    ds_read_b128 v[40:43], v16 offset:2048
    ds_read_b128 v[44:47], v16 offset:4096
    ds_read_b128 v[48:51], v16 offset:6144
    ds_read_b64_tr_b16 v[60:61], v17 offset:0
    ds_read_b64_tr_b16 v[62:63], v17 offset:512
    ds_read_b64_tr_b16 v[64:65], v18 offset:0
    ds_read_b64_tr_b16 v[66:67], v18 offset:512
    v_mfma_f32_16x16x32_bf16 v[84:87], v[52:55], v[28:31], v[84:87]
    v_mfma_f32_16x16x32_bf16 v[88:91], v[56:59], v[28:31], v[88:91]
    v_mfma_f32_16x16x32_bf16 v[92:95], v[52:55], v[32:35], v[92:95]
    v_mfma_f32_16x16x32_bf16 v[96:99], v[56:59], v[32:35], v[96:99]
    s_waitcnt lgkmcnt(0)
    v_mfma_f32_16x16x32_bf16 v[68:71], v[60:63], v[36:39], v[68:71]
    v_mfma_f32_16x16x32_bf16 v[72:75], v[64:67], v[36:39], v[72:75]
    v_mfma_f32_16x16x32_bf16 v[76:79], v[60:63], v[40:43], v[76:79]
    v_mfma_f32_16x16x32_bf16 v[80:83], v[64:67], v[40:43], v[80:83]
    s_waitcnt vmcnt(9)
    s_barrier
    v_add_u32 v16, s37, v13
    v_add_u32 v17, s37, v14
    v_add_u32 v18, s37, v15
    s_add_u32 s37, s37, 24576
    s_cmp_ge_u32 s37, 147456
    s_cselect_b32 s37, 0, s37
    ds_read_b128 v[20:23], v16 offset:0
    ds_read_b128 v[24:27], v16 offset:2048
    ds_read_b128 v[28:31], v16 offset:4096
    ds_read_b128 v[32:35], v16 offset:6144
    ds_read_b64_tr_b16 v[52:53], v17 offset:0
    ds_read_b64_tr_b16 v[54:55], v17 offset:512
    ds_read_b64_tr_b16 v[56:57], v18 offset:0
    ds_read_b64_tr_b16 v[58:59], v18 offset:512
    v_mfma_f32_16x16x32_bf16 v[84:87], v[60:63], v[44:47], v[84:87]
    v_mfma_f32_16x16x32_bf16 v[88:91], v[64:67], v[44:47], v[88:91]
    v_mfma_f32_16x16x32_bf16 v[92:95], v[60:63], v[48:51], v[92:95]
    v_mfma_f32_16x16x32_bf16 v[96:99], v[64:67], v[48:51], v[96:99]
    s_waitcnt lgkmcnt(0)
    v_mfma_f32_16x16x32_bf16 v[68:71], v[52:55], v[20:23], v[68:71]
    v_mfma_f32_16x16x32_bf16 v[72:75], v[56:59], v[20:23], v[72:75]
    v_mfma_f32_16x16x32_bf16 v[76:79], v[52:55], v[24:27], v[76:79]
    v_mfma_f32_16x16x32_bf16 v[80:83], v[56:59], v[24:27], v[80:83]
    s_waitcnt vmcnt(6)
    s_barrier
    v_add_u32 v16, s37, v13
    v_add_u32 v17, s37, v14
    v_add_u32 v18, s37, v15
    s_add_u32 s37, s37, 24576
    s_cmp_ge_u32 s37, 147456
    s_cselect_b32 s37, 0, s37
    ds_read_b128 v[36:39], v16 offset:0
    ds_read_b128 v[40:43], v16 offset:2048
    ds_read_b128 v[44:47], v16 offset:4096
    ds_read_b128 v[48:51], v16 offset:6144
    ds_read_b64_tr_b16 v[60:61], v17 offset:0
    ds_read_b64_tr_b16 v[62:63], v17 offset:512
    ds_read_b64_tr_b16 v[64:65], v18 offset:0
    ds_read_b64_tr_b16 v[66:67], v18 offset:512
    v_mfma_f32_16x16x32_bf16 v[84:87], v[52:55], v[28:31], v[84:87]
    v_mfma_f32_16x16x32_bf16 v[88:91], v[56:59], v[28:31], v[88:91]
    v_mfma_f32_16x16x32_bf16 v[92:95], v[52:55], v[32:35], v[92:95]
    v_mfma_f32_16x16x32_bf16 v[96:99], v[56:59], v[32:35], v[96:99]
    s_waitcnt lgkmcnt(0)
    v_mfma_f32_16x16x32_bf16 v[68:71], v[60:63], v[36:39], v[68:71]
    v_mfma_f32_16x16x32_bf16 v[72:75], v[64:67], v[36:39], v[72:75]
    v_mfma_f32_16x16x32_bf16 v[76:79], v[60:63], v[40:43], v[76:79]
    v_mfma_f32_16x16x32_bf16 v[80:83], v[64:67], v[40:43], v[80:83]
    s_waitcnt vmcnt(3)
    s_barrier
    v_add_u32 v16, s37, v13
    v_add_u32 v17, s37, v14
    v_add_u32 v18, s37, v15
    s_add_u32 s37, s37, 24576
    s_cmp_ge_u32 s37, 147456
    s_cselect_b32 s37, 0, s37
    ds_read_b128 v[20:23], v16 offset:0
    ds_read_b128 v[24:27], v16 offset:2048
    ds_read_b128 v[28:31], v16 offset:4096
    ds_read_b128 v[32:35], v16 offset:6144
    ds_read_b64_tr_b16 v[52:53], v17 offset:0
    ds_read_b64_tr_b16 v[54:55], v17 offset:512
    ds_read_b64_tr_b16 v[56:57], v18 offset:0
    ds_read_b64_tr_b16 v[58:59], v18 offset:512
    v_mfma_f32_16x16x32_bf16 v[84:87], v[60:63], v[44:47], v[84:87]
    v_mfma_f32_16x16x32_bf16 v[88:91], v[64:67], v[44:47], v[88:91]
    v_mfma_f32_16x16x32_bf16 v[92:95], v[60:63], v[48:51], v[92:95]
    v_mfma_f32_16x16x32_bf16 v[96:99], v[64:67], v[48:51], v[96:99]
    s_waitcnt lgkmcnt(0)
    v_mfma_f32_16x16x32_bf16 v[68:71], v[52:55], v[20:23], v[68:71]
    v_mfma_f32_16x16x32_bf16 v[72:75], v[56:59], v[20:23], v[72:75]
    v_mfma_f32_16x16x32_bf16 v[76:79], v[52:55], v[24:27], v[76:79]
    v_mfma_f32_16x16x32_bf16 v[80:83], v[56:59], v[24:27], v[80:83]
    s_waitcnt vmcnt(0)
    s_barrier
    v_add_u32 v16, s37, v13
    v_add_u32 v17, s37, v14
    v_add_u32 v18, s37, v15
    s_add_u32 s37, s37, 24576
    s_cmp_ge_u32 s37, 147456
    s_cselect_b32 s37, 0, s37
    ds_read_b128 v[36:39], v16 offset:0
    ds_read_b128 v[40:43], v16 offset:2048
    ds_read_b128 v[44:47], v16 offset:4096
    ds_read_b128 v[48:51], v16 offset:6144
    ds_read_b64_tr_b16 v[60:61], v17 offset:0
    ds_read_b64_tr_b16 v[62:63], v17 offset:512
    ds_read_b64_tr_b16 v[64:65], v18 offset:0
    ds_read_b64_tr_b16 v[66:67], v18 offset:512
    v_mfma_f32_16x16x32_bf16 v[84:87], v[52:55], v[28:31], v[84:87]
    v_mfma_f32_16x16x32_bf16 v[88:91], v[56:59], v[28:31], v[88:91]
    v_mfma_f32_16x16x32_bf16 v[92:95], v[52:55], v[32:35], v[92:95]
    v_mfma_f32_16x16x32_bf16 v[96:99], v[56:59], v[32:35], v[96:99]
    s_waitcnt lgkmcnt(0)
    v_mfma_f32_16x16x32_bf16 v[68:71], v[60:63], v[36:39], v[68:71]
    v_mfma_f32_16x16x32_bf16 v[72:75], v[64:67], v[36:39], v[72:75]
    v_mfma_f32_16x16x32_bf16 v[76:79], v[60:63], v[40:43], v[76:79]
    v_mfma_f32_16x16x32_bf16 v[80:83], v[64:67], v[40:43], v[80:83]
    v_mfma_f32_16x16x32_bf16 v[84:87], v[60:63], v[44:47], v[84:87]
    v_mfma_f32_16x16x32_bf16 v[88:91], v[64:67], v[44:47], v[88:91]
    v_mfma_f32_16x16x32_bf16 v[92:95], v[60:63], v[48:51], v[92:95]
    v_mfma_f32_16x16x32_bf16 v[96:99], v[64:67], v[48:51], v[96:99]
    s_waitcnt vmcnt(0) lgkmcnt(0)
    s_barrier
    s_xor_b32 s38, s26, 4
    s_mul_i32 s38, s38, 4096
    v_lshlrev_b32 v2, 4, v1
    v_add_u32 v2, s38, v2
    s_nop 7
    s_cmp_eq_u32 s27, 0
    s_cbranch_scc0 L_give1_proj_1_kernel
    ds_write_b128 v2, v[84:87] offset:0
    ds_write_b128 v2, v[88:91] offset:1024
    ds_write_b128 v2, v[92:95] offset:2048
    ds_write_b128 v2, v[96:99] offset:3072
    s_branch L_give_done_proj_1_kernel
L_give1_proj_1_kernel:
    ds_write_b128 v2, v[68:71] offset:0
    ds_write_b128 v2, v[72:75] offset:1024
    ds_write_b128 v2, v[76:79] offset:2048
    ds_write_b128 v2, v[80:83] offset:3072
L_give_done_proj_1_kernel:
    s_waitcnt lgkmcnt(0)
    s_barrier
    s_mul_i32 s38, s26, 4096
    v_lshlrev_b32 v2, 4, v1
    v_add_u32 v2, s38, v2
    s_mul_i32 s38, s27, 16
    s_cmp_eq_u32 s27, 0
    s_cbranch_scc0 L_keep1_proj_1_kernel
    ds_read_b128 v[20:23], v2 offset:0
    ds_read_b128 v[24:27], v2 offset:1024
    ds_read_b128 v[28:31], v2 offset:2048
    ds_read_b128 v[32:35], v2 offset:3072
    s_waitcnt lgkmcnt(0)
    v_add_f32 v20, v68, v20
    v_add_f32 v21, v69, v21
    v_add_f32 v22, v70, v22
    v_add_f32 v23, v71, v23
    v_add_f32 v24, v72, v24
    v_add_f32 v25, v73, v25
    v_add_f32 v26, v74, v26
    v_add_f32 v27, v75, v27
    v_add_f32 v28, v76, v28
    v_add_f32 v29, v77, v29
    v_add_f32 v30, v78, v30
    v_add_f32 v31, v79, v31
    v_add_f32 v32, v80, v32
    v_add_f32 v33, v81, v33
    v_add_f32 v34, v82, v34
    v_add_f32 v35, v83, v35
    s_branch L_keep_done_proj_1_kernel
L_keep1_proj_1_kernel:
    ds_read_b128 v[20:23], v2 offset:0
    ds_read_b128 v[24:27], v2 offset:1024
    ds_read_b128 v[28:31], v2 offset:2048
    ds_read_b128 v[32:35], v2 offset:3072
    s_waitcnt lgkmcnt(0)
    v_add_f32 v20, v84, v20
    v_add_f32 v21, v85, v21
    v_add_f32 v22, v86, v22
    v_add_f32 v23, v87, v23
    v_add_f32 v24, v88, v24
    v_add_f32 v25, v89, v25
    v_add_f32 v26, v90, v26
    v_add_f32 v27, v91, v27
    v_add_f32 v28, v92, v28
    v_add_f32 v29, v93, v29
    v_add_f32 v30, v94, v30
    v_add_f32 v31, v95, v31
    v_add_f32 v32, v96, v32
    v_add_f32 v33, v97, v33
    v_add_f32 v34, v98, v34
    v_add_f32 v35, v99, v35
L_keep_done_proj_1_kernel:
    s_add_u32 s12, s50, 20971520
    s_addc_u32 s13, s51, 0
    s_mov_b32 s14, 4194304
    s_mov_b32 s15, 0x00020000
    s_add_u32 s16, s50, 16777216
    s_addc_u32 s17, s51, 0
    s_mov_b32 s18, 4194304
    s_mov_b32 s19, 0x00020000
    v_and_b32 v2, 15, v1
    s_lshl_b32 s38, s24, 7
    s_lshl_b32 s39, s28, 6
    s_add_u32 s38, s38, s39
    s_lshl_b32 s39, s27, 5
    s_add_u32 s38, s38, s39
    v_add_u32 v2, s38, v2
    s_mov_b32 s38, 2048
    v_mul_lo_u32 v2, v2, s38
    v_lshrrev_b32 v3, 4, v1
    v_lshlrev_b32 v3, 3, v3
    s_lshl_b32 s38, s29, 6
    s_mul_i32 s39, s25, 128
    s_add_u32 s38, s38, s39
    v_add3_u32 v2, v2, v3, s38
    s_mov_b32 s39, 0
    buffer_load_dwordx2 v[36:37], v2, s[16:19], s39 offen offset:0
    s_mov_b32 s39, 0
    buffer_load_dwordx2 v[38:39], v2, s[16:19], s39 offen offset:32
    s_mov_b32 s39, 32768
    buffer_load_dwordx2 v[40:41], v2, s[16:19], s39 offen offset:0
    s_mov_b32 s39, 32768
    buffer_load_dwordx2 v[42:43], v2, s[16:19], s39 offen offset:32
    s_waitcnt vmcnt(0)
    v_cvt_pk_bf16_f32 v4, v20, v21
    v_lshlrev_b32 v20, 16, v4
    v_and_b32 v21, 0xffff0000, v4
    v_cvt_pk_bf16_f32 v4, v22, v23
    v_lshlrev_b32 v22, 16, v4
    v_and_b32 v23, 0xffff0000, v4
    v_lshlrev_b32 v4, 16, v36
    v_add_f32 v20, v4, v20
    v_and_b32 v4, 0xffff0000, v36
    v_add_f32 v21, v4, v21
    v_lshlrev_b32 v4, 16, v37
    v_add_f32 v22, v4, v22
    v_and_b32 v4, 0xffff0000, v37
    v_add_f32 v23, v4, v23
    v_cvt_pk_bf16_f32 v4, v20, v21
    v_cvt_pk_bf16_f32 v5, v22, v23
    s_mov_b32 s39, 0
    buffer_store_dwordx2 v[4:5], v2, s[12:15], s39 offen offset:0
    v_cvt_pk_bf16_f32 v4, v24, v25
    v_lshlrev_b32 v24, 16, v4
    v_and_b32 v25, 0xffff0000, v4
    v_cvt_pk_bf16_f32 v4, v26, v27
    v_lshlrev_b32 v26, 16, v4
    v_and_b32 v27, 0xffff0000, v4
    v_lshlrev_b32 v4, 16, v38
    v_add_f32 v24, v4, v24
    v_and_b32 v4, 0xffff0000, v38
    v_add_f32 v25, v4, v25
    v_lshlrev_b32 v4, 16, v39
    v_add_f32 v26, v4, v26
    v_and_b32 v4, 0xffff0000, v39
    v_add_f32 v27, v4, v27
    v_cvt_pk_bf16_f32 v4, v24, v25
    v_cvt_pk_bf16_f32 v5, v26, v27
    s_mov_b32 s39, 0
    buffer_store_dwordx2 v[4:5], v2, s[12:15], s39 offen offset:32
    v_cvt_pk_bf16_f32 v4, v28, v29
    v_lshlrev_b32 v28, 16, v4
    v_and_b32 v29, 0xffff0000, v4
    v_cvt_pk_bf16_f32 v4, v30, v31
    v_lshlrev_b32 v30, 16, v4
    v_and_b32 v31, 0xffff0000, v4
    v_lshlrev_b32 v4, 16, v40
    v_add_f32 v28, v4, v28
    v_and_b32 v4, 0xffff0000, v40
    v_add_f32 v29, v4, v29
    v_lshlrev_b32 v4, 16, v41
    v_add_f32 v30, v4, v30
    v_and_b32 v4, 0xffff0000, v41
    v_add_f32 v31, v4, v31
    v_cvt_pk_bf16_f32 v4, v28, v29
    v_cvt_pk_bf16_f32 v5, v30, v31
    s_mov_b32 s39, 32768
    buffer_store_dwordx2 v[4:5], v2, s[12:15], s39 offen offset:0
    v_cvt_pk_bf16_f32 v4, v32, v33
    v_lshlrev_b32 v32, 16, v4
    v_and_b32 v33, 0xffff0000, v4
    v_cvt_pk_bf16_f32 v4, v34, v35
    v_lshlrev_b32 v34, 16, v4
    v_and_b32 v35, 0xffff0000, v4
    v_lshlrev_b32 v4, 16, v42
    v_add_f32 v32, v4, v32
    v_and_b32 v4, 0xffff0000, v42
    v_add_f32 v33, v4, v33
    v_lshlrev_b32 v4, 16, v43
    v_add_f32 v34, v4, v34
    v_and_b32 v4, 0xffff0000, v43
    v_add_f32 v35, v4, v35
    v_cvt_pk_bf16_f32 v4, v32, v33
    v_cvt_pk_bf16_f32 v5, v34, v35
    s_mov_b32 s39, 32768
    buffer_store_dwordx2 v[4:5], v2, s[12:15], s39 offen offset:32
    s_waitcnt vmcnt(0)
    s_waitcnt vmcnt(0)
L_end_proj_1_kernel:
    s_endpgm
.globl ln2_1_kernel
.p2align 8
.type ln2_1_kernel,@function
ln2_1_kernel:
    s_cmp_ge_u32 s2, 512
    s_cbranch_scc1 L_end_ln2_1_kernel
    s_load_dwordx2 s[4:5], s[0:1], 80
    s_load_dwordx2 s[6:7], s[0:1], 80
    v_lshrrev_b32 v2, 6, v0
    v_and_b32 v1, 63, v0
    s_lshl_b32 s3, s2, 2
    v_add_u32 v2, s3, v2
    v_lshlrev_b32 v2, 11, v2
    v_lshlrev_b32 v3, 4, v1
    v_add_u32 v2, v2, v3
    s_waitcnt lgkmcnt(0)
    s_add_u32 s8, s4, 20971520
    s_addc_u32 s9, s5, 0
    s_mov_b32 s10, 4194304
    s_mov_b32 s11, 0x00020000
    s_add_u32 s12, s6, 0
    s_addc_u32 s13, s7, 0
    s_mov_b32 s14, 4194304
    s_mov_b32 s15, 0x00020000
    buffer_load_dwordx4 v[4:7], v2, s[8:11], 0 offen
    buffer_load_dwordx4 v[8:11], v2, s[8:11], 0 offen offset:1024
    s_waitcnt vmcnt(0)
    v_lshlrev_b32 v20, 16, v4
    v_and_b32 v21, 0xffff0000, v4
    v_lshlrev_b32 v22, 16, v5
    v_and_b32 v23, 0xffff0000, v5
    v_lshlrev_b32 v24, 16, v6
    v_and_b32 v25, 0xffff0000, v6
    v_lshlrev_b32 v26, 16, v7
    v_and_b32 v27, 0xffff0000, v7
    v_lshlrev_b32 v28, 16, v8
    v_and_b32 v29, 0xffff0000, v8
    v_lshlrev_b32 v30, 16, v9
    v_and_b32 v31, 0xffff0000, v9
    v_lshlrev_b32 v32, 16, v10
    v_and_b32 v33, 0xffff0000, v10
    v_lshlrev_b32 v34, 16, v11
    v_and_b32 v35, 0xffff0000, v11
    v_add_f32 v40, v20, v21
    v_add_f32 v40, v40, v22
    v_add_f32 v40, v40, v23
    v_add_f32 v40, v40, v24
    v_add_f32 v40, v40, v25
    v_add_f32 v40, v40, v26
    v_add_f32 v40, v40, v27
    v_add_f32 v40, v40, v28
    v_add_f32 v40, v40, v29
    v_add_f32 v40, v40, v30
    v_add_f32 v40, v40, v31
    v_add_f32 v40, v40, v32
    v_add_f32 v40, v40, v33
    v_add_f32 v40, v40, v34
    v_add_f32 v40, v40, v35
    s_nop 1
    v_add_f32_dpp v40, v40, v40 quad_perm:[1,0,3,2] row_mask:0xf bank_mask:0xf
    s_nop 1
    v_add_f32_dpp v40, v40, v40 quad_perm:[2,3,0,1] row_mask:0xf bank_mask:0xf
    s_nop 1
    v_add_f32_dpp v40, v40, v40 row_ror:4 row_mask:0xf bank_mask:0xf
    s_nop 1
    v_add_f32_dpp v40, v40, v40 row_ror:8 row_mask:0xf bank_mask:0xf
    v_mov_b32 v41, v40
    s_nop 1
    v_permlane16_swap_b32 v40, v41
    s_nop 1
    v_add_f32 v40, v40, v41
    v_mov_b32 v41, v40
    s_nop 1
    v_permlane32_swap_b32 v40, v41
    s_nop 1
    v_add_f32 v40, v40, v41
    v_mul_f32 v40, 0x3a800000, v40
    v_sub_f32 v42, v20, v40
    v_mul_f32 v43, v42, v42
    v_sub_f32 v42, v21, v40
    v_fmac_f32 v43, v42, v42
    v_sub_f32 v42, v22, v40
    v_fmac_f32 v43, v42, v42
    v_sub_f32 v42, v23, v40
    v_fmac_f32 v43, v42, v42
    v_sub_f32 v42, v24, v40
    v_fmac_f32 v43, v42, v42
    v_sub_f32 v42, v25, v40
    v_fmac_f32 v43, v42, v42
    v_sub_f32 v42, v26, v40
    v_fmac_f32 v43, v42, v42
    v_sub_f32 v42, v27, v40
    v_fmac_f32 v43, v42, v42
    v_sub_f32 v42, v28, v40
    v_fmac_f32 v43, v42, v42
    v_sub_f32 v42, v29, v40
    v_fmac_f32 v43, v42, v42
    v_sub_f32 v42, v30, v40
    v_fmac_f32 v43, v42, v42
    v_sub_f32 v42, v31, v40
    v_fmac_f32 v43, v42, v42
    v_sub_f32 v42, v32, v40
    v_fmac_f32 v43, v42, v42
    v_sub_f32 v42, v33, v40
    v_fmac_f32 v43, v42, v42
    v_sub_f32 v42, v34, v40
    v_fmac_f32 v43, v42, v42
    v_sub_f32 v42, v35, v40
    v_fmac_f32 v43, v42, v42
    s_nop 1
    v_add_f32_dpp v43, v43, v43 quad_perm:[1,0,3,2] row_mask:0xf bank_mask:0xf
    s_nop 1
    v_add_f32_dpp v43, v43, v43 quad_perm:[2,3,0,1] row_mask:0xf bank_mask:0xf
    s_nop 1
    v_add_f32_dpp v43, v43, v43 row_ror:4 row_mask:0xf bank_mask:0xf
    s_nop 1
    v_add_f32_dpp v43, v43, v43 row_ror:8 row_mask:0xf bank_mask:0xf
    v_mov_b32 v41, v43
    s_nop 1
    v_permlane16_swap_b32 v43, v41
    s_nop 1
    v_add_f32 v43, v43, v41
    v_mov_b32 v41, v43
    s_nop 1
    v_permlane32_swap_b32 v43, v41
    s_nop 1
    v_add_f32 v43, v43, v41
    v_mul_f32 v43, 0x3a800000, v43
    v_cvt_pk_bf16_f32 v41, v40, v43
    v_lshlrev_b32 v40, 16, v41
    v_and_b32 v43, 0xffff0000, v41
    v_add_f32 v43, 0x3727c5ac, v43
    v_mov_b32 v44, v43
    v_cvt_pk_bf16_f32 v41, v43, v44
    v_lshlrev_b32 v43, 16, v41
    v_and_b32 v44, 0xffff0000, v41
    v_sqrt_f32 v43, v43
    s_nop 0
    v_mov_b32 v44, v43
    v_cvt_pk_bf16_f32 v41, v43, v44
    v_lshlrev_b32 v43, 16, v41
    v_and_b32 v44, 0xffff0000, v41
    v_rcp_f32 v43, v43
    s_nop 0
    v_sub_f32 v20, v20, v40
    v_sub_f32 v21, v21, v40
    v_cvt_pk_bf16_f32 v41, v20, v21
    v_lshlrev_b32 v20, 16, v41
    v_and_b32 v21, 0xffff0000, v41
    v_mul_f32 v20, v20, v43
    v_mul_f32 v21, v21, v43
    v_cvt_pk_bf16_f32 v41, v20, v21
    v_lshlrev_b32 v20, 16, v41
    v_and_b32 v21, 0xffff0000, v41
    v_sub_f32 v22, v22, v40
    v_sub_f32 v23, v23, v40
    v_cvt_pk_bf16_f32 v41, v22, v23
    v_lshlrev_b32 v22, 16, v41
    v_and_b32 v23, 0xffff0000, v41
    v_mul_f32 v22, v22, v43
    v_mul_f32 v23, v23, v43
    v_cvt_pk_bf16_f32 v41, v22, v23
    v_lshlrev_b32 v22, 16, v41
    v_and_b32 v23, 0xffff0000, v41
    v_sub_f32 v24, v24, v40
    v_sub_f32 v25, v25, v40
    v_cvt_pk_bf16_f32 v41, v24, v25
    v_lshlrev_b32 v24, 16, v41
    v_and_b32 v25, 0xffff0000, v41
    v_mul_f32 v24, v24, v43
    v_mul_f32 v25, v25, v43
    v_cvt_pk_bf16_f32 v41, v24, v25
    v_lshlrev_b32 v24, 16, v41
    v_and_b32 v25, 0xffff0000, v41
    v_sub_f32 v26, v26, v40
    v_sub_f32 v27, v27, v40
    v_cvt_pk_bf16_f32 v41, v26, v27
    v_lshlrev_b32 v26, 16, v41
    v_and_b32 v27, 0xffff0000, v41
    v_mul_f32 v26, v26, v43
    v_mul_f32 v27, v27, v43
    v_cvt_pk_bf16_f32 v41, v26, v27
    v_lshlrev_b32 v26, 16, v41
    v_and_b32 v27, 0xffff0000, v41
    v_sub_f32 v28, v28, v40
    v_sub_f32 v29, v29, v40
    v_cvt_pk_bf16_f32 v41, v28, v29
    v_lshlrev_b32 v28, 16, v41
    v_and_b32 v29, 0xffff0000, v41
    v_mul_f32 v28, v28, v43
    v_mul_f32 v29, v29, v43
    v_cvt_pk_bf16_f32 v41, v28, v29
    v_lshlrev_b32 v28, 16, v41
    v_and_b32 v29, 0xffff0000, v41
    v_sub_f32 v30, v30, v40
    v_sub_f32 v31, v31, v40
    v_cvt_pk_bf16_f32 v41, v30, v31
    v_lshlrev_b32 v30, 16, v41
    v_and_b32 v31, 0xffff0000, v41
    v_mul_f32 v30, v30, v43
    v_mul_f32 v31, v31, v43
    v_cvt_pk_bf16_f32 v41, v30, v31
    v_lshlrev_b32 v30, 16, v41
    v_and_b32 v31, 0xffff0000, v41
    v_sub_f32 v32, v32, v40
    v_sub_f32 v33, v33, v40
    v_cvt_pk_bf16_f32 v41, v32, v33
    v_lshlrev_b32 v32, 16, v41
    v_and_b32 v33, 0xffff0000, v41
    v_mul_f32 v32, v32, v43
    v_mul_f32 v33, v33, v43
    v_cvt_pk_bf16_f32 v41, v32, v33
    v_lshlrev_b32 v32, 16, v41
    v_and_b32 v33, 0xffff0000, v41
    v_sub_f32 v34, v34, v40
    v_sub_f32 v35, v35, v40
    v_cvt_pk_bf16_f32 v41, v34, v35
    v_lshlrev_b32 v34, 16, v41
    v_and_b32 v35, 0xffff0000, v41
    v_mul_f32 v34, v34, v43
    v_mul_f32 v35, v35, v43
    v_cvt_pk_bf16_f32 v41, v34, v35
    v_lshlrev_b32 v34, 16, v41
    v_and_b32 v35, 0xffff0000, v41
    v_add_f32 v40, v20, v21
    v_add_f32 v40, v40, v22
    v_add_f32 v40, v40, v23
    v_add_f32 v40, v40, v24
    v_add_f32 v40, v40, v25
    v_add_f32 v40, v40, v26
    v_add_f32 v40, v40, v27
    v_add_f32 v40, v40, v28
    v_add_f32 v40, v40, v29
    v_add_f32 v40, v40, v30
    v_add_f32 v40, v40, v31
    v_add_f32 v40, v40, v32
    v_add_f32 v40, v40, v33
    v_add_f32 v40, v40, v34
    v_add_f32 v40, v40, v35
    s_nop 1
    v_add_f32_dpp v40, v40, v40 quad_perm:[1,0,3,2] row_mask:0xf bank_mask:0xf
    s_nop 1
    v_add_f32_dpp v40, v40, v40 quad_perm:[2,3,0,1] row_mask:0xf bank_mask:0xf
    s_nop 1
    v_add_f32_dpp v40, v40, v40 row_ror:4 row_mask:0xf bank_mask:0xf
    s_nop 1
    v_add_f32_dpp v40, v40, v40 row_ror:8 row_mask:0xf bank_mask:0xf
    v_mov_b32 v41, v40
    s_nop 1
    v_permlane16_swap_b32 v40, v41
    s_nop 1
    v_add_f32 v40, v40, v41
    v_mov_b32 v41, v40
    s_nop 1
    v_permlane32_swap_b32 v40, v41
    s_nop 1
    v_add_f32 v40, v40, v41
    v_mul_f32 v40, 0x3a800000, v40
    v_sub_f32 v42, v20, v40
    v_mul_f32 v43, v42, v42
    v_sub_f32 v42, v21, v40
    v_fmac_f32 v43, v42, v42
    v_sub_f32 v42, v22, v40
    v_fmac_f32 v43, v42, v42
    v_sub_f32 v42, v23, v40
    v_fmac_f32 v43, v42, v42
    v_sub_f32 v42, v24, v40
    v_fmac_f32 v43, v42, v42
    v_sub_f32 v42, v25, v40
    v_fmac_f32 v43, v42, v42
    v_sub_f32 v42, v26, v40
    v_fmac_f32 v43, v42, v42
    v_sub_f32 v42, v27, v40
    v_fmac_f32 v43, v42, v42
    v_sub_f32 v42, v28, v40
    v_fmac_f32 v43, v42, v42
    v_sub_f32 v42, v29, v40
    v_fmac_f32 v43, v42, v42
    v_sub_f32 v42, v30, v40
    v_fmac_f32 v43, v42, v42
    v_sub_f32 v42, v31, v40
    v_fmac_f32 v43, v42, v42
    v_sub_f32 v42, v32, v40
    v_fmac_f32 v43, v42, v42
    v_sub_f32 v42, v33, v40
    v_fmac_f32 v43, v42, v42
    v_sub_f32 v42, v34, v40
    v_fmac_f32 v43, v42, v42
    v_sub_f32 v42, v35, v40
    v_fmac_f32 v43, v42, v42
    s_nop 1
    v_add_f32_dpp v43, v43, v43 quad_perm:[1,0,3,2] row_mask:0xf bank_mask:0xf
    s_nop 1
    v_add_f32_dpp v43, v43, v43 quad_perm:[2,3,0,1] row_mask:0xf bank_mask:0xf
    s_nop 1
    v_add_f32_dpp v43, v43, v43 row_ror:4 row_mask:0xf bank_mask:0xf
    s_nop 1
    v_add_f32_dpp v43, v43, v43 row_ror:8 row_mask:0xf bank_mask:0xf
    v_mov_b32 v41, v43
    s_nop 1
    v_permlane16_swap_b32 v43, v41
    s_nop 1
    v_add_f32 v43, v43, v41
    v_mov_b32 v41, v43
    s_nop 1
    v_permlane32_swap_b32 v43, v41
    s_nop 1
    v_add_f32 v43, v43, v41
    v_mul_f32 v43, 0x3a800000, v43
    v_cvt_pk_bf16_f32 v41, v40, v43
    v_lshlrev_b32 v40, 16, v41
    v_and_b32 v43, 0xffff0000, v41
    v_add_f32 v43, 0x3727c5ac, v43
    v_mov_b32 v44, v43
    v_cvt_pk_bf16_f32 v41, v43, v44
    v_lshlrev_b32 v43, 16, v41
    v_and_b32 v44, 0xffff0000, v41
    v_sqrt_f32 v43, v43
    s_nop 0
    v_mov_b32 v44, v43
    v_cvt_pk_bf16_f32 v41, v43, v44
    v_lshlrev_b32 v43, 16, v41
    v_and_b32 v44, 0xffff0000, v41
    v_rcp_f32 v43, v43
    s_nop 0
    v_sub_f32 v20, v20, v40
    v_sub_f32 v21, v21, v40
    v_cvt_pk_bf16_f32 v41, v20, v21
    v_lshlrev_b32 v20, 16, v41
    v_and_b32 v21, 0xffff0000, v41
    v_mul_f32 v20, v20, v43
    v_mul_f32 v21, v21, v43
    v_sub_f32 v22, v22, v40
    v_sub_f32 v23, v23, v40
    v_cvt_pk_bf16_f32 v41, v22, v23
    v_lshlrev_b32 v22, 16, v41
    v_and_b32 v23, 0xffff0000, v41
    v_mul_f32 v22, v22, v43
    v_mul_f32 v23, v23, v43
    v_sub_f32 v24, v24, v40
    v_sub_f32 v25, v25, v40
    v_cvt_pk_bf16_f32 v41, v24, v25
    v_lshlrev_b32 v24, 16, v41
    v_and_b32 v25, 0xffff0000, v41
    v_mul_f32 v24, v24, v43
    v_mul_f32 v25, v25, v43
    v_sub_f32 v26, v26, v40
    v_sub_f32 v27, v27, v40
    v_cvt_pk_bf16_f32 v41, v26, v27
    v_lshlrev_b32 v26, 16, v41
    v_and_b32 v27, 0xffff0000, v41
    v_mul_f32 v26, v26, v43
    v_mul_f32 v27, v27, v43
    v_sub_f32 v28, v28, v40
    v_sub_f32 v29, v29, v40
    v_cvt_pk_bf16_f32 v41, v28, v29
    v_lshlrev_b32 v28, 16, v41
    v_and_b32 v29, 0xffff0000, v41
    v_mul_f32 v28, v28, v43
    v_mul_f32 v29, v29, v43
    v_sub_f32 v30, v30, v40
    v_sub_f32 v31, v31, v40
    v_cvt_pk_bf16_f32 v41, v30, v31
    v_lshlrev_b32 v30, 16, v41
    v_and_b32 v31, 0xffff0000, v41
    v_mul_f32 v30, v30, v43
    v_mul_f32 v31, v31, v43
    v_sub_f32 v32, v32, v40
    v_sub_f32 v33, v33, v40
    v_cvt_pk_bf16_f32 v41, v32, v33
    v_lshlrev_b32 v32, 16, v41
    v_and_b32 v33, 0xffff0000, v41
    v_mul_f32 v32, v32, v43
    v_mul_f32 v33, v33, v43
    v_sub_f32 v34, v34, v40
    v_sub_f32 v35, v35, v40
    v_cvt_pk_bf16_f32 v41, v34, v35
    v_lshlrev_b32 v34, 16, v41
    v_and_b32 v35, 0xffff0000, v41
    v_mul_f32 v34, v34, v43
    v_mul_f32 v35, v35, v43
    v_cvt_pk_bf16_f32 v4, v20, v21
    v_cvt_pk_bf16_f32 v5, v22, v23
    v_cvt_pk_bf16_f32 v6, v24, v25
    v_cvt_pk_bf16_f32 v7, v26, v27
    v_cvt_pk_bf16_f32 v8, v28, v29
    v_cvt_pk_bf16_f32 v9, v30, v31
    v_cvt_pk_bf16_f32 v10, v32, v33
    v_cvt_pk_bf16_f32 v11, v34, v35
    buffer_store_dwordx4 v[4:7], v2, s[12:15], 0 offen
    buffer_store_dwordx4 v[8:11], v2, s[12:15], 0 offen offset:1024
    s_waitcnt vmcnt(0)
L_end_ln2_1_kernel:
    s_endpgm
.globl mlp1_1_kernel
.p2align 8
.type mlp1_1_kernel,@function
mlp1_1_kernel:
    s_cmp_ge_u32 s2, 224
    s_cbranch_scc1 L_end_mlp1_1_kernel
    s_load_dwordx2 s[40:41], s[0:1], 80
    s_load_dwordx2 s[42:43], s[0:1], 32
    s_load_dwordx2 s[50:51], s[0:1], 80
    s_load_dwordx2 s[56:57], s[0:1], 40
    v_and_b32 v1, 63, v0
    v_lshrrev_b32 v2, 6, v0
    s_and_b32 s24, s2, 15
    v_readfirstlane_b32 s26, v2
    s_lshr_b32 s25, s2, 4
    s_nop 1
    s_lshr_b32 s27, s26, 2
    s_and_b32 s28, s26, 1
    s_bfe_u32 s29, s26, 0x10001
    v_lshrrev_b32 v2, 3, v1
    v_and_b32 v3, 7, v1
    v_xor_b32 v3, v3, v2
    s_lshl_b32 s38, s26, 4
    s_lshl_b32 s39, s24, 7
    s_add_u32 s38, s38, s39
    v_add_u32 v4, s38, v2
    s_mov_b32 s38, 2048
    v_mul_lo_u32 v4, v4, s38
    v_lshlrev_b32 v3, 4, v3
    v_add_u32 v10, v4, v3
    v_add_u32 v11, 16384, v10
    v_lshrrev_b32 v2, 3, v1
    s_lshl_b32 s38, s26, 3
    v_add_u32 v2, s38, v2
    s_mov_b32 s38, 7168
    v_mul_lo_u32 v2, v2, s38
    v_bfe_u32 v3, v1, 1, 2
    v_bfe_u32 v4, v1, 4, 1
    s_and_b32 s38, s26, 1
    s_lshl_b32 s38, s38, 1
    v_or_b32 v4, s38, v4
    v_xor_b32 v3, v3, v4
    v_lshlrev_b32 v3, 5, v3
    v_and_b32 v4, 1, v1
    v_lshlrev_b32 v4, 4, v4
    v_add3_u32 v12, v2, v3, v4
    v_and_b32 v2, 15, v1
    s_lshl_b32 s38, s28, 6
    v_add_u32 v2, s38, v2
    v_lshlrev_b32 v2, 7, v2
    v_lshrrev_b32 v3, 4, v1
    s_lshl_b32 s38, s27, 2
    v_add_u32 v3, s38, v3
    v_and_b32 v4, 7, v1
    v_xor_b32 v3, v3, v4
    v_lshlrev_b32 v3, 4, v3
    v_add_u32 v13, v2, v3
    v_lshrrev_b32 v2, 4, v1
    v_lshlrev_b32 v2, 3, v2
    v_bfe_u32 v3, v1, 2, 2
    v_add_u32 v2, v2, v3
    v_lshlrev_b32 v2, 7, v2
    v_and_b32 v3, 3, v1
    v_lshlrev_b32 v3, 3, v3
    v_add_u32 v2, v2, v3
    s_lshl_b32 s38, s27, 12
    s_add_u32 s38, s38, 16384
    v_add_u32 v2, s38, v2
    v_bfe_u32 v3, v1, 3, 1
    v_bfe_u32 v4, v1, 4, 1
    v_lshlrev_b32 v4, 1, v4
    v_or_b32 v3, v3, v4
    s_lshl_b32 s38, s29, 1
    v_xor_b32 v4, s38, v3
    v_lshlrev_b32 v4, 5, v4
    v_add_u32 v14, v2, v4
    v_xor_b32 v4, 32, v4
    v_add_u32 v15, v2, v4
    s_waitcnt lgkmcnt(0)
    s_mov_b32 s4, s40
    s_mov_b32 s5, s41
    s_mov_b32 s6, 4194304
    s_mov_b32 s7, 0x00020000
    s_mov_b32 s8, s42
    s_mov_b32 s9, s43
    s_mov_b32 s10, 7340032
    s_mov_b32 s11, 0x00020000
    s_mov_b32 s31, 0
    s_mul_i32 s32, s25, 512
    s_add_u32 s33, s32, 128
    s_add_u32 s34, s32, 256
    s_add_u32 s35, s32, 384
    s_mov_b32 s36, 0
    s_lshl_b32 s44, s26, 11
    s_add_u32 s45, s44, 1024
    s_lshl_b32 s46, s26, 10
    s_add_u32 s46, s46, 16384
    s_add_u32 s47, s46, 8192
    s_add_u32 s48, s46, 16384
    s_add_u32 s49, s46, 24576
    s_add_u32 m0, s36, s44
    s_nop 0
    buffer_load_dwordx4 v10, s[4:7], s31 offen lds
    s_add_u32 m0, s36, s45
    s_nop 0
    buffer_load_dwordx4 v11, s[4:7], s31 offen lds
    s_add_u32 m0, s36, s46
    s_nop 0
    buffer_load_dwordx4 v12, s[8:11], s32 offen lds
    s_add_u32 m0, s36, s47
    s_nop 0
    buffer_load_dwordx4 v12, s[8:11], s33 offen lds
    s_add_u32 m0, s36, s48
    s_nop 0
    buffer_load_dwordx4 v12, s[8:11], s34 offen lds
    s_add_u32 m0, s36, s49
    s_nop 0
    buffer_load_dwordx4 v12, s[8:11], s35 offen lds
    s_add_u32 s31, s31, 128
    s_add_u32 s32, s32, 458752
    s_add_u32 s33, s33, 458752
    s_add_u32 s34, s34, 458752
    s_add_u32 s35, s35, 458752
    s_add_u32 s36, s36, 49152
    s_cmp_ge_u32 s36, 147456
    s_cselect_b32 s36, 0, s36
    v_mov_b32 v116, 0
    v_mov_b32 v117, 0
    v_mov_b32 v118, 0
    v_mov_b32 v119, 0
    v_mov_b32 v120, 0
    v_mov_b32 v121, 0
    v_mov_b32 v122, 0
    v_mov_b32 v123, 0
    v_mov_b32 v124, 0
    v_mov_b32 v125, 0
    v_mov_b32 v126, 0
    v_mov_b32 v127, 0
    v_mov_b32 v128, 0
    v_mov_b32 v129, 0
    v_mov_b32 v130, 0
    v_mov_b32 v131, 0
    v_mov_b32 v132, 0
    v_mov_b32 v133, 0
    v_mov_b32 v134, 0
    v_mov_b32 v135, 0
    v_mov_b32 v136, 0
    v_mov_b32 v137, 0
    v_mov_b32 v138, 0
    v_mov_b32 v139, 0
    v_mov_b32 v140, 0
    v_mov_b32 v141, 0
    v_mov_b32 v142, 0
    v_mov_b32 v143, 0
    v_mov_b32 v144, 0
    v_mov_b32 v145, 0
    v_mov_b32 v146, 0
    v_mov_b32 v147, 0
    v_mov_b32 v148, 0
    v_mov_b32 v149, 0
    v_mov_b32 v150, 0
    v_mov_b32 v151, 0
    v_mov_b32 v152, 0
    v_mov_b32 v153, 0
    v_mov_b32 v154, 0
    v_mov_b32 v155, 0
    v_mov_b32 v156, 0
    v_mov_b32 v157, 0
    v_mov_b32 v158, 0
    v_mov_b32 v159, 0
    v_mov_b32 v160, 0
    v_mov_b32 v161, 0
    v_mov_b32 v162, 0
    v_mov_b32 v163, 0
    v_mov_b32 v164, 0
    v_mov_b32 v165, 0
    v_mov_b32 v166, 0
    v_mov_b32 v167, 0
    v_mov_b32 v168, 0
    v_mov_b32 v169, 0
    v_mov_b32 v170, 0
    v_mov_b32 v171, 0
    v_mov_b32 v172, 0
    v_mov_b32 v173, 0
    v_mov_b32 v174, 0
    v_mov_b32 v175, 0
    v_mov_b32 v176, 0
    v_mov_b32 v177, 0
    v_mov_b32 v178, 0
    v_mov_b32 v179, 0
    v_mov_b32 v180, 0
    v_mov_b32 v181, 0
    v_mov_b32 v182, 0
    v_mov_b32 v183, 0
    v_mov_b32 v184, 0
    v_mov_b32 v185, 0
    v_mov_b32 v186, 0
    v_mov_b32 v187, 0
    v_mov_b32 v188, 0
    v_mov_b32 v189, 0
    v_mov_b32 v190, 0
    v_mov_b32 v191, 0
    v_mov_b32 v192, 0
    v_mov_b32 v193, 0
    v_mov_b32 v194, 0
    v_mov_b32 v195, 0
    v_mov_b32 v196, 0
    v_mov_b32 v197, 0
    v_mov_b32 v198, 0
    v_mov_b32 v199, 0
    v_mov_b32 v200, 0
    v_mov_b32 v201, 0
    v_mov_b32 v202, 0
    v_mov_b32 v203, 0
    v_mov_b32 v204, 0
    v_mov_b32 v205, 0
    v_mov_b32 v206, 0
    v_mov_b32 v207, 0
    v_mov_b32 v208, 0
    v_mov_b32 v209, 0
    v_mov_b32 v210, 0
    v_mov_b32 v211, 0
    v_mov_b32 v212, 0
    v_mov_b32 v213, 0
    v_mov_b32 v214, 0
    v_mov_b32 v215, 0
    v_mov_b32 v216, 0
    v_mov_b32 v217, 0
    v_mov_b32 v218, 0
    v_mov_b32 v219, 0
    v_mov_b32 v220, 0
    v_mov_b32 v221, 0
    v_mov_b32 v222, 0
    v_mov_b32 v223, 0
    v_mov_b32 v224, 0
    v_mov_b32 v225, 0
    v_mov_b32 v226, 0
    v_mov_b32 v227, 0
    v_mov_b32 v228, 0
    v_mov_b32 v229, 0
    v_mov_b32 v230, 0
    v_mov_b32 v231, 0
    v_mov_b32 v232, 0
    v_mov_b32 v233, 0
    v_mov_b32 v234, 0
    v_mov_b32 v235, 0
    v_mov_b32 v236, 0
    v_mov_b32 v237, 0
    v_mov_b32 v238, 0
    v_mov_b32 v239, 0
    v_mov_b32 v240, 0
    v_mov_b32 v241, 0
    v_mov_b32 v242, 0
    v_mov_b32 v243, 0
    s_add_u32 m0, s36, s44
    s_nop 0
    buffer_load_dwordx4 v10, s[4:7], s31 offen lds
    s_add_u32 m0, s36, s45
    s_nop 0
    buffer_load_dwordx4 v11, s[4:7], s31 offen lds
    s_add_u32 m0, s36, s46
    s_nop 0
    buffer_load_dwordx4 v12, s[8:11], s32 offen lds
    s_add_u32 m0, s36, s47
    s_nop 0
    buffer_load_dwordx4 v12, s[8:11], s33 offen lds
    s_add_u32 m0, s36, s48
    s_nop 0
    buffer_load_dwordx4 v12, s[8:11], s34 offen lds
    s_add_u32 m0, s36, s49
    s_nop 0
    buffer_load_dwordx4 v12, s[8:11], s35 offen lds
    s_add_u32 s31, s31, 128
    s_add_u32 s32, s32, 458752
    s_add_u32 s33, s33, 458752
    s_add_u32 s34, s34, 458752
    s_add_u32 s35, s35, 458752
    s_add_u32 s36, s36, 49152
    s_cmp_ge_u32 s36, 147456
    s_cselect_b32 s36, 0, s36
    s_add_u32 m0, s36, s44
    s_nop 0
    buffer_load_dwordx4 v10, s[4:7], s31 offen lds
    s_add_u32 m0, s36, s45
    s_nop 0
    buffer_load_dwordx4 v11, s[4:7], s31 offen lds
    s_add_u32 m0, s36, s46
    s_nop 0
    buffer_load_dwordx4 v12, s[8:11], s32 offen lds
    s_add_u32 m0, s36, s47
    s_nop 0
    buffer_load_dwordx4 v12, s[8:11], s33 offen lds
    s_add_u32 m0, s36, s48
    s_nop 0
    buffer_load_dwordx4 v12, s[8:11], s34 offen lds
    s_add_u32 m0, s36, s49
    s_nop 0
    buffer_load_dwordx4 v12, s[8:11], s35 offen lds
    s_add_u32 s31, s31, 128
    s_add_u32 s32, s32, 458752
    s_add_u32 s33, s33, 458752
    s_add_u32 s34, s34, 458752
    s_add_u32 s35, s35, 458752
    s_add_u32 s36, s36, 49152
    s_cmp_ge_u32 s36, 147456
    s_cselect_b32 s36, 0, s36
    s_mov_b32 s37, 0
    s_waitcnt vmcnt(12)
    s_barrier
    v_add_u32 v16, s37, v13
    v_add_u32 v17, s37, v14
    v_add_u32 v18, s37, v15
    s_add_u32 s37, s37, 49152
    s_cmp_ge_u32 s37, 147456
    s_cselect_b32 s37, 0, s37
    ds_read_b128 v[20:23], v16 offset:0
    ds_read_b128 v[24:27], v16 offset:2048
    ds_read_b128 v[28:31], v16 offset:4096
    ds_read_b128 v[32:35], v16 offset:6144
    ds_read_b64_tr_b16 v[52:53], v17 offset:0
    ds_read_b64_tr_b16 v[54:55], v17 offset:512
    ds_read_b64_tr_b16 v[56:57], v18 offset:0
    ds_read_b64_tr_b16 v[58:59], v18 offset:512
    ds_read_b64_tr_b16 v[60:61], v17 offset:8192
    ds_read_b64_tr_b16 v[62:63], v17 offset:8704
    ds_read_b64_tr_b16 v[64:65], v18 offset:8192
    ds_read_b64_tr_b16 v[66:67], v18 offset:8704
    ds_read_b64_tr_b16 v[68:69], v17 offset:16384
    ds_read_b64_tr_b16 v[70:71], v17 offset:16896
    ds_read_b64_tr_b16 v[72:73], v18 offset:16384
    ds_read_b64_tr_b16 v[74:75], v18 offset:16896
    ds_read_b64_tr_b16 v[76:77], v17 offset:24576
    ds_read_b64_tr_b16 v[78:79], v17 offset:25088
    ds_read_b64_tr_b16 v[80:81], v18 offset:24576
    ds_read_b64_tr_b16 v[82:83], v18 offset:25088
    s_mov_b32 s30, 6
L_loop_mlp1_1_kernel:
    s_waitcnt lgkmcnt(0)
    v_mfma_f32_16x16x32_bf16 v[116:119], v[52:55], v[20:23], v[116:119]
    v_mfma_f32_16x16x32_bf16 v[120:123], v[56:59], v[20:23], v[120:123]
    v_mfma_f32_16x16x32_bf16 v[124:127], v[60:63], v[20:23], v[124:127]
    v_mfma_f32_16x16x32_bf16 v[128:131], v[64:67], v[20:23], v[128:131]
    v_mfma_f32_16x16x32_bf16 v[132:135], v[68:71], v[20:23], v[132:135]
    v_mfma_f32_16x16x32_bf16 v[136:139], v[72:75], v[20:23], v[136:139]
    v_mfma_f32_16x16x32_bf16 v[140:143], v[76:79], v[20:23], v[140:143]
    v_mfma_f32_16x16x32_bf16 v[144:147], v[80:83], v[20:23], v[144:147]
    v_mfma_f32_16x16x32_bf16 v[148:151], v[52:55], v[24:27], v[148:151]
    v_mfma_f32_16x16x32_bf16 v[152:155], v[56:59], v[24:27], v[152:155]
    v_mfma_f32_16x16x32_bf16 v[156:159], v[60:63], v[24:27], v[156:159]
    v_mfma_f32_16x16x32_bf16 v[160:163], v[64:67], v[24:27], v[160:163]
    v_mfma_f32_16x16x32_bf16 v[164:167], v[68:71], v[24:27], v[164:167]
    v_mfma_f32_16x16x32_bf16 v[168:171], v[72:75], v[24:27], v[168:171]
    v_mfma_f32_16x16x32_bf16 v[172:175], v[76:79], v[24:27], v[172:175]
    v_mfma_f32_16x16x32_bf16 v[176:179], v[80:83], v[24:27], v[176:179]
    s_waitcnt vmcnt(6)
    s_barrier
    v_add_u32 v16, s37, v13
    v_add_u32 v17, s37, v14
    v_add_u32 v18, s37, v15
    s_add_u32 s37, s37, 49152
    s_cmp_ge_u32 s37, 147456
    s_cselect_b32 s37, 0, s37
    ds_read_b128 v[36:39], v16 offset:0
    ds_read_b128 v[40:43], v16 offset:2048
    ds_read_b128 v[44:47], v16 offset:4096
    ds_read_b128 v[48:51], v16 offset:6144
    ds_read_b64_tr_b16 v[84:85], v17 offset:0
    ds_read_b64_tr_b16 v[86:87], v17 offset:512
    ds_read_b64_tr_b16 v[88:89], v18 offset:0
    ds_read_b64_tr_b16 v[90:91], v18 offset:512
    ds_read_b64_tr_b16 v[92:93], v17 offset:8192
    ds_read_b64_tr_b16 v[94:95], v17 offset:8704
    ds_read_b64_tr_b16 v[96:97], v18 offset:8192
    ds_read_b64_tr_b16 v[98:99], v18 offset:8704
    ds_read_b64_tr_b16 v[100:101], v17 offset:16384
    ds_read_b64_tr_b16 v[102:103], v17 offset:16896
    ds_read_b64_tr_b16 v[104:105], v18 offset:16384
    ds_read_b64_tr_b16 v[106:107], v18 offset:16896
    ds_read_b64_tr_b16 v[108:109], v17 offset:24576
    ds_read_b64_tr_b16 v[110:111], v17 offset:25088
    ds_read_b64_tr_b16 v[112:113], v18 offset:24576
    ds_read_b64_tr_b16 v[114:115], v18 offset:25088
    s_add_u32 m0, s36, s44
    v_mfma_f32_16x16x32_bf16 v[180:183], v[52:55], v[28:31], v[180:183]
    buffer_load_dwordx4 v10, s[4:7], s31 offen lds
    v_mfma_f32_16x16x32_bf16 v[184:187], v[56:59], v[28:31], v[184:187]
    s_add_u32 m0, s36, s45
    v_mfma_f32_16x16x32_bf16 v[188:191], v[60:63], v[28:31], v[188:191]
    buffer_load_dwordx4 v11, s[4:7], s31 offen lds
    v_mfma_f32_16x16x32_bf16 v[192:195], v[64:67], v[28:31], v[192:195]
    s_add_u32 m0, s36, s46
    v_mfma_f32_16x16x32_bf16 v[196:199], v[68:71], v[28:31], v[196:199]
    buffer_load_dwordx4 v12, s[8:11], s32 offen lds
    v_mfma_f32_16x16x32_bf16 v[200:203], v[72:75], v[28:31], v[200:203]
    s_add_u32 m0, s36, s47
    v_mfma_f32_16x16x32_bf16 v[204:207], v[76:79], v[28:31], v[204:207]
    buffer_load_dwordx4 v12, s[8:11], s33 offen lds
    v_mfma_f32_16x16x32_bf16 v[208:211], v[80:83], v[28:31], v[208:211]
    s_add_u32 m0, s36, s48
    v_mfma_f32_16x16x32_bf16 v[212:215], v[52:55], v[32:35], v[212:215]
    buffer_load_dwordx4 v12, s[8:11], s34 offen lds
    v_mfma_f32_16x16x32_bf16 v[216:219], v[56:59], v[32:35], v[216:219]
    s_add_u32 m0, s36, s49
    v_mfma_f32_16x16x32_bf16 v[220:223], v[60:63], v[32:35], v[220:223]
    buffer_load_dwordx4 v12, s[8:11], s35 offen lds
    v_mfma_f32_16x16x32_bf16 v[224:227], v[64:67], v[32:35], v[224:227]
    v_mfma_f32_16x16x32_bf16 v[228:231], v[68:71], v[32:35], v[228:231]
    v_mfma_f32_16x16x32_bf16 v[232:235], v[72:75], v[32:35], v[232:235]
    v_mfma_f32_16x16x32_bf16 v[236:239], v[76:79], v[32:35], v[236:239]
    v_mfma_f32_16x16x32_bf16 v[240:243], v[80:83], v[32:35], v[240:243]
    s_add_u32 s31, s31, 128
    s_add_u32 s32, s32, 458752
    s_add_u32 s33, s33, 458752
    s_add_u32 s34, s34, 458752
    s_add_u32 s35, s35, 458752
    s_add_u32 s36, s36, 49152
    s_cmp_ge_u32 s36, 147456
    s_cselect_b32 s36, 0, s36
    s_waitcnt lgkmcnt(0)
    v_mfma_f32_16x16x32_bf16 v[116:119], v[84:87], v[36:39], v[116:119]
    v_mfma_f32_16x16x32_bf16 v[120:123], v[88:91], v[36:39], v[120:123]
    v_mfma_f32_16x16x32_bf16 v[124:127], v[92:95], v[36:39], v[124:127]
    v_mfma_f32_16x16x32_bf16 v[128:131], v[96:99], v[36:39], v[128:131]
    v_mfma_f32_16x16x32_bf16 v[132:135], v[100:103], v[36:39], v[132:135]
    v_mfma_f32_16x16x32_bf16 v[136:139], v[104:107], v[36:39], v[136:139]
    v_mfma_f32_16x16x32_bf16 v[140:143], v[108:111], v[36:39], v[140:143]
    v_mfma_f32_16x16x32_bf16 v[144:147], v[112:115], v[36:39], v[144:147]
    v_mfma_f32_16x16x32_bf16 v[148:151], v[84:87], v[40:43], v[148:151]
    v_mfma_f32_16x16x32_bf16 v[152:155], v[88:91], v[40:43], v[152:155]
    v_mfma_f32_16x16x32_bf16 v[156:159], v[92:95], v[40:43], v[156:159]
    v_mfma_f32_16x16x32_bf16 v[160:163], v[96:99], v[40:43], v[160:163]
    v_mfma_f32_16x16x32_bf16 v[164:167], v[100:103], v[40:43], v[164:167]
    v_mfma_f32_16x16x32_bf16 v[168:171], v[104:107], v[40:43], v[168:171]
    v_mfma_f32_16x16x32_bf16 v[172:175], v[108:111], v[40:43], v[172:175]
    v_mfma_f32_16x16x32_bf16 v[176:179], v[112:115], v[40:43], v[176:179]
    s_waitcnt vmcnt(6)
    s_barrier
    v_add_u32 v16, s37, v13
    v_add_u32 v17, s37, v14
    v_add_u32 v18, s37, v15
    s_add_u32 s37, s37, 49152
    s_cmp_ge_u32 s37, 147456
    s_cselect_b32 s37, 0, s37
    ds_read_b128 v[20:23], v16 offset:0
    ds_read_b128 v[24:27], v16 offset:2048
    ds_read_b128 v[28:31], v16 offset:4096
    ds_read_b128 v[32:35], v16 offset:6144
    ds_read_b64_tr_b16 v[52:53], v17 offset:0
    ds_read_b64_tr_b16 v[54:55], v17 offset:512
    ds_read_b64_tr_b16 v[56:57], v18 offset:0
    ds_read_b64_tr_b16 v[58:59], v18 offset:512
    ds_read_b64_tr_b16 v[60:61], v17 offset:8192
    ds_read_b64_tr_b16 v[62:63], v17 offset:8704
    ds_read_b64_tr_b16 v[64:65], v18 offset:8192
    ds_read_b64_tr_b16 v[66:67], v18 offset:8704
    ds_read_b64_tr_b16 v[68:69], v17 offset:16384
    ds_read_b64_tr_b16 v[70:71], v17 offset:16896
    ds_read_b64_tr_b16 v[72:73], v18 offset:16384
    ds_read_b64_tr_b16 v[74:75], v18 offset:16896
    ds_read_b64_tr_b16 v[76:77], v17 offset:24576
    ds_read_b64_tr_b16 v[78:79], v17 offset:25088
    ds_read_b64_tr_b16 v[80:81], v18 offset:24576
    ds_read_b64_tr_b16 v[82:83], v18 offset:25088
    s_add_u32 m0, s36, s44
    v_mfma_f32_16x16x32_bf16 v[180:183], v[84:87], v[44:47], v[180:183]
    buffer_load_dwordx4 v10, s[4:7], s31 offen lds
    v_mfma_f32_16x16x32_bf16 v[184:187], v[88:91], v[44:47], v[184:187]
    s_add_u32 m0, s36, s45
    v_mfma_f32_16x16x32_bf16 v[188:191], v[92:95], v[44:47], v[188:191]
    buffer_load_dwordx4 v11, s[4:7], s31 offen lds
    v_mfma_f32_16x16x32_bf16 v[192:195], v[96:99], v[44:47], v[192:195]
    s_add_u32 m0, s36, s46
    v_mfma_f32_16x16x32_bf16 v[196:199], v[100:103], v[44:47], v[196:199]
    buffer_load_dwordx4 v12, s[8:11], s32 offen lds
    v_mfma_f32_16x16x32_bf16 v[200:203], v[104:107], v[44:47], v[200:203]
    s_add_u32 m0, s36, s47
    v_mfma_f32_16x16x32_bf16 v[204:207], v[108:111], v[44:47], v[204:207]
    buffer_load_dwordx4 v12, s[8:11], s33 offen lds
    v_mfma_f32_16x16x32_bf16 v[208:211], v[112:115], v[44:47], v[208:211]
    s_add_u32 m0, s36, s48
    v_mfma_f32_16x16x32_bf16 v[212:215], v[84:87], v[48:51], v[212:215]
    buffer_load_dwordx4 v12, s[8:11], s34 offen lds
    v_mfma_f32_16x16x32_bf16 v[216:219], v[88:91], v[48:51], v[216:219]
    s_add_u32 m0, s36, s49
    v_mfma_f32_16x16x32_bf16 v[220:223], v[92:95], v[48:51], v[220:223]
    buffer_load_dwordx4 v12, s[8:11], s35 offen lds
    v_mfma_f32_16x16x32_bf16 v[224:227], v[96:99], v[48:51], v[224:227]
    v_mfma_f32_16x16x32_bf16 v[228:231], v[100:103], v[48:51], v[228:231]
    v_mfma_f32_16x16x32_bf16 v[232:235], v[104:107], v[48:51], v[232:235]
    v_mfma_f32_16x16x32_bf16 v[236:239], v[108:111], v[48:51], v[236:239]
    v_mfma_f32_16x16x32_bf16 v[240:243], v[112:115], v[48:51], v[240:243]
    s_add_u32 s31, s31, 128
    s_add_u32 s32, s32, 458752
    s_add_u32 s33, s33, 458752
    s_add_u32 s34, s34, 458752
    s_add_u32 s35, s35, 458752
    s_add_u32 s36, s36, 49152
    s_cmp_ge_u32 s36, 147456
    s_cselect_b32 s36, 0, s36
    s_sub_u32 s30, s30, 1
    s_cmp_lg_u32 s30, 0
    s_cbranch_scc1 L_loop_mlp1_1_kernel
    s_waitcnt lgkmcnt(0)
    v_mfma_f32_16x16x32_bf16 v[116:119], v[52:55], v[20:23], v[116:119]
    v_mfma_f32_16x16x32_bf16 v[120:123], v[56:59], v[20:23], v[120:123]
    v_mfma_f32_16x16x32_bf16 v[124:127], v[60:63], v[20:23], v[124:127]
    v_mfma_f32_16x16x32_bf16 v[128:131], v[64:67], v[20:23], v[128:131]
    v_mfma_f32_16x16x32_bf16 v[132:135], v[68:71], v[20:23], v[132:135]
    v_mfma_f32_16x16x32_bf16 v[136:139], v[72:75], v[20:23], v[136:139]
    v_mfma_f32_16x16x32_bf16 v[140:143], v[76:79], v[20:23], v[140:143]
    v_mfma_f32_16x16x32_bf16 v[144:147], v[80:83], v[20:23], v[144:147]
    v_mfma_f32_16x16x32_bf16 v[148:151], v[52:55], v[24:27], v[148:151]
    v_mfma_f32_16x16x32_bf16 v[152:155], v[56:59], v[24:27], v[152:155]
    v_mfma_f32_16x16x32_bf16 v[156:159], v[60:63], v[24:27], v[156:159]
    v_mfma_f32_16x16x32_bf16 v[160:163], v[64:67], v[24:27], v[160:163]
    v_mfma_f32_16x16x32_bf16 v[164:167], v[68:71], v[24:27], v[164:167]
    v_mfma_f32_16x16x32_bf16 v[168:171], v[72:75], v[24:27], v[168:171]
    v_mfma_f32_16x16x32_bf16 v[172:175], v[76:79], v[24:27], v[172:175]
    v_mfma_f32_16x16x32_bf16 v[176:179], v[80:83], v[24:27], v[176:179]
    s_waitcnt vmcnt(6)
    s_barrier
    v_add_u32 v16, s37, v13
    v_add_u32 v17, s37, v14
    v_add_u32 v18, s37, v15
    s_add_u32 s37, s37, 49152
    s_cmp_ge_u32 s37, 147456
    s_cselect_b32 s37, 0, s37
    ds_read_b128 v[36:39], v16 offset:0
    ds_read_b128 v[40:43], v16 offset:2048
    ds_read_b128 v[44:47], v16 offset:4096
    ds_read_b128 v[48:51], v16 offset:6144
    ds_read_b64_tr_b16 v[84:85], v17 offset:0
    ds_read_b64_tr_b16 v[86:87], v17 offset:512
    ds_read_b64_tr_b16 v[88:89], v18 offset:0
    ds_read_b64_tr_b16 v[90:91], v18 offset:512
    ds_read_b64_tr_b16 v[92:93], v17 offset:8192
    ds_read_b64_tr_b16 v[94:95], v17 offset:8704
    ds_read_b64_tr_b16 v[96:97], v18 offset:8192
    ds_read_b64_tr_b16 v[98:99], v18 offset:8704
    ds_read_b64_tr_b16 v[100:101], v17 offset:16384
    ds_read_b64_tr_b16 v[102:103], v17 offset:16896
    ds_read_b64_tr_b16 v[104:105], v18 offset:16384
    ds_read_b64_tr_b16 v[106:107], v18 offset:16896
    ds_read_b64_tr_b16 v[108:109], v17 offset:24576
    ds_read_b64_tr_b16 v[110:111], v17 offset:25088
    ds_read_b64_tr_b16 v[112:113], v18 offset:24576
    ds_read_b64_tr_b16 v[114:115], v18 offset:25088
    s_add_u32 m0, s36, s44
    v_mfma_f32_16x16x32_bf16 v[180:183], v[52:55], v[28:31], v[180:183]
    buffer_load_dwordx4 v10, s[4:7], s31 offen lds
    v_mfma_f32_16x16x32_bf16 v[184:187], v[56:59], v[28:31], v[184:187]
    s_add_u32 m0, s36, s45
    v_mfma_f32_16x16x32_bf16 v[188:191], v[60:63], v[28:31], v[188:191]
    buffer_load_dwordx4 v11, s[4:7], s31 offen lds
    v_mfma_f32_16x16x32_bf16 v[192:195], v[64:67], v[28:31], v[192:195]
    s_add_u32 m0, s36, s46
    v_mfma_f32_16x16x32_bf16 v[196:199], v[68:71], v[28:31], v[196:199]
    buffer_load_dwordx4 v12, s[8:11], s32 offen lds
    v_mfma_f32_16x16x32_bf16 v[200:203], v[72:75], v[28:31], v[200:203]
    s_add_u32 m0, s36, s47
    v_mfma_f32_16x16x32_bf16 v[204:207], v[76:79], v[28:31], v[204:207]
    buffer_load_dwordx4 v12, s[8:11], s33 offen lds
    v_mfma_f32_16x16x32_bf16 v[208:211], v[80:83], v[28:31], v[208:211]
    s_add_u32 m0, s36, s48
    v_mfma_f32_16x16x32_bf16 v[212:215], v[52:55], v[32:35], v[212:215]
    buffer_load_dwordx4 v12, s[8:11], s34 offen lds
    v_mfma_f32_16x16x32_bf16 v[216:219], v[56:59], v[32:35], v[216:219]
    s_add_u32 m0, s36, s49
    v_mfma_f32_16x16x32_bf16 v[220:223], v[60:63], v[32:35], v[220:223]
    buffer_load_dwordx4 v12, s[8:11], s35 offen lds
    v_mfma_f32_16x16x32_bf16 v[224:227], v[64:67], v[32:35], v[224:227]
    v_mfma_f32_16x16x32_bf16 v[228:231], v[68:71], v[32:35], v[228:231]
    v_mfma_f32_16x16x32_bf16 v[232:235], v[72:75], v[32:35], v[232:235]
    v_mfma_f32_16x16x32_bf16 v[236:239], v[76:79], v[32:35], v[236:239]
    v_mfma_f32_16x16x32_bf16 v[240:243], v[80:83], v[32:35], v[240:243]
    s_add_u32 s31, s31, 128
    s_add_u32 s32, s32, 458752
    s_add_u32 s33, s33, 458752
    s_add_u32 s34, s34, 458752
    s_add_u32 s35, s35, 458752
    s_add_u32 s36, s36, 49152
    s_cmp_ge_u32 s36, 147456
    s_cselect_b32 s36, 0, s36
    s_waitcnt lgkmcnt(0)
    v_mfma_f32_16x16x32_bf16 v[116:119], v[84:87], v[36:39], v[116:119]
    v_mfma_f32_16x16x32_bf16 v[120:123], v[88:91], v[36:39], v[120:123]
    v_mfma_f32_16x16x32_bf16 v[124:127], v[92:95], v[36:39], v[124:127]
    v_mfma_f32_16x16x32_bf16 v[128:131], v[96:99], v[36:39], v[128:131]
    v_mfma_f32_16x16x32_bf16 v[132:135], v[100:103], v[36:39], v[132:135]
    v_mfma_f32_16x16x32_bf16 v[136:139], v[104:107], v[36:39], v[136:139]
    v_mfma_f32_16x16x32_bf16 v[140:143], v[108:111], v[36:39], v[140:143]
    v_mfma_f32_16x16x32_bf16 v[144:147], v[112:115], v[36:39], v[144:147]
    v_mfma_f32_16x16x32_bf16 v[148:151], v[84:87], v[40:43], v[148:151]
    v_mfma_f32_16x16x32_bf16 v[152:155], v[88:91], v[40:43], v[152:155]
    v_mfma_f32_16x16x32_bf16 v[156:159], v[92:95], v[40:43], v[156:159]
    v_mfma_f32_16x16x32_bf16 v[160:163], v[96:99], v[40:43], v[160:163]
    v_mfma_f32_16x16x32_bf16 v[164:167], v[100:103], v[40:43], v[164:167]
    v_mfma_f32_16x16x32_bf16 v[168:171], v[104:107], v[40:43], v[168:171]
    v_mfma_f32_16x16x32_bf16 v[172:175], v[108:111], v[40:43], v[172:175]
    v_mfma_f32_16x16x32_bf16 v[176:179], v[112:115], v[40:43], v[176:179]
    s_waitcnt vmcnt(6)
    s_barrier
    v_add_u32 v16, s37, v13
    v_add_u32 v17, s37, v14
    v_add_u32 v18, s37, v15
    s_add_u32 s37, s37, 49152
    s_cmp_ge_u32 s37, 147456
    s_cselect_b32 s37, 0, s37
    ds_read_b128 v[20:23], v16 offset:0
    ds_read_b128 v[24:27], v16 offset:2048
    ds_read_b128 v[28:31], v16 offset:4096
    ds_read_b128 v[32:35], v16 offset:6144
    ds_read_b64_tr_b16 v[52:53], v17 offset:0
    ds_read_b64_tr_b16 v[54:55], v17 offset:512
    ds_read_b64_tr_b16 v[56:57], v18 offset:0
    ds_read_b64_tr_b16 v[58:59], v18 offset:512
    ds_read_b64_tr_b16 v[60:61], v17 offset:8192
    ds_read_b64_tr_b16 v[62:63], v17 offset:8704
    ds_read_b64_tr_b16 v[64:65], v18 offset:8192
    ds_read_b64_tr_b16 v[66:67], v18 offset:8704
    ds_read_b64_tr_b16 v[68:69], v17 offset:16384
    ds_read_b64_tr_b16 v[70:71], v17 offset:16896
    ds_read_b64_tr_b16 v[72:73], v18 offset:16384
    ds_read_b64_tr_b16 v[74:75], v18 offset:16896
    ds_read_b64_tr_b16 v[76:77], v17 offset:24576
    ds_read_b64_tr_b16 v[78:79], v17 offset:25088
    ds_read_b64_tr_b16 v[80:81], v18 offset:24576
    ds_read_b64_tr_b16 v[82:83], v18 offset:25088
    v_mfma_f32_16x16x32_bf16 v[180:183], v[84:87], v[44:47], v[180:183]
    v_mfma_f32_16x16x32_bf16 v[184:187], v[88:91], v[44:47], v[184:187]
    v_mfma_f32_16x16x32_bf16 v[188:191], v[92:95], v[44:47], v[188:191]
    v_mfma_f32_16x16x32_bf16 v[192:195], v[96:99], v[44:47], v[192:195]
    v_mfma_f32_16x16x32_bf16 v[196:199], v[100:103], v[44:47], v[196:199]
    v_mfma_f32_16x16x32_bf16 v[200:203], v[104:107], v[44:47], v[200:203]
    v_mfma_f32_16x16x32_bf16 v[204:207], v[108:111], v[44:47], v[204:207]
    v_mfma_f32_16x16x32_bf16 v[208:211], v[112:115], v[44:47], v[208:211]
    v_mfma_f32_16x16x32_bf16 v[212:215], v[84:87], v[48:51], v[212:215]
    v_mfma_f32_16x16x32_bf16 v[216:219], v[88:91], v[48:51], v[216:219]
    v_mfma_f32_16x16x32_bf16 v[220:223], v[92:95], v[48:51], v[220:223]
    v_mfma_f32_16x16x32_bf16 v[224:227], v[96:99], v[48:51], v[224:227]
    v_mfma_f32_16x16x32_bf16 v[228:231], v[100:103], v[48:51], v[228:231]
    v_mfma_f32_16x16x32_bf16 v[232:235], v[104:107], v[48:51], v[232:235]
    v_mfma_f32_16x16x32_bf16 v[236:239], v[108:111], v[48:51], v[236:239]
    v_mfma_f32_16x16x32_bf16 v[240:243], v[112:115], v[48:51], v[240:243]
    s_waitcnt lgkmcnt(0)
    v_mfma_f32_16x16x32_bf16 v[116:119], v[52:55], v[20:23], v[116:119]
    v_mfma_f32_16x16x32_bf16 v[120:123], v[56:59], v[20:23], v[120:123]
    v_mfma_f32_16x16x32_bf16 v[124:127], v[60:63], v[20:23], v[124:127]
    v_mfma_f32_16x16x32_bf16 v[128:131], v[64:67], v[20:23], v[128:131]
    v_mfma_f32_16x16x32_bf16 v[132:135], v[68:71], v[20:23], v[132:135]
    v_mfma_f32_16x16x32_bf16 v[136:139], v[72:75], v[20:23], v[136:139]
    v_mfma_f32_16x16x32_bf16 v[140:143], v[76:79], v[20:23], v[140:143]
    v_mfma_f32_16x16x32_bf16 v[144:147], v[80:83], v[20:23], v[144:147]
    v_mfma_f32_16x16x32_bf16 v[148:151], v[52:55], v[24:27], v[148:151]
    v_mfma_f32_16x16x32_bf16 v[152:155], v[56:59], v[24:27], v[152:155]
    v_mfma_f32_16x16x32_bf16 v[156:159], v[60:63], v[24:27], v[156:159]
    v_mfma_f32_16x16x32_bf16 v[160:163], v[64:67], v[24:27], v[160:163]
    v_mfma_f32_16x16x32_bf16 v[164:167], v[68:71], v[24:27], v[164:167]
    v_mfma_f32_16x16x32_bf16 v[168:171], v[72:75], v[24:27], v[168:171]
    v_mfma_f32_16x16x32_bf16 v[172:175], v[76:79], v[24:27], v[172:175]
    v_mfma_f32_16x16x32_bf16 v[176:179], v[80:83], v[24:27], v[176:179]
    s_waitcnt vmcnt(0)
    s_barrier
    v_add_u32 v16, s37, v13
    v_add_u32 v17, s37, v14
    v_add_u32 v18, s37, v15
    s_add_u32 s37, s37, 49152
    s_cmp_ge_u32 s37, 147456
    s_cselect_b32 s37, 0, s37
    ds_read_b128 v[36:39], v16 offset:0
    ds_read_b128 v[40:43], v16 offset:2048
    ds_read_b128 v[44:47], v16 offset:4096
    ds_read_b128 v[48:51], v16 offset:6144
    ds_read_b64_tr_b16 v[84:85], v17 offset:0
    ds_read_b64_tr_b16 v[86:87], v17 offset:512
    ds_read_b64_tr_b16 v[88:89], v18 offset:0
    ds_read_b64_tr_b16 v[90:91], v18 offset:512
    ds_read_b64_tr_b16 v[92:93], v17 offset:8192
    ds_read_b64_tr_b16 v[94:95], v17 offset:8704
    ds_read_b64_tr_b16 v[96:97], v18 offset:8192
    ds_read_b64_tr_b16 v[98:99], v18 offset:8704
    ds_read_b64_tr_b16 v[100:101], v17 offset:16384
    ds_read_b64_tr_b16 v[102:103], v17 offset:16896
    ds_read_b64_tr_b16 v[104:105], v18 offset:16384
    ds_read_b64_tr_b16 v[106:107], v18 offset:16896
    ds_read_b64_tr_b16 v[108:109], v17 offset:24576
    ds_read_b64_tr_b16 v[110:111], v17 offset:25088
    ds_read_b64_tr_b16 v[112:113], v18 offset:24576
    ds_read_b64_tr_b16 v[114:115], v18 offset:25088
    v_mfma_f32_16x16x32_bf16 v[180:183], v[52:55], v[28:31], v[180:183]
    v_mfma_f32_16x16x32_bf16 v[184:187], v[56:59], v[28:31], v[184:187]
    v_mfma_f32_16x16x32_bf16 v[188:191], v[60:63], v[28:31], v[188:191]
    v_mfma_f32_16x16x32_bf16 v[192:195], v[64:67], v[28:31], v[192:195]
    v_mfma_f32_16x16x32_bf16 v[196:199], v[68:71], v[28:31], v[196:199]
    v_mfma_f32_16x16x32_bf16 v[200:203], v[72:75], v[28:31], v[200:203]
    v_mfma_f32_16x16x32_bf16 v[204:207], v[76:79], v[28:31], v[204:207]
    v_mfma_f32_16x16x32_bf16 v[208:211], v[80:83], v[28:31], v[208:211]
    v_mfma_f32_16x16x32_bf16 v[212:215], v[52:55], v[32:35], v[212:215]
    v_mfma_f32_16x16x32_bf16 v[216:219], v[56:59], v[32:35], v[216:219]
    v_mfma_f32_16x16x32_bf16 v[220:223], v[60:63], v[32:35], v[220:223]
    v_mfma_f32_16x16x32_bf16 v[224:227], v[64:67], v[32:35], v[224:227]
    v_mfma_f32_16x16x32_bf16 v[228:231], v[68:71], v[32:35], v[228:231]
    v_mfma_f32_16x16x32_bf16 v[232:235], v[72:75], v[32:35], v[232:235]
    v_mfma_f32_16x16x32_bf16 v[236:239], v[76:79], v[32:35], v[236:239]
    v_mfma_f32_16x16x32_bf16 v[240:243], v[80:83], v[32:35], v[240:243]
    s_waitcnt lgkmcnt(0)
    v_mfma_f32_16x16x32_bf16 v[116:119], v[84:87], v[36:39], v[116:119]
    v_mfma_f32_16x16x32_bf16 v[120:123], v[88:91], v[36:39], v[120:123]
    v_mfma_f32_16x16x32_bf16 v[124:127], v[92:95], v[36:39], v[124:127]
    v_mfma_f32_16x16x32_bf16 v[128:131], v[96:99], v[36:39], v[128:131]
    v_mfma_f32_16x16x32_bf16 v[132:135], v[100:103], v[36:39], v[132:135]
    v_mfma_f32_16x16x32_bf16 v[136:139], v[104:107], v[36:39], v[136:139]
    v_mfma_f32_16x16x32_bf16 v[140:143], v[108:111], v[36:39], v[140:143]
    v_mfma_f32_16x16x32_bf16 v[144:147], v[112:115], v[36:39], v[144:147]
    v_mfma_f32_16x16x32_bf16 v[148:151], v[84:87], v[40:43], v[148:151]
    v_mfma_f32_16x16x32_bf16 v[152:155], v[88:91], v[40:43], v[152:155]
    v_mfma_f32_16x16x32_bf16 v[156:159], v[92:95], v[40:43], v[156:159]
    v_mfma_f32_16x16x32_bf16 v[160:163], v[96:99], v[40:43], v[160:163]
    v_mfma_f32_16x16x32_bf16 v[164:167], v[100:103], v[40:43], v[164:167]
    v_mfma_f32_16x16x32_bf16 v[168:171], v[104:107], v[40:43], v[168:171]
    v_mfma_f32_16x16x32_bf16 v[172:175], v[108:111], v[40:43], v[172:175]
    v_mfma_f32_16x16x32_bf16 v[176:179], v[112:115], v[40:43], v[176:179]
    v_mfma_f32_16x16x32_bf16 v[180:183], v[84:87], v[44:47], v[180:183]
    v_mfma_f32_16x16x32_bf16 v[184:187], v[88:91], v[44:47], v[184:187]
    v_mfma_f32_16x16x32_bf16 v[188:191], v[92:95], v[44:47], v[188:191]
    v_mfma_f32_16x16x32_bf16 v[192:195], v[96:99], v[44:47], v[192:195]
    v_mfma_f32_16x16x32_bf16 v[196:199], v[100:103], v[44:47], v[196:199]
    v_mfma_f32_16x16x32_bf16 v[200:203], v[104:107], v[44:47], v[200:203]
    v_mfma_f32_16x16x32_bf16 v[204:207], v[108:111], v[44:47], v[204:207]
    v_mfma_f32_16x16x32_bf16 v[208:211], v[112:115], v[44:47], v[208:211]
    v_mfma_f32_16x16x32_bf16 v[212:215], v[84:87], v[48:51], v[212:215]
    v_mfma_f32_16x16x32_bf16 v[216:219], v[88:91], v[48:51], v[216:219]
    v_mfma_f32_16x16x32_bf16 v[220:223], v[92:95], v[48:51], v[220:223]
    v_mfma_f32_16x16x32_bf16 v[224:227], v[96:99], v[48:51], v[224:227]
    v_mfma_f32_16x16x32_bf16 v[228:231], v[100:103], v[48:51], v[228:231]
    v_mfma_f32_16x16x32_bf16 v[232:235], v[104:107], v[48:51], v[232:235]
    v_mfma_f32_16x16x32_bf16 v[236:239], v[108:111], v[48:51], v[236:239]
    v_mfma_f32_16x16x32_bf16 v[240:243], v[112:115], v[48:51], v[240:243]
    s_waitcnt vmcnt(0) lgkmcnt(0)
    s_barrier
    s_xor_b32 s38, s26, 4
    s_mul_i32 s38, s38, 16384
    v_lshlrev_b32 v2, 4, v1
    v_add_u32 v2, s38, v2
    s_nop 7
    s_cmp_eq_u32 s27, 0
    s_cbranch_scc0 L_give1_mlp1_1_kernel
    ds_write_b128 v2, v[180:183] offset:0
    ds_write_b128 v2, v[184:187] offset:1024
    ds_write_b128 v2, v[188:191] offset:2048
    ds_write_b128 v2, v[192:195] offset:3072
    ds_write_b128 v2, v[196:199] offset:4096
    ds_write_b128 v2, v[200:203] offset:5120
    ds_write_b128 v2, v[204:207] offset:6144
    ds_write_b128 v2, v[208:211] offset:7168
    ds_write_b128 v2, v[212:215] offset:8192
    ds_write_b128 v2, v[216:219] offset:9216
    ds_write_b128 v2, v[220:223] offset:10240
    ds_write_b128 v2, v[224:227] offset:11264
    ds_write_b128 v2, v[228:231] offset:12288
    ds_write_b128 v2, v[232:235] offset:13312
    ds_write_b128 v2, v[236:239] offset:14336
    ds_write_b128 v2, v[240:243] offset:15360
    s_branch L_give_done_mlp1_1_kernel
L_give1_mlp1_1_kernel:
    ds_write_b128 v2, v[116:119] offset:0
    ds_write_b128 v2, v[120:123] offset:1024
    ds_write_b128 v2, v[124:127] offset:2048
    ds_write_b128 v2, v[128:131] offset:3072
    ds_write_b128 v2, v[132:135] offset:4096
    ds_write_b128 v2, v[136:139] offset:5120
    ds_write_b128 v2, v[140:143] offset:6144
    ds_write_b128 v2, v[144:147] offset:7168
    ds_write_b128 v2, v[148:151] offset:8192
    ds_write_b128 v2, v[152:155] offset:9216
    ds_write_b128 v2, v[156:159] offset:10240
    ds_write_b128 v2, v[160:163] offset:11264
    ds_write_b128 v2, v[164:167] offset:12288
    ds_write_b128 v2, v[168:171] offset:13312
    ds_write_b128 v2, v[172:175] offset:14336
    ds_write_b128 v2, v[176:179] offset:15360
L_give_done_mlp1_1_kernel:
    s_waitcnt lgkmcnt(0)
    s_barrier
    s_mul_i32 s38, s26, 16384
    v_lshlrev_b32 v2, 4, v1
    v_add_u32 v2, s38, v2
    s_mul_i32 s38, s27, 64
    s_cmp_eq_u32 s27, 0
    s_cbranch_scc0 L_keep1_mlp1_1_kernel
    ds_read_b128 v[20:23], v2 offset:0
    ds_read_b128 v[24:27], v2 offset:1024
    ds_read_b128 v[28:31], v2 offset:2048
    ds_read_b128 v[32:35], v2 offset:3072
    ds_read_b128 v[36:39], v2 offset:4096
    ds_read_b128 v[40:43], v2 offset:5120
    ds_read_b128 v[44:47], v2 offset:6144
    ds_read_b128 v[48:51], v2 offset:7168
    ds_read_b128 v[52:55], v2 offset:8192
    ds_read_b128 v[56:59], v2 offset:9216
    ds_read_b128 v[60:63], v2 offset:10240
    ds_read_b128 v[64:67], v2 offset:11264
    ds_read_b128 v[68:71], v2 offset:12288
    ds_read_b128 v[72:75], v2 offset:13312
    ds_read_b128 v[76:79], v2 offset:14336
    ds_read_b128 v[80:83], v2 offset:15360
    s_waitcnt lgkmcnt(0)
    v_add_f32 v20, v116, v20
    v_add_f32 v21, v117, v21
    v_add_f32 v22, v118, v22
    v_add_f32 v23, v119, v23
    v_add_f32 v24, v120, v24
    v_add_f32 v25, v121, v25
    v_add_f32 v26, v122, v26
    v_add_f32 v27, v123, v27
    v_add_f32 v28, v124, v28
    v_add_f32 v29, v125, v29
    v_add_f32 v30, v126, v30
    v_add_f32 v31, v127, v31
    v_add_f32 v32, v128, v32
    v_add_f32 v33, v129, v33
    v_add_f32 v34, v130, v34
    v_add_f32 v35, v131, v35
    v_add_f32 v36, v132, v36
    v_add_f32 v37, v133, v37
    v_add_f32 v38, v134, v38
    v_add_f32 v39, v135, v39
    v_add_f32 v40, v136, v40
    v_add_f32 v41, v137, v41
    v_add_f32 v42, v138, v42
    v_add_f32 v43, v139, v43
    v_add_f32 v44, v140, v44
    v_add_f32 v45, v141, v45
    v_add_f32 v46, v142, v46
    v_add_f32 v47, v143, v47
    v_add_f32 v48, v144, v48
    v_add_f32 v49, v145, v49
    v_add_f32 v50, v146, v50
    v_add_f32 v51, v147, v51
    v_add_f32 v52, v148, v52
    v_add_f32 v53, v149, v53
    v_add_f32 v54, v150, v54
    v_add_f32 v55, v151, v55
    v_add_f32 v56, v152, v56
    v_add_f32 v57, v153, v57
    v_add_f32 v58, v154, v58
    v_add_f32 v59, v155, v59
    v_add_f32 v60, v156, v60
    v_add_f32 v61, v157, v61
    v_add_f32 v62, v158, v62
    v_add_f32 v63, v159, v63
    v_add_f32 v64, v160, v64
    v_add_f32 v65, v161, v65
    v_add_f32 v66, v162, v66
    v_add_f32 v67, v163, v67
    v_add_f32 v68, v164, v68
    v_add_f32 v69, v165, v69
    v_add_f32 v70, v166, v70
    v_add_f32 v71, v167, v71
    v_add_f32 v72, v168, v72
    v_add_f32 v73, v169, v73
    v_add_f32 v74, v170, v74
    v_add_f32 v75, v171, v75
    v_add_f32 v76, v172, v76
    v_add_f32 v77, v173, v77
    v_add_f32 v78, v174, v78
    v_add_f32 v79, v175, v79
    v_add_f32 v80, v176, v80
    v_add_f32 v81, v177, v81
    v_add_f32 v82, v178, v82
    v_add_f32 v83, v179, v83
    s_branch L_keep_done_mlp1_1_kernel
L_keep1_mlp1_1_kernel:
    ds_read_b128 v[20:23], v2 offset:0
    ds_read_b128 v[24:27], v2 offset:1024
    ds_read_b128 v[28:31], v2 offset:2048
    ds_read_b128 v[32:35], v2 offset:3072
    ds_read_b128 v[36:39], v2 offset:4096
    ds_read_b128 v[40:43], v2 offset:5120
    ds_read_b128 v[44:47], v2 offset:6144
    ds_read_b128 v[48:51], v2 offset:7168
    ds_read_b128 v[52:55], v2 offset:8192
    ds_read_b128 v[56:59], v2 offset:9216
    ds_read_b128 v[60:63], v2 offset:10240
    ds_read_b128 v[64:67], v2 offset:11264
    ds_read_b128 v[68:71], v2 offset:12288
    ds_read_b128 v[72:75], v2 offset:13312
    ds_read_b128 v[76:79], v2 offset:14336
    ds_read_b128 v[80:83], v2 offset:15360
    s_waitcnt lgkmcnt(0)
    v_add_f32 v20, v180, v20
    v_add_f32 v21, v181, v21
    v_add_f32 v22, v182, v22
    v_add_f32 v23, v183, v23
    v_add_f32 v24, v184, v24
    v_add_f32 v25, v185, v25
    v_add_f32 v26, v186, v26
    v_add_f32 v27, v187, v27
    v_add_f32 v28, v188, v28
    v_add_f32 v29, v189, v29
    v_add_f32 v30, v190, v30
    v_add_f32 v31, v191, v31
    v_add_f32 v32, v192, v32
    v_add_f32 v33, v193, v33
    v_add_f32 v34, v194, v34
    v_add_f32 v35, v195, v35
    v_add_f32 v36, v196, v36
    v_add_f32 v37, v197, v37
    v_add_f32 v38, v198, v38
    v_add_f32 v39, v199, v39
    v_add_f32 v40, v200, v40
    v_add_f32 v41, v201, v41
    v_add_f32 v42, v202, v42
    v_add_f32 v43, v203, v43
    v_add_f32 v44, v204, v44
    v_add_f32 v45, v205, v45
    v_add_f32 v46, v206, v46
    v_add_f32 v47, v207, v47
    v_add_f32 v48, v208, v48
    v_add_f32 v49, v209, v49
    v_add_f32 v50, v210, v50
    v_add_f32 v51, v211, v51
    v_add_f32 v52, v212, v52
    v_add_f32 v53, v213, v53
    v_add_f32 v54, v214, v54
    v_add_f32 v55, v215, v55
    v_add_f32 v56, v216, v56
    v_add_f32 v57, v217, v57
    v_add_f32 v58, v218, v58
    v_add_f32 v59, v219, v59
    v_add_f32 v60, v220, v60
    v_add_f32 v61, v221, v61
    v_add_f32 v62, v222, v62
    v_add_f32 v63, v223, v63
    v_add_f32 v64, v224, v64
    v_add_f32 v65, v225, v65
    v_add_f32 v66, v226, v66
    v_add_f32 v67, v227, v67
    v_add_f32 v68, v228, v68
    v_add_f32 v69, v229, v69
    v_add_f32 v70, v230, v70
    v_add_f32 v71, v231, v71
    v_add_f32 v72, v232, v72
    v_add_f32 v73, v233, v73
    v_add_f32 v74, v234, v74
    v_add_f32 v75, v235, v75
    v_add_f32 v76, v236, v76
    v_add_f32 v77, v237, v77
    v_add_f32 v78, v238, v78
    v_add_f32 v79, v239, v79
    v_add_f32 v80, v240, v80
    v_add_f32 v81, v241, v81
    v_add_f32 v82, v242, v82
    v_add_f32 v83, v243, v83
L_keep_done_mlp1_1_kernel:
    s_add_u32 s12, s50, 25165824
    s_addc_u32 s13, s51, 0
    s_mov_b32 s14, 14680064
    s_mov_b32 s15, 0x00020000
    s_mov_b32 s20, s56
    s_mov_b32 s21, s57
    s_mov_b32 s22, 7168
    s_mov_b32 s23, 0x00020000
    s_mov_b32 s62, 0x3d372713
    s_mov_b32 s63, 0xc0135761
    v_and_b32 v2, 15, v1
    s_lshl_b32 s38, s24, 7
    s_lshl_b32 s39, s28, 6
    s_add_u32 s38, s38, s39
    s_lshl_b32 s39, s27, 5
    s_add_u32 s38, s38, s39
    v_add_u32 v2, s38, v2
    s_mov_b32 s38, 7168
    v_mul_lo_u32 v2, v2, s38
    v_lshrrev_b32 v3, 4, v1
    v_lshlrev_b32 v3, 3, v3
    s_lshl_b32 s38, s29, 6
    s_mul_i32 s39, s25, 512
    s_add_u32 s38, s38, s39
    v_add3_u32 v2, v2, v3, s38
    v_lshrrev_b32 v3, 4, v1
    v_lshlrev_b32 v3, 3, v3
    s_lshl_b32 s38, s29, 6
    s_mul_i32 s39, s25, 512
    s_add_u32 s38, s38, s39
    v_add_u32 v3, s38, v3
    buffer_load_dwordx2 v[84:85], v3, s[20:23], 0 offen offset:0
    buffer_load_dwordx2 v[86:87], v3, s[20:23], 0 offen offset:32
    buffer_load_dwordx2 v[88:89], v3, s[20:23], 0 offen offset:128
    buffer_load_dwordx2 v[90:91], v3, s[20:23], 0 offen offset:160
    buffer_load_dwordx2 v[92:93], v3, s[20:23], 0 offen offset:256
    buffer_load_dwordx2 v[94:95], v3, s[20:23], 0 offen offset:288
    buffer_load_dwordx2 v[96:97], v3, s[20:23], 0 offen offset:384
    buffer_load_dwordx2 v[98:99], v3, s[20:23], 0 offen offset:416
    s_waitcnt vmcnt(0)
    v_cvt_pk_bf16_f32 v4, v20, v21
    v_lshlrev_b32 v20, 16, v4
    v_and_b32 v21, 0xffff0000, v4
    v_cvt_pk_bf16_f32 v4, v22, v23
    v_lshlrev_b32 v22, 16, v4
    v_and_b32 v23, 0xffff0000, v4
    v_lshlrev_b32 v4, 16, v84
    v_add_f32 v20, v4, v20
    v_and_b32 v4, 0xffff0000, v84
    v_add_f32 v21, v4, v21
    v_lshlrev_b32 v4, 16, v85
    v_add_f32 v22, v4, v22
    v_and_b32 v4, 0xffff0000, v85
    v_add_f32 v23, v4, v23
    v_cvt_pk_bf16_f32 v4, v20, v21
    v_lshlrev_b32 v20, 16, v4
    v_and_b32 v21, 0xffff0000, v4
    v_cvt_pk_bf16_f32 v4, v22, v23
    v_lshlrev_b32 v22, 16, v4
    v_and_b32 v23, 0xffff0000, v4
    v_mul_f32 v100, v20, v20
    v_mul_f32 v101, v21, v21
    v_mul_f32 v102, v22, v22
    v_mul_f32 v103, v23, v23
    v_fma_f32 v100, v100, s62, 1.0
    v_fma_f32 v101, v101, s62, 1.0
    v_fma_f32 v102, v102, s62, 1.0
    v_fma_f32 v103, v103, s62, 1.0
    v_mul_f32 v100, v100, v20
    v_mul_f32 v101, v101, v21
    v_mul_f32 v102, v102, v22
    v_mul_f32 v103, v103, v23
    v_mul_f32 v100, s63, v100
    v_mul_f32 v101, s63, v101
    v_mul_f32 v102, s63, v102
    v_mul_f32 v103, s63, v103
    v_exp_f32 v100, v100
    v_exp_f32 v101, v101
    v_exp_f32 v102, v102
    v_exp_f32 v103, v103
    s_nop 0
    v_add_f32 v100, 1.0, v100
    v_add_f32 v101, 1.0, v101
    v_add_f32 v102, 1.0, v102
    v_add_f32 v103, 1.0, v103
    v_rcp_f32 v100, v100
    v_rcp_f32 v101, v101
    v_rcp_f32 v102, v102
    v_rcp_f32 v103, v103
    s_nop 0
    v_mul_f32 v20, v20, v100
    v_mul_f32 v21, v21, v101
    v_mul_f32 v22, v22, v102
    v_mul_f32 v23, v23, v103
    v_cvt_pk_bf16_f32 v4, v20, v21
    v_cvt_pk_bf16_f32 v5, v22, v23
    s_mov_b32 s39, 0
    buffer_store_dwordx2 v[4:5], v2, s[12:15], s39 offen offset:0
    v_cvt_pk_bf16_f32 v4, v24, v25
    v_lshlrev_b32 v24, 16, v4
    v_and_b32 v25, 0xffff0000, v4
    v_cvt_pk_bf16_f32 v4, v26, v27
    v_lshlrev_b32 v26, 16, v4
    v_and_b32 v27, 0xffff0000, v4
    v_lshlrev_b32 v4, 16, v86
    v_add_f32 v24, v4, v24
    v_and_b32 v4, 0xffff0000, v86
    v_add_f32 v25, v4, v25
    v_lshlrev_b32 v4, 16, v87
    v_add_f32 v26, v4, v26
    v_and_b32 v4, 0xffff0000, v87
    v_add_f32 v27, v4, v27
    v_cvt_pk_bf16_f32 v4, v24, v25
    v_lshlrev_b32 v24, 16, v4
    v_and_b32 v25, 0xffff0000, v4
    v_cvt_pk_bf16_f32 v4, v26, v27
    v_lshlrev_b32 v26, 16, v4
    v_and_b32 v27, 0xffff0000, v4
    v_mul_f32 v100, v24, v24
    v_mul_f32 v101, v25, v25
    v_mul_f32 v102, v26, v26
    v_mul_f32 v103, v27, v27
    v_fma_f32 v100, v100, s62, 1.0
    v_fma_f32 v101, v101, s62, 1.0
    v_fma_f32 v102, v102, s62, 1.0
    v_fma_f32 v103, v103, s62, 1.0
    v_mul_f32 v100, v100, v24
    v_mul_f32 v101, v101, v25
    v_mul_f32 v102, v102, v26
    v_mul_f32 v103, v103, v27
    v_mul_f32 v100, s63, v100
    v_mul_f32 v101, s63, v101
    v_mul_f32 v102, s63, v102
    v_mul_f32 v103, s63, v103
    v_exp_f32 v100, v100
    v_exp_f32 v101, v101
    v_exp_f32 v102, v102
    v_exp_f32 v103, v103
    s_nop 0
    v_add_f32 v100, 1.0, v100
    v_add_f32 v101, 1.0, v101
    v_add_f32 v102, 1.0, v102
    v_add_f32 v103, 1.0, v103
    v_rcp_f32 v100, v100
    v_rcp_f32 v101, v101
    v_rcp_f32 v102, v102
    v_rcp_f32 v103, v103
    s_nop 0
    v_mul_f32 v24, v24, v100
    v_mul_f32 v25, v25, v101
    v_mul_f32 v26, v26, v102
    v_mul_f32 v27, v27, v103
    v_cvt_pk_bf16_f32 v4, v24, v25
    v_cvt_pk_bf16_f32 v5, v26, v27
    s_mov_b32 s39, 0
    buffer_store_dwordx2 v[4:5], v2, s[12:15], s39 offen offset:32
    v_cvt_pk_bf16_f32 v4, v28, v29
    v_lshlrev_b32 v28, 16, v4
    v_and_b32 v29, 0xffff0000, v4
    v_cvt_pk_bf16_f32 v4, v30, v31
    v_lshlrev_b32 v30, 16, v4
    v_and_b32 v31, 0xffff0000, v4
    v_lshlrev_b32 v4, 16, v88
    v_add_f32 v28, v4, v28
    v_and_b32 v4, 0xffff0000, v88
    v_add_f32 v29, v4, v29
    v_lshlrev_b32 v4, 16, v89
    v_add_f32 v30, v4, v30
    v_and_b32 v4, 0xffff0000, v89
    v_add_f32 v31, v4, v31
    v_cvt_pk_bf16_f32 v4, v28, v29
    v_lshlrev_b32 v28, 16, v4
    v_and_b32 v29, 0xffff0000, v4
    v_cvt_pk_bf16_f32 v4, v30, v31
    v_lshlrev_b32 v30, 16, v4
    v_and_b32 v31, 0xffff0000, v4
    v_mul_f32 v100, v28, v28
    v_mul_f32 v101, v29, v29
    v_mul_f32 v102, v30, v30
    v_mul_f32 v103, v31, v31
    v_fma_f32 v100, v100, s62, 1.0
    v_fma_f32 v101, v101, s62, 1.0
    v_fma_f32 v102, v102, s62, 1.0
    v_fma_f32 v103, v103, s62, 1.0
    v_mul_f32 v100, v100, v28
    v_mul_f32 v101, v101, v29
    v_mul_f32 v102, v102, v30
    v_mul_f32 v103, v103, v31
    v_mul_f32 v100, s63, v100
    v_mul_f32 v101, s63, v101
    v_mul_f32 v102, s63, v102
    v_mul_f32 v103, s63, v103
    v_exp_f32 v100, v100
    v_exp_f32 v101, v101
    v_exp_f32 v102, v102
    v_exp_f32 v103, v103
    s_nop 0
    v_add_f32 v100, 1.0, v100
    v_add_f32 v101, 1.0, v101
    v_add_f32 v102, 1.0, v102
    v_add_f32 v103, 1.0, v103
    v_rcp_f32 v100, v100
    v_rcp_f32 v101, v101
    v_rcp_f32 v102, v102
    v_rcp_f32 v103, v103
    s_nop 0
    v_mul_f32 v28, v28, v100
    v_mul_f32 v29, v29, v101
    v_mul_f32 v30, v30, v102
    v_mul_f32 v31, v31, v103
    v_cvt_pk_bf16_f32 v4, v28, v29
    v_cvt_pk_bf16_f32 v5, v30, v31
    s_mov_b32 s39, 0
    buffer_store_dwordx2 v[4:5], v2, s[12:15], s39 offen offset:128
    v_cvt_pk_bf16_f32 v4, v32, v33
    v_lshlrev_b32 v32, 16, v4
    v_and_b32 v33, 0xffff0000, v4
    v_cvt_pk_bf16_f32 v4, v34, v35
    v_lshlrev_b32 v34, 16, v4
    v_and_b32 v35, 0xffff0000, v4
    v_lshlrev_b32 v4, 16, v90
    v_add_f32 v32, v4, v32
    v_and_b32 v4, 0xffff0000, v90
    v_add_f32 v33, v4, v33
    v_lshlrev_b32 v4, 16, v91
    v_add_f32 v34, v4, v34
    v_and_b32 v4, 0xffff0000, v91
    v_add_f32 v35, v4, v35
    v_cvt_pk_bf16_f32 v4, v32, v33
    v_lshlrev_b32 v32, 16, v4
    v_and_b32 v33, 0xffff0000, v4
    v_cvt_pk_bf16_f32 v4, v34, v35
    v_lshlrev_b32 v34, 16, v4
    v_and_b32 v35, 0xffff0000, v4
    v_mul_f32 v100, v32, v32
    v_mul_f32 v101, v33, v33
    v_mul_f32 v102, v34, v34
    v_mul_f32 v103, v35, v35
    v_fma_f32 v100, v100, s62, 1.0
    v_fma_f32 v101, v101, s62, 1.0
    v_fma_f32 v102, v102, s62, 1.0
    v_fma_f32 v103, v103, s62, 1.0
    v_mul_f32 v100, v100, v32
    v_mul_f32 v101, v101, v33
    v_mul_f32 v102, v102, v34
    v_mul_f32 v103, v103, v35
    v_mul_f32 v100, s63, v100
    v_mul_f32 v101, s63, v101
    v_mul_f32 v102, s63, v102
    v_mul_f32 v103, s63, v103
    v_exp_f32 v100, v100
    v_exp_f32 v101, v101
    v_exp_f32 v102, v102
    v_exp_f32 v103, v103
    s_nop 0
    v_add_f32 v100, 1.0, v100
    v_add_f32 v101, 1.0, v101
    v_add_f32 v102, 1.0, v102
    v_add_f32 v103, 1.0, v103
    v_rcp_f32 v100, v100
    v_rcp_f32 v101, v101
    v_rcp_f32 v102, v102
    v_rcp_f32 v103, v103
    s_nop 0
    v_mul_f32 v32, v32, v100
    v_mul_f32 v33, v33, v101
    v_mul_f32 v34, v34, v102
    v_mul_f32 v35, v35, v103
    v_cvt_pk_bf16_f32 v4, v32, v33
    v_cvt_pk_bf16_f32 v5, v34, v35
    s_mov_b32 s39, 0
    buffer_store_dwordx2 v[4:5], v2, s[12:15], s39 offen offset:160
    v_cvt_pk_bf16_f32 v4, v36, v37
    v_lshlrev_b32 v36, 16, v4
    v_and_b32 v37, 0xffff0000, v4
    v_cvt_pk_bf16_f32 v4, v38, v39
    v_lshlrev_b32 v38, 16, v4
    v_and_b32 v39, 0xffff0000, v4
    v_lshlrev_b32 v4, 16, v92
    v_add_f32 v36, v4, v36
    v_and_b32 v4, 0xffff0000, v92
    v_add_f32 v37, v4, v37
    v_lshlrev_b32 v4, 16, v93
    v_add_f32 v38, v4, v38
    v_and_b32 v4, 0xffff0000, v93
    v_add_f32 v39, v4, v39
    v_cvt_pk_bf16_f32 v4, v36, v37
    v_lshlrev_b32 v36, 16, v4
    v_and_b32 v37, 0xffff0000, v4
    v_cvt_pk_bf16_f32 v4, v38, v39
    v_lshlrev_b32 v38, 16, v4
    v_and_b32 v39, 0xffff0000, v4
    v_mul_f32 v100, v36, v36
    v_mul_f32 v101, v37, v37
    v_mul_f32 v102, v38, v38
    v_mul_f32 v103, v39, v39
    v_fma_f32 v100, v100, s62, 1.0
    v_fma_f32 v101, v101, s62, 1.0
    v_fma_f32 v102, v102, s62, 1.0
    v_fma_f32 v103, v103, s62, 1.0
    v_mul_f32 v100, v100, v36
    v_mul_f32 v101, v101, v37
    v_mul_f32 v102, v102, v38
    v_mul_f32 v103, v103, v39
    v_mul_f32 v100, s63, v100
    v_mul_f32 v101, s63, v101
    v_mul_f32 v102, s63, v102
    v_mul_f32 v103, s63, v103
    v_exp_f32 v100, v100
    v_exp_f32 v101, v101
    v_exp_f32 v102, v102
    v_exp_f32 v103, v103
    s_nop 0
    v_add_f32 v100, 1.0, v100
    v_add_f32 v101, 1.0, v101
    v_add_f32 v102, 1.0, v102
    v_add_f32 v103, 1.0, v103
    v_rcp_f32 v100, v100
    v_rcp_f32 v101, v101
    v_rcp_f32 v102, v102
    v_rcp_f32 v103, v103
    s_nop 0
    v_mul_f32 v36, v36, v100
    v_mul_f32 v37, v37, v101
    v_mul_f32 v38, v38, v102
    v_mul_f32 v39, v39, v103
    v_cvt_pk_bf16_f32 v4, v36, v37
    v_cvt_pk_bf16_f32 v5, v38, v39
    s_mov_b32 s39, 0
    buffer_store_dwordx2 v[4:5], v2, s[12:15], s39 offen offset:256
    v_cvt_pk_bf16_f32 v4, v40, v41
    v_lshlrev_b32 v40, 16, v4
    v_and_b32 v41, 0xffff0000, v4
    v_cvt_pk_bf16_f32 v4, v42, v43
    v_lshlrev_b32 v42, 16, v4
    v_and_b32 v43, 0xffff0000, v4
    v_lshlrev_b32 v4, 16, v94
    v_add_f32 v40, v4, v40
    v_and_b32 v4, 0xffff0000, v94
    v_add_f32 v41, v4, v41
    v_lshlrev_b32 v4, 16, v95
    v_add_f32 v42, v4, v42
    v_and_b32 v4, 0xffff0000, v95
    v_add_f32 v43, v4, v43
    v_cvt_pk_bf16_f32 v4, v40, v41
    v_lshlrev_b32 v40, 16, v4
    v_and_b32 v41, 0xffff0000, v4
    v_cvt_pk_bf16_f32 v4, v42, v43
    v_lshlrev_b32 v42, 16, v4
    v_and_b32 v43, 0xffff0000, v4
    v_mul_f32 v100, v40, v40
    v_mul_f32 v101, v41, v41
    v_mul_f32 v102, v42, v42
    v_mul_f32 v103, v43, v43
    v_fma_f32 v100, v100, s62, 1.0
    v_fma_f32 v101, v101, s62, 1.0
    v_fma_f32 v102, v102, s62, 1.0
    v_fma_f32 v103, v103, s62, 1.0
    v_mul_f32 v100, v100, v40
    v_mul_f32 v101, v101, v41
    v_mul_f32 v102, v102, v42
    v_mul_f32 v103, v103, v43
    v_mul_f32 v100, s63, v100
    v_mul_f32 v101, s63, v101
    v_mul_f32 v102, s63, v102
    v_mul_f32 v103, s63, v103
    v_exp_f32 v100, v100
    v_exp_f32 v101, v101
    v_exp_f32 v102, v102
    v_exp_f32 v103, v103
    s_nop 0
    v_add_f32 v100, 1.0, v100
    v_add_f32 v101, 1.0, v101
    v_add_f32 v102, 1.0, v102
    v_add_f32 v103, 1.0, v103
    v_rcp_f32 v100, v100
    v_rcp_f32 v101, v101
    v_rcp_f32 v102, v102
    v_rcp_f32 v103, v103
    s_nop 0
    v_mul_f32 v40, v40, v100
    v_mul_f32 v41, v41, v101
    v_mul_f32 v42, v42, v102
    v_mul_f32 v43, v43, v103
    v_cvt_pk_bf16_f32 v4, v40, v41
    v_cvt_pk_bf16_f32 v5, v42, v43
    s_mov_b32 s39, 0
    buffer_store_dwordx2 v[4:5], v2, s[12:15], s39 offen offset:288
    v_cvt_pk_bf16_f32 v4, v44, v45
    v_lshlrev_b32 v44, 16, v4
    v_and_b32 v45, 0xffff0000, v4
    v_cvt_pk_bf16_f32 v4, v46, v47
    v_lshlrev_b32 v46, 16, v4
    v_and_b32 v47, 0xffff0000, v4
    v_lshlrev_b32 v4, 16, v96
    v_add_f32 v44, v4, v44
    v_and_b32 v4, 0xffff0000, v96
    v_add_f32 v45, v4, v45
    v_lshlrev_b32 v4, 16, v97
    v_add_f32 v46, v4, v46
    v_and_b32 v4, 0xffff0000, v97
    v_add_f32 v47, v4, v47
    v_cvt_pk_bf16_f32 v4, v44, v45
    v_lshlrev_b32 v44, 16, v4
    v_and_b32 v45, 0xffff0000, v4
    v_cvt_pk_bf16_f32 v4, v46, v47
    v_lshlrev_b32 v46, 16, v4
    v_and_b32 v47, 0xffff0000, v4
    v_mul_f32 v100, v44, v44
    v_mul_f32 v101, v45, v45
    v_mul_f32 v102, v46, v46
    v_mul_f32 v103, v47, v47
    v_fma_f32 v100, v100, s62, 1.0
    v_fma_f32 v101, v101, s62, 1.0
    v_fma_f32 v102, v102, s62, 1.0
    v_fma_f32 v103, v103, s62, 1.0
    v_mul_f32 v100, v100, v44
    v_mul_f32 v101, v101, v45
    v_mul_f32 v102, v102, v46
    v_mul_f32 v103, v103, v47
    v_mul_f32 v100, s63, v100
    v_mul_f32 v101, s63, v101
    v_mul_f32 v102, s63, v102
    v_mul_f32 v103, s63, v103
    v_exp_f32 v100, v100
    v_exp_f32 v101, v101
    v_exp_f32 v102, v102
    v_exp_f32 v103, v103
    s_nop 0
    v_add_f32 v100, 1.0, v100
    v_add_f32 v101, 1.0, v101
    v_add_f32 v102, 1.0, v102
    v_add_f32 v103, 1.0, v103
    v_rcp_f32 v100, v100
    v_rcp_f32 v101, v101
    v_rcp_f32 v102, v102
    v_rcp_f32 v103, v103
    s_nop 0
    v_mul_f32 v44, v44, v100
    v_mul_f32 v45, v45, v101
    v_mul_f32 v46, v46, v102
    v_mul_f32 v47, v47, v103
    v_cvt_pk_bf16_f32 v4, v44, v45
    v_cvt_pk_bf16_f32 v5, v46, v47
    s_mov_b32 s39, 0
    buffer_store_dwordx2 v[4:5], v2, s[12:15], s39 offen offset:384
    v_cvt_pk_bf16_f32 v4, v48, v49
    v_lshlrev_b32 v48, 16, v4
    v_and_b32 v49, 0xffff0000, v4
    v_cvt_pk_bf16_f32 v4, v50, v51
    v_lshlrev_b32 v50, 16, v4
    v_and_b32 v51, 0xffff0000, v4
    v_lshlrev_b32 v4, 16, v98
    v_add_f32 v48, v4, v48
    v_and_b32 v4, 0xffff0000, v98
    v_add_f32 v49, v4, v49
    v_lshlrev_b32 v4, 16, v99
    v_add_f32 v50, v4, v50
    v_and_b32 v4, 0xffff0000, v99
    v_add_f32 v51, v4, v51
    v_cvt_pk_bf16_f32 v4, v48, v49
    v_lshlrev_b32 v48, 16, v4
    v_and_b32 v49, 0xffff0000, v4
    v_cvt_pk_bf16_f32 v4, v50, v51
    v_lshlrev_b32 v50, 16, v4
    v_and_b32 v51, 0xffff0000, v4
    v_mul_f32 v100, v48, v48
    v_mul_f32 v101, v49, v49
    v_mul_f32 v102, v50, v50
    v_mul_f32 v103, v51, v51
    v_fma_f32 v100, v100, s62, 1.0
    v_fma_f32 v101, v101, s62, 1.0
    v_fma_f32 v102, v102, s62, 1.0
    v_fma_f32 v103, v103, s62, 1.0
    v_mul_f32 v100, v100, v48
    v_mul_f32 v101, v101, v49
    v_mul_f32 v102, v102, v50
    v_mul_f32 v103, v103, v51
    v_mul_f32 v100, s63, v100
    v_mul_f32 v101, s63, v101
    v_mul_f32 v102, s63, v102
    v_mul_f32 v103, s63, v103
    v_exp_f32 v100, v100
    v_exp_f32 v101, v101
    v_exp_f32 v102, v102
    v_exp_f32 v103, v103
    s_nop 0
    v_add_f32 v100, 1.0, v100
    v_add_f32 v101, 1.0, v101
    v_add_f32 v102, 1.0, v102
    v_add_f32 v103, 1.0, v103
    v_rcp_f32 v100, v100
    v_rcp_f32 v101, v101
    v_rcp_f32 v102, v102
    v_rcp_f32 v103, v103
    s_nop 0
    v_mul_f32 v48, v48, v100
    v_mul_f32 v49, v49, v101
    v_mul_f32 v50, v50, v102
    v_mul_f32 v51, v51, v103
    v_cvt_pk_bf16_f32 v4, v48, v49
    v_cvt_pk_bf16_f32 v5, v50, v51
    s_mov_b32 s39, 0
    buffer_store_dwordx2 v[4:5], v2, s[12:15], s39 offen offset:416
    v_cvt_pk_bf16_f32 v4, v52, v53
    v_lshlrev_b32 v52, 16, v4
    v_and_b32 v53, 0xffff0000, v4
    v_cvt_pk_bf16_f32 v4, v54, v55
    v_lshlrev_b32 v54, 16, v4
    v_and_b32 v55, 0xffff0000, v4
    v_lshlrev_b32 v4, 16, v84
    v_add_f32 v52, v4, v52
    v_and_b32 v4, 0xffff0000, v84
    v_add_f32 v53, v4, v53
    v_lshlrev_b32 v4, 16, v85
    v_add_f32 v54, v4, v54
    v_and_b32 v4, 0xffff0000, v85
    v_add_f32 v55, v4, v55
    v_cvt_pk_bf16_f32 v4, v52, v53
    v_lshlrev_b32 v52, 16, v4
    v_and_b32 v53, 0xffff0000, v4
    v_cvt_pk_bf16_f32 v4, v54, v55
    v_lshlrev_b32 v54, 16, v4
    v_and_b32 v55, 0xffff0000, v4
    v_mul_f32 v100, v52, v52
    v_mul_f32 v101, v53, v53
    v_mul_f32 v102, v54, v54
    v_mul_f32 v103, v55, v55
    v_fma_f32 v100, v100, s62, 1.0
    v_fma_f32 v101, v101, s62, 1.0
    v_fma_f32 v102, v102, s62, 1.0
    v_fma_f32 v103, v103, s62, 1.0
    v_mul_f32 v100, v100, v52
    v_mul_f32 v101, v101, v53
    v_mul_f32 v102, v102, v54
    v_mul_f32 v103, v103, v55
    v_mul_f32 v100, s63, v100
    v_mul_f32 v101, s63, v101
    v_mul_f32 v102, s63, v102
    v_mul_f32 v103, s63, v103
    v_exp_f32 v100, v100
    v_exp_f32 v101, v101
    v_exp_f32 v102, v102
    v_exp_f32 v103, v103
    s_nop 0
    v_add_f32 v100, 1.0, v100
    v_add_f32 v101, 1.0, v101
    v_add_f32 v102, 1.0, v102
    v_add_f32 v103, 1.0, v103
    v_rcp_f32 v100, v100
    v_rcp_f32 v101, v101
    v_rcp_f32 v102, v102
    v_rcp_f32 v103, v103
    s_nop 0
    v_mul_f32 v52, v52, v100
    v_mul_f32 v53, v53, v101
    v_mul_f32 v54, v54, v102
    v_mul_f32 v55, v55, v103
    v_cvt_pk_bf16_f32 v4, v52, v53
    v_cvt_pk_bf16_f32 v5, v54, v55
    s_mov_b32 s39, 114688
    buffer_store_dwordx2 v[4:5], v2, s[12:15], s39 offen offset:0
    v_cvt_pk_bf16_f32 v4, v56, v57
    v_lshlrev_b32 v56, 16, v4
    v_and_b32 v57, 0xffff0000, v4
    v_cvt_pk_bf16_f32 v4, v58, v59
    v_lshlrev_b32 v58, 16, v4
    v_and_b32 v59, 0xffff0000, v4
    v_lshlrev_b32 v4, 16, v86
    v_add_f32 v56, v4, v56
    v_and_b32 v4, 0xffff0000, v86
    v_add_f32 v57, v4, v57
    v_lshlrev_b32 v4, 16, v87
    v_add_f32 v58, v4, v58
    v_and_b32 v4, 0xffff0000, v87
    v_add_f32 v59, v4, v59
    v_cvt_pk_bf16_f32 v4, v56, v57
    v_lshlrev_b32 v56, 16, v4
    v_and_b32 v57, 0xffff0000, v4
    v_cvt_pk_bf16_f32 v4, v58, v59
    v_lshlrev_b32 v58, 16, v4
    v_and_b32 v59, 0xffff0000, v4
    v_mul_f32 v100, v56, v56
    v_mul_f32 v101, v57, v57
    v_mul_f32 v102, v58, v58
    v_mul_f32 v103, v59, v59
    v_fma_f32 v100, v100, s62, 1.0
    v_fma_f32 v101, v101, s62, 1.0
    v_fma_f32 v102, v102, s62, 1.0
    v_fma_f32 v103, v103, s62, 1.0
    v_mul_f32 v100, v100, v56
    v_mul_f32 v101, v101, v57
    v_mul_f32 v102, v102, v58
    v_mul_f32 v103, v103, v59
    v_mul_f32 v100, s63, v100
    v_mul_f32 v101, s63, v101
    v_mul_f32 v102, s63, v102
    v_mul_f32 v103, s63, v103
    v_exp_f32 v100, v100
    v_exp_f32 v101, v101
    v_exp_f32 v102, v102
    v_exp_f32 v103, v103
    s_nop 0
    v_add_f32 v100, 1.0, v100
    v_add_f32 v101, 1.0, v101
    v_add_f32 v102, 1.0, v102
    v_add_f32 v103, 1.0, v103
    v_rcp_f32 v100, v100
    v_rcp_f32 v101, v101
    v_rcp_f32 v102, v102
    v_rcp_f32 v103, v103
    s_nop 0
    v_mul_f32 v56, v56, v100
    v_mul_f32 v57, v57, v101
    v_mul_f32 v58, v58, v102
    v_mul_f32 v59, v59, v103
    v_cvt_pk_bf16_f32 v4, v56, v57
    v_cvt_pk_bf16_f32 v5, v58, v59
    s_mov_b32 s39, 114688
    buffer_store_dwordx2 v[4:5], v2, s[12:15], s39 offen offset:32
    v_cvt_pk_bf16_f32 v4, v60, v61
    v_lshlrev_b32 v60, 16, v4
    v_and_b32 v61, 0xffff0000, v4
    v_cvt_pk_bf16_f32 v4, v62, v63
    v_lshlrev_b32 v62, 16, v4
    v_and_b32 v63, 0xffff0000, v4
    v_lshlrev_b32 v4, 16, v88
    v_add_f32 v60, v4, v60
    v_and_b32 v4, 0xffff0000, v88
    v_add_f32 v61, v4, v61
    v_lshlrev_b32 v4, 16, v89
    v_add_f32 v62, v4, v62
    v_and_b32 v4, 0xffff0000, v89
    v_add_f32 v63, v4, v63
    v_cvt_pk_bf16_f32 v4, v60, v61
    v_lshlrev_b32 v60, 16, v4
    v_and_b32 v61, 0xffff0000, v4
    v_cvt_pk_bf16_f32 v4, v62, v63
    v_lshlrev_b32 v62, 16, v4
    v_and_b32 v63, 0xffff0000, v4
    v_mul_f32 v100, v60, v60
    v_mul_f32 v101, v61, v61
    v_mul_f32 v102, v62, v62
    v_mul_f32 v103, v63, v63
    v_fma_f32 v100, v100, s62, 1.0
    v_fma_f32 v101, v101, s62, 1.0
    v_fma_f32 v102, v102, s62, 1.0
    v_fma_f32 v103, v103, s62, 1.0
    v_mul_f32 v100, v100, v60
    v_mul_f32 v101, v101, v61
    v_mul_f32 v102, v102, v62
    v_mul_f32 v103, v103, v63
    v_mul_f32 v100, s63, v100
    v_mul_f32 v101, s63, v101
    v_mul_f32 v102, s63, v102
    v_mul_f32 v103, s63, v103
    v_exp_f32 v100, v100
    v_exp_f32 v101, v101
    v_exp_f32 v102, v102
    v_exp_f32 v103, v103
    s_nop 0
    v_add_f32 v100, 1.0, v100
    v_add_f32 v101, 1.0, v101
    v_add_f32 v102, 1.0, v102
    v_add_f32 v103, 1.0, v103
    v_rcp_f32 v100, v100
    v_rcp_f32 v101, v101
    v_rcp_f32 v102, v102
    v_rcp_f32 v103, v103
    s_nop 0
    v_mul_f32 v60, v60, v100
    v_mul_f32 v61, v61, v101
    v_mul_f32 v62, v62, v102
    v_mul_f32 v63, v63, v103
    v_cvt_pk_bf16_f32 v4, v60, v61
    v_cvt_pk_bf16_f32 v5, v62, v63
    s_mov_b32 s39, 114688
    buffer_store_dwordx2 v[4:5], v2, s[12:15], s39 offen offset:128
    v_cvt_pk_bf16_f32 v4, v64, v65
    v_lshlrev_b32 v64, 16, v4
    v_and_b32 v65, 0xffff0000, v4
    v_cvt_pk_bf16_f32 v4, v66, v67
    v_lshlrev_b32 v66, 16, v4
    v_and_b32 v67, 0xffff0000, v4
    v_lshlrev_b32 v4, 16, v90
    v_add_f32 v64, v4, v64
    v_and_b32 v4, 0xffff0000, v90
    v_add_f32 v65, v4, v65
    v_lshlrev_b32 v4, 16, v91
    v_add_f32 v66, v4, v66
    v_and_b32 v4, 0xffff0000, v91
    v_add_f32 v67, v4, v67
    v_cvt_pk_bf16_f32 v4, v64, v65
    v_lshlrev_b32 v64, 16, v4
    v_and_b32 v65, 0xffff0000, v4
    v_cvt_pk_bf16_f32 v4, v66, v67
    v_lshlrev_b32 v66, 16, v4
    v_and_b32 v67, 0xffff0000, v4
    v_mul_f32 v100, v64, v64
    v_mul_f32 v101, v65, v65
    v_mul_f32 v102, v66, v66
    v_mul_f32 v103, v67, v67
    v_fma_f32 v100, v100, s62, 1.0
    v_fma_f32 v101, v101, s62, 1.0
    v_fma_f32 v102, v102, s62, 1.0
    v_fma_f32 v103, v103, s62, 1.0
    v_mul_f32 v100, v100, v64
    v_mul_f32 v101, v101, v65
    v_mul_f32 v102, v102, v66
    v_mul_f32 v103, v103, v67
    v_mul_f32 v100, s63, v100
    v_mul_f32 v101, s63, v101
    v_mul_f32 v102, s63, v102
    v_mul_f32 v103, s63, v103
    v_exp_f32 v100, v100
    v_exp_f32 v101, v101
    v_exp_f32 v102, v102
    v_exp_f32 v103, v103
    s_nop 0
    v_add_f32 v100, 1.0, v100
    v_add_f32 v101, 1.0, v101
    v_add_f32 v102, 1.0, v102
    v_add_f32 v103, 1.0, v103
    v_rcp_f32 v100, v100
    v_rcp_f32 v101, v101
    v_rcp_f32 v102, v102
    v_rcp_f32 v103, v103
    s_nop 0
    v_mul_f32 v64, v64, v100
    v_mul_f32 v65, v65, v101
    v_mul_f32 v66, v66, v102
    v_mul_f32 v67, v67, v103
    v_cvt_pk_bf16_f32 v4, v64, v65
    v_cvt_pk_bf16_f32 v5, v66, v67
    s_mov_b32 s39, 114688
    buffer_store_dwordx2 v[4:5], v2, s[12:15], s39 offen offset:160
    v_cvt_pk_bf16_f32 v4, v68, v69
    v_lshlrev_b32 v68, 16, v4
    v_and_b32 v69, 0xffff0000, v4
    v_cvt_pk_bf16_f32 v4, v70, v71
    v_lshlrev_b32 v70, 16, v4
    v_and_b32 v71, 0xffff0000, v4
    v_lshlrev_b32 v4, 16, v92
    v_add_f32 v68, v4, v68
    v_and_b32 v4, 0xffff0000, v92
    v_add_f32 v69, v4, v69
    v_lshlrev_b32 v4, 16, v93
    v_add_f32 v70, v4, v70
    v_and_b32 v4, 0xffff0000, v93
    v_add_f32 v71, v4, v71
    v_cvt_pk_bf16_f32 v4, v68, v69
    v_lshlrev_b32 v68, 16, v4
    v_and_b32 v69, 0xffff0000, v4
    v_cvt_pk_bf16_f32 v4, v70, v71
    v_lshlrev_b32 v70, 16, v4
    v_and_b32 v71, 0xffff0000, v4
    v_mul_f32 v100, v68, v68
    v_mul_f32 v101, v69, v69
    v_mul_f32 v102, v70, v70
    v_mul_f32 v103, v71, v71
    v_fma_f32 v100, v100, s62, 1.0
    v_fma_f32 v101, v101, s62, 1.0
    v_fma_f32 v102, v102, s62, 1.0
    v_fma_f32 v103, v103, s62, 1.0
    v_mul_f32 v100, v100, v68
    v_mul_f32 v101, v101, v69
    v_mul_f32 v102, v102, v70
    v_mul_f32 v103, v103, v71
    v_mul_f32 v100, s63, v100
    v_mul_f32 v101, s63, v101
    v_mul_f32 v102, s63, v102
    v_mul_f32 v103, s63, v103
    v_exp_f32 v100, v100
    v_exp_f32 v101, v101
    v_exp_f32 v102, v102
    v_exp_f32 v103, v103
    s_nop 0
    v_add_f32 v100, 1.0, v100
    v_add_f32 v101, 1.0, v101
    v_add_f32 v102, 1.0, v102
    v_add_f32 v103, 1.0, v103
    v_rcp_f32 v100, v100
    v_rcp_f32 v101, v101
    v_rcp_f32 v102, v102
    v_rcp_f32 v103, v103
    s_nop 0
    v_mul_f32 v68, v68, v100
    v_mul_f32 v69, v69, v101
    v_mul_f32 v70, v70, v102
    v_mul_f32 v71, v71, v103
    v_cvt_pk_bf16_f32 v4, v68, v69
    v_cvt_pk_bf16_f32 v5, v70, v71
    s_mov_b32 s39, 114688
    buffer_store_dwordx2 v[4:5], v2, s[12:15], s39 offen offset:256
    v_cvt_pk_bf16_f32 v4, v72, v73
    v_lshlrev_b32 v72, 16, v4
    v_and_b32 v73, 0xffff0000, v4
    v_cvt_pk_bf16_f32 v4, v74, v75
    v_lshlrev_b32 v74, 16, v4
    v_and_b32 v75, 0xffff0000, v4
    v_lshlrev_b32 v4, 16, v94
    v_add_f32 v72, v4, v72
    v_and_b32 v4, 0xffff0000, v94
    v_add_f32 v73, v4, v73
    v_lshlrev_b32 v4, 16, v95
    v_add_f32 v74, v4, v74
    v_and_b32 v4, 0xffff0000, v95
    v_add_f32 v75, v4, v75
    v_cvt_pk_bf16_f32 v4, v72, v73
    v_lshlrev_b32 v72, 16, v4
    v_and_b32 v73, 0xffff0000, v4
    v_cvt_pk_bf16_f32 v4, v74, v75
    v_lshlrev_b32 v74, 16, v4
    v_and_b32 v75, 0xffff0000, v4
    v_mul_f32 v100, v72, v72
    v_mul_f32 v101, v73, v73
    v_mul_f32 v102, v74, v74
    v_mul_f32 v103, v75, v75
    v_fma_f32 v100, v100, s62, 1.0
    v_fma_f32 v101, v101, s62, 1.0
    v_fma_f32 v102, v102, s62, 1.0
    v_fma_f32 v103, v103, s62, 1.0
    v_mul_f32 v100, v100, v72
    v_mul_f32 v101, v101, v73
    v_mul_f32 v102, v102, v74
    v_mul_f32 v103, v103, v75
    v_mul_f32 v100, s63, v100
    v_mul_f32 v101, s63, v101
    v_mul_f32 v102, s63, v102
    v_mul_f32 v103, s63, v103
    v_exp_f32 v100, v100
    v_exp_f32 v101, v101
    v_exp_f32 v102, v102
    v_exp_f32 v103, v103
    s_nop 0
    v_add_f32 v100, 1.0, v100
    v_add_f32 v101, 1.0, v101
    v_add_f32 v102, 1.0, v102
    v_add_f32 v103, 1.0, v103
    v_rcp_f32 v100, v100
    v_rcp_f32 v101, v101
    v_rcp_f32 v102, v102
    v_rcp_f32 v103, v103
    s_nop 0
    v_mul_f32 v72, v72, v100
    v_mul_f32 v73, v73, v101
    v_mul_f32 v74, v74, v102
    v_mul_f32 v75, v75, v103
    v_cvt_pk_bf16_f32 v4, v72, v73
    v_cvt_pk_bf16_f32 v5, v74, v75
    s_mov_b32 s39, 114688
    buffer_store_dwordx2 v[4:5], v2, s[12:15], s39 offen offset:288
    v_cvt_pk_bf16_f32 v4, v76, v77
    v_lshlrev_b32 v76, 16, v4
    v_and_b32 v77, 0xffff0000, v4
    v_cvt_pk_bf16_f32 v4, v78, v79
    v_lshlrev_b32 v78, 16, v4
    v_and_b32 v79, 0xffff0000, v4
    v_lshlrev_b32 v4, 16, v96
    v_add_f32 v76, v4, v76
    v_and_b32 v4, 0xffff0000, v96
    v_add_f32 v77, v4, v77
    v_lshlrev_b32 v4, 16, v97
    v_add_f32 v78, v4, v78
    v_and_b32 v4, 0xffff0000, v97
    v_add_f32 v79, v4, v79
    v_cvt_pk_bf16_f32 v4, v76, v77
    v_lshlrev_b32 v76, 16, v4
    v_and_b32 v77, 0xffff0000, v4
    v_cvt_pk_bf16_f32 v4, v78, v79
    v_lshlrev_b32 v78, 16, v4
    v_and_b32 v79, 0xffff0000, v4
    v_mul_f32 v100, v76, v76
    v_mul_f32 v101, v77, v77
    v_mul_f32 v102, v78, v78
    v_mul_f32 v103, v79, v79
    v_fma_f32 v100, v100, s62, 1.0
    v_fma_f32 v101, v101, s62, 1.0
    v_fma_f32 v102, v102, s62, 1.0
    v_fma_f32 v103, v103, s62, 1.0
    v_mul_f32 v100, v100, v76
    v_mul_f32 v101, v101, v77
    v_mul_f32 v102, v102, v78
    v_mul_f32 v103, v103, v79
    v_mul_f32 v100, s63, v100
    v_mul_f32 v101, s63, v101
    v_mul_f32 v102, s63, v102
    v_mul_f32 v103, s63, v103
    v_exp_f32 v100, v100
    v_exp_f32 v101, v101
    v_exp_f32 v102, v102
    v_exp_f32 v103, v103
    s_nop 0
    v_add_f32 v100, 1.0, v100
    v_add_f32 v101, 1.0, v101
    v_add_f32 v102, 1.0, v102
    v_add_f32 v103, 1.0, v103
    v_rcp_f32 v100, v100
    v_rcp_f32 v101, v101
    v_rcp_f32 v102, v102
    v_rcp_f32 v103, v103
    s_nop 0
    v_mul_f32 v76, v76, v100
    v_mul_f32 v77, v77, v101
    v_mul_f32 v78, v78, v102
    v_mul_f32 v79, v79, v103
    v_cvt_pk_bf16_f32 v4, v76, v77
    v_cvt_pk_bf16_f32 v5, v78, v79
    s_mov_b32 s39, 114688
    buffer_store_dwordx2 v[4:5], v2, s[12:15], s39 offen offset:384
    v_cvt_pk_bf16_f32 v4, v80, v81
    v_lshlrev_b32 v80, 16, v4
    v_and_b32 v81, 0xffff0000, v4
    v_cvt_pk_bf16_f32 v4, v82, v83
    v_lshlrev_b32 v82, 16, v4
    v_and_b32 v83, 0xffff0000, v4
    v_lshlrev_b32 v4, 16, v98
    v_add_f32 v80, v4, v80
    v_and_b32 v4, 0xffff0000, v98
    v_add_f32 v81, v4, v81
    v_lshlrev_b32 v4, 16, v99
    v_add_f32 v82, v4, v82
    v_and_b32 v4, 0xffff0000, v99
    v_add_f32 v83, v4, v83
    v_cvt_pk_bf16_f32 v4, v80, v81
    v_lshlrev_b32 v80, 16, v4
    v_and_b32 v81, 0xffff0000, v4
    v_cvt_pk_bf16_f32 v4, v82, v83
    v_lshlrev_b32 v82, 16, v4
    v_and_b32 v83, 0xffff0000, v4
    v_mul_f32 v100, v80, v80
    v_mul_f32 v101, v81, v81
    v_mul_f32 v102, v82, v82
    v_mul_f32 v103, v83, v83
    v_fma_f32 v100, v100, s62, 1.0
    v_fma_f32 v101, v101, s62, 1.0
    v_fma_f32 v102, v102, s62, 1.0
    v_fma_f32 v103, v103, s62, 1.0
    v_mul_f32 v100, v100, v80
    v_mul_f32 v101, v101, v81
    v_mul_f32 v102, v102, v82
    v_mul_f32 v103, v103, v83
    v_mul_f32 v100, s63, v100
    v_mul_f32 v101, s63, v101
    v_mul_f32 v102, s63, v102
    v_mul_f32 v103, s63, v103
    v_exp_f32 v100, v100
    v_exp_f32 v101, v101
    v_exp_f32 v102, v102
    v_exp_f32 v103, v103
    s_nop 0
    v_add_f32 v100, 1.0, v100
    v_add_f32 v101, 1.0, v101
    v_add_f32 v102, 1.0, v102
    v_add_f32 v103, 1.0, v103
    v_rcp_f32 v100, v100
    v_rcp_f32 v101, v101
    v_rcp_f32 v102, v102
    v_rcp_f32 v103, v103
    s_nop 0
    v_mul_f32 v80, v80, v100
    v_mul_f32 v81, v81, v101
    v_mul_f32 v82, v82, v102
    v_mul_f32 v83, v83, v103
    v_cvt_pk_bf16_f32 v4, v80, v81
    v_cvt_pk_bf16_f32 v5, v82, v83
    s_mov_b32 s39, 114688
    buffer_store_dwordx2 v[4:5], v2, s[12:15], s39 offen offset:416
    s_waitcnt vmcnt(0)
    s_waitcnt vmcnt(0)
L_end_mlp1_1_kernel:
    s_endpgm
.globl mlp2_1_kernel
.p2align 8
.type mlp2_1_kernel,@function
mlp2_1_kernel:
    s_cmp_ge_u32 s2, 256
    s_cbranch_scc1 L_end_mlp2_1_kernel
    s_load_dwordx2 s[40:41], s[0:1], 80
    s_load_dwordx2 s[42:43], s[0:1], 48
    s_load_dwordx2 s[50:51], s[0:1], 80
    s_load_dwordx2 s[52:53], s[0:1], 64
    s_load_dwordx2 s[56:57], s[0:1], 56
    v_and_b32 v1, 63, v0
    v_lshrrev_b32 v2, 6, v0
    s_and_b32 s24, s2, 15
    v_readfirstlane_b32 s26, v2
    s_lshr_b32 s25, s2, 4
    s_nop 1
    s_lshr_b32 s27, s26, 2
    s_and_b32 s28, s26, 1
    s_bfe_u32 s29, s26, 0x10001
    v_lshrrev_b32 v2, 3, v1
    v_and_b32 v3, 7, v1
    v_xor_b32 v3, v3, v2
    s_lshl_b32 s38, s26, 4
    s_lshl_b32 s39, s24, 7
    s_add_u32 s38, s38, s39
    v_add_u32 v4, s38, v2
    s_mov_b32 s38, 7168
    v_mul_lo_u32 v4, v4, s38
    v_lshlrev_b32 v3, 4, v3
    v_add_u32 v10, v4, v3
    v_add_u32 v11, 57344, v10
    v_lshrrev_b32 v2, 3, v1
    s_lshl_b32 s38, s26, 3
    v_add_u32 v2, s38, v2
    s_mov_b32 s38, 2048
    v_mul_lo_u32 v2, v2, s38
    v_bfe_u32 v3, v1, 1, 2
    v_bfe_u32 v4, v1, 4, 1
    s_and_b32 s38, s26, 1
    s_lshl_b32 s38, s38, 1
    v_or_b32 v4, s38, v4
    v_xor_b32 v3, v3, v4
    v_lshlrev_b32 v3, 5, v3
    v_and_b32 v4, 1, v1
    v_lshlrev_b32 v4, 4, v4
    v_add3_u32 v12, v2, v3, v4
    v_and_b32 v2, 15, v1
    s_lshl_b32 s38, s28, 6
    v_add_u32 v2, s38, v2
    v_lshlrev_b32 v2, 7, v2
    v_lshrrev_b32 v3, 4, v1
    s_lshl_b32 s38, s27, 2
    v_add_u32 v3, s38, v3
    v_and_b32 v4, 7, v1
    v_xor_b32 v3, v3, v4
    v_lshlrev_b32 v3, 4, v3
    v_add_u32 v13, v2, v3
    v_lshrrev_b32 v2, 4, v1
    v_lshlrev_b32 v2, 3, v2
    v_bfe_u32 v3, v1, 2, 2
    v_add_u32 v2, v2, v3
    v_lshlrev_b32 v2, 7, v2
    v_and_b32 v3, 3, v1
    v_lshlrev_b32 v3, 3, v3
    v_add_u32 v2, v2, v3
    s_lshl_b32 s38, s27, 12
    s_add_u32 s38, s38, 16384
    v_add_u32 v2, s38, v2
    v_bfe_u32 v3, v1, 3, 1
    v_bfe_u32 v4, v1, 4, 1
    v_lshlrev_b32 v4, 1, v4
    v_or_b32 v3, v3, v4
    s_lshl_b32 s38, s29, 1
    v_xor_b32 v4, s38, v3
    v_lshlrev_b32 v4, 5, v4
    v_add_u32 v14, v2, v4
    v_xor_b32 v4, 32, v4
    v_add_u32 v15, v2, v4
    s_waitcnt lgkmcnt(0)
    s_add_u32 s4, s40, 25165824
    s_addc_u32 s5, s41, 0
    s_mov_b32 s6, 14680064
    s_mov_b32 s7, 0x00020000
    s_mov_b32 s8, s42
    s_mov_b32 s9, s43
    s_mov_b32 s10, 7340032
    s_mov_b32 s11, 0x00020000
    s_mov_b32 s31, 0
    s_mul_i32 s32, s25, 128
    s_mov_b32 s36, 0
    s_lshl_b32 s44, s26, 11
    s_add_u32 s45, s44, 1024
    s_lshl_b32 s46, s26, 10
    s_add_u32 s46, s46, 16384
    s_add_u32 m0, s36, s44
    s_nop 0
    buffer_load_dwordx4 v10, s[4:7], s31 offen lds
    s_add_u32 m0, s36, s45
    s_nop 0
    buffer_load_dwordx4 v11, s[4:7], s31 offen lds
    s_add_u32 m0, s36, s46
    s_nop 0
    buffer_load_dwordx4 v12, s[8:11], s32 offen lds
    s_add_u32 s31, s31, 128
    s_add_u32 s32, s32, 131072
    s_add_u32 s36, s36, 24576
    s_cmp_ge_u32 s36, 147456
    s_cselect_b32 s36, 0, s36
    v_mov_b32 v68, 0
    v_mov_b32 v69, 0
    v_mov_b32 v70, 0
    v_mov_b32 v71, 0
    v_mov_b32 v72, 0
    v_mov_b32 v73, 0
    v_mov_b32 v74, 0
    v_mov_b32 v75, 0
    v_mov_b32 v76, 0
    v_mov_b32 v77, 0
    v_mov_b32 v78, 0
    v_mov_b32 v79, 0
    v_mov_b32 v80, 0
    v_mov_b32 v81, 0
    v_mov_b32 v82, 0
    v_mov_b32 v83, 0
    v_mov_b32 v84, 0
    v_mov_b32 v85, 0
    v_mov_b32 v86, 0
    v_mov_b32 v87, 0
    v_mov_b32 v88, 0
    v_mov_b32 v89, 0
    v_mov_b32 v90, 0
    v_mov_b32 v91, 0
    v_mov_b32 v92, 0
    v_mov_b32 v93, 0
    v_mov_b32 v94, 0
    v_mov_b32 v95, 0
    v_mov_b32 v96, 0
    v_mov_b32 v97, 0
    v_mov_b32 v98, 0
    v_mov_b32 v99, 0
    s_add_u32 m0, s36, s44
    s_nop 0
    buffer_load_dwordx4 v10, s[4:7], s31 offen lds
    s_add_u32 m0, s36, s45
    s_nop 0
    buffer_load_dwordx4 v11, s[4:7], s31 offen lds
    s_add_u32 m0, s36, s46
    s_nop 0
    buffer_load_dwordx4 v12, s[8:11], s32 offen lds
    s_add_u32 s31, s31, 128
    s_add_u32 s32, s32, 131072
    s_add_u32 s36, s36, 24576
    s_cmp_ge_u32 s36, 147456
    s_cselect_b32 s36, 0, s36
    s_add_u32 m0, s36, s44
    s_nop 0
    buffer_load_dwordx4 v10, s[4:7], s31 offen lds
    s_add_u32 m0, s36, s45
    s_nop 0
    buffer_load_dwordx4 v11, s[4:7], s31 offen lds
    s_add_u32 m0, s36, s46
    s_nop 0
    buffer_load_dwordx4 v12, s[8:11], s32 offen lds
    s_add_u32 s31, s31, 128
    s_add_u32 s32, s32, 131072
    s_add_u32 s36, s36, 24576
    s_cmp_ge_u32 s36, 147456
    s_cselect_b32 s36, 0, s36
    s_add_u32 m0, s36, s44
    s_nop 0
    buffer_load_dwordx4 v10, s[4:7], s31 offen lds
    s_add_u32 m0, s36, s45
    s_nop 0
    buffer_load_dwordx4 v11, s[4:7], s31 offen lds
    s_add_u32 m0, s36, s46
    s_nop 0
    buffer_load_dwordx4 v12, s[8:11], s32 offen lds
    s_add_u32 s31, s31, 128
    s_add_u32 s32, s32, 131072
    s_add_u32 s36, s36, 24576
    s_cmp_ge_u32 s36, 147456
    s_cselect_b32 s36, 0, s36
    s_add_u32 m0, s36, s44
    s_nop 0
    buffer_load_dwordx4 v10, s[4:7], s31 offen lds
    s_add_u32 m0, s36, s45
    s_nop 0
    buffer_load_dwordx4 v11, s[4:7], s31 offen lds
    s_add_u32 m0, s36, s46
    s_nop 0
    buffer_load_dwordx4 v12, s[8:11], s32 offen lds
    s_add_u32 s31, s31, 128
    s_add_u32 s32, s32, 131072
    s_add_u32 s36, s36, 24576
    s_cmp_ge_u32 s36, 147456
    s_cselect_b32 s36, 0, s36
    s_add_u32 m0, s36, s44
    s_nop 0
    buffer_load_dwordx4 v10, s[4:7], s31 offen lds
    s_add_u32 m0, s36, s45
    s_nop 0
    buffer_load_dwordx4 v11, s[4:7], s31 offen lds
    s_add_u32 m0, s36, s46
    s_nop 0
    buffer_load_dwordx4 v12, s[8:11], s32 offen lds
    s_add_u32 s31, s31, 128
    s_add_u32 s32, s32, 131072
    s_add_u32 s36, s36, 24576
    s_cmp_ge_u32 s36, 147456
    s_cselect_b32 s36, 0, s36
    s_mov_b32 s37, 0
    s_waitcnt vmcnt(15)
    s_barrier
    v_add_u32 v16, s37, v13
    v_add_u32 v17, s37, v14
    v_add_u32 v18, s37, v15
    s_add_u32 s37, s37, 24576
    s_cmp_ge_u32 s37, 147456
    s_cselect_b32 s37, 0, s37
    ds_read_b128 v[20:23], v16 offset:0
    ds_read_b128 v[24:27], v16 offset:2048
    ds_read_b128 v[28:31], v16 offset:4096
    ds_read_b128 v[32:35], v16 offset:6144
    ds_read_b64_tr_b16 v[52:53], v17 offset:0
    ds_read_b64_tr_b16 v[54:55], v17 offset:512
    ds_read_b64_tr_b16 v[56:57], v18 offset:0
    ds_read_b64_tr_b16 v[58:59], v18 offset:512
    s_mov_b32 s30, 25
L_loop_mlp2_1_kernel:
    s_waitcnt lgkmcnt(0)
    v_mfma_f32_16x16x32_bf16 v[68:71], v[52:55], v[20:23], v[68:71]
    v_mfma_f32_16x16x32_bf16 v[72:75], v[56:59], v[20:23], v[72:75]
    v_mfma_f32_16x16x32_bf16 v[76:79], v[52:55], v[24:27], v[76:79]
    v_mfma_f32_16x16x32_bf16 v[80:83], v[56:59], v[24:27], v[80:83]
    s_waitcnt vmcnt(12)
    s_barrier
    v_add_u32 v16, s37, v13
    v_add_u32 v17, s37, v14
    v_add_u32 v18, s37, v15
    s_add_u32 s37, s37, 24576
    s_cmp_ge_u32 s37, 147456
    s_cselect_b32 s37, 0, s37
    ds_read_b128 v[36:39], v16 offset:0
    ds_read_b128 v[40:43], v16 offset:2048
    ds_read_b128 v[44:47], v16 offset:4096
    ds_read_b128 v[48:51], v16 offset:6144
    ds_read_b64_tr_b16 v[60:61], v17 offset:0
    ds_read_b64_tr_b16 v[62:63], v17 offset:512
    ds_read_b64_tr_b16 v[64:65], v18 offset:0
    ds_read_b64_tr_b16 v[66:67], v18 offset:512
    s_add_u32 m0, s36, s44
    v_mfma_f32_16x16x32_bf16 v[84:87], v[52:55], v[28:31], v[84:87]
    buffer_load_dwordx4 v10, s[4:7], s31 offen lds
    s_add_u32 m0, s36, s45
    v_mfma_f32_16x16x32_bf16 v[88:91], v[56:59], v[28:31], v[88:91]
    buffer_load_dwordx4 v11, s[4:7], s31 offen lds
    s_add_u32 m0, s36, s46
    v_mfma_f32_16x16x32_bf16 v[92:95], v[52:55], v[32:35], v[92:95]
    buffer_load_dwordx4 v12, s[8:11], s32 offen lds
    v_mfma_f32_16x16x32_bf16 v[96:99], v[56:59], v[32:35], v[96:99]
    s_add_u32 s31, s31, 128
    s_add_u32 s32, s32, 131072
    s_add_u32 s36, s36, 24576
    s_cmp_ge_u32 s36, 147456
    s_cselect_b32 s36, 0, s36
    s_waitcnt lgkmcnt(0)
    v_mfma_f32_16x16x32_bf16 v[68:71], v[60:63], v[36:39], v[68:71]
    v_mfma_f32_16x16x32_bf16 v[72:75], v[64:67], v[36:39], v[72:75]
    v_mfma_f32_16x16x32_bf16 v[76:79], v[60:63], v[40:43], v[76:79]
    v_mfma_f32_16x16x32_bf16 v[80:83], v[64:67], v[40:43], v[80:83]
    s_waitcnt vmcnt(12)
    s_barrier
    v_add_u32 v16, s37, v13
    v_add_u32 v17, s37, v14
    v_add_u32 v18, s37, v15
    s_add_u32 s37, s37, 24576
    s_cmp_ge_u32 s37, 147456
    s_cselect_b32 s37, 0, s37
    ds_read_b128 v[20:23], v16 offset:0
    ds_read_b128 v[24:27], v16 offset:2048
    ds_read_b128 v[28:31], v16 offset:4096
    ds_read_b128 v[32:35], v16 offset:6144
    ds_read_b64_tr_b16 v[52:53], v17 offset:0
    ds_read_b64_tr_b16 v[54:55], v17 offset:512
    ds_read_b64_tr_b16 v[56:57], v18 offset:0
    ds_read_b64_tr_b16 v[58:59], v18 offset:512
    s_add_u32 m0, s36, s44
    v_mfma_f32_16x16x32_bf16 v[84:87], v[60:63], v[44:47], v[84:87]
    buffer_load_dwordx4 v10, s[4:7], s31 offen lds
    s_add_u32 m0, s36, s45
    v_mfma_f32_16x16x32_bf16 v[88:91], v[64:67], v[44:47], v[88:91]
    buffer_load_dwordx4 v11, s[4:7], s31 offen lds
    s_add_u32 m0, s36, s46
    v_mfma_f32_16x16x32_bf16 v[92:95], v[60:63], v[48:51], v[92:95]
    buffer_load_dwordx4 v12, s[8:11], s32 offen lds
    v_mfma_f32_16x16x32_bf16 v[96:99], v[64:67], v[48:51], v[96:99]
    s_add_u32 s31, s31, 128
    s_add_u32 s32, s32, 131072
    s_add_u32 s36, s36, 24576
    s_cmp_ge_u32 s36, 147456
    s_cselect_b32 s36, 0, s36
    s_sub_u32 s30, s30, 1
    s_cmp_lg_u32 s30, 0
    s_cbranch_scc1 L_loop_mlp2_1_kernel
    s_waitcnt lgkmcnt(0)
    v_mfma_f32_16x16x32_bf16 v[68:71], v[52:55], v[20:23], v[68:71]
    v_mfma_f32_16x16x32_bf16 v[72:75], v[56:59], v[20:23], v[72:75]
    v_mfma_f32_16x16x32_bf16 v[76:79], v[52:55], v[24:27], v[76:79]
    v_mfma_f32_16x16x32_bf16 v[80:83], v[56:59], v[24:27], v[80:83]
    s_waitcnt vmcnt(12)
    s_barrier
    v_add_u32 v16, s37, v13
    v_add_u32 v17, s37, v14
    v_add_u32 v18, s37, v15
    s_add_u32 s37, s37, 24576
    s_cmp_ge_u32 s37, 147456
    s_cselect_b32 s37, 0, s37
    ds_read_b128 v[36:39], v16 offset:0
    ds_read_b128 v[40:43], v16 offset:2048
    ds_read_b128 v[44:47], v16 offset:4096
    ds_read_b128 v[48:51], v16 offset:6144
    ds_read_b64_tr_b16 v[60:61], v17 offset:0
    ds_read_b64_tr_b16 v[62:63], v17 offset:512
    ds_read_b64_tr_b16 v[64:65], v18 offset:0
    ds_read_b64_tr_b16 v[66:67], v18 offset:512
    v_mfma_f32_16x16x32_bf16 v[84:87], v[52:55], v[28:31], v[84:87]
    v_mfma_f32_16x16x32_bf16 v[88:91], v[56:59], v[28:31], v[88:91]
    v_mfma_f32_16x16x32_bf16 v[92:95], v[52:55], v[32:35], v[92:95]
    v_mfma_f32_16x16x32_bf16 v[96:99], v[56:59], v[32:35], v[96:99]
    s_waitcnt lgkmcnt(0)
    v_mfma_f32_16x16x32_bf16 v[68:71], v[60:63], v[36:39], v[68:71]
    v_mfma_f32_16x16x32_bf16 v[72:75], v[64:67], v[36:39], v[72:75]
    v_mfma_f32_16x16x32_bf16 v[76:79], v[60:63], v[40:43], v[76:79]
    v_mfma_f32_16x16x32_bf16 v[80:83], v[64:67], v[40:43], v[80:83]
    s_waitcnt vmcnt(9)
    s_barrier
    v_add_u32 v16, s37, v13
    v_add_u32 v17, s37, v14
    v_add_u32 v18, s37, v15
    s_add_u32 s37, s37, 24576
    s_cmp_ge_u32 s37, 147456
    s_cselect_b32 s37, 0, s37
    ds_read_b128 v[20:23], v16 offset:0
    ds_read_b128 v[24:27], v16 offset:2048
    ds_read_b128 v[28:31], v16 offset:4096
    ds_read_b128 v[32:35], v16 offset:6144
    ds_read_b64_tr_b16 v[52:53], v17 offset:0
    ds_read_b64_tr_b16 v[54:55], v17 offset:512
    ds_read_b64_tr_b16 v[56:57], v18 offset:0
    ds_read_b64_tr_b16 v[58:59], v18 offset:512
    v_mfma_f32_16x16x32_bf16 v[84:87], v[60:63], v[44:47], v[84:87]
    v_mfma_f32_16x16x32_bf16 v[88:91], v[64:67], v[44:47], v[88:91]
    v_mfma_f32_16x16x32_bf16 v[92:95], v[60:63], v[48:51], v[92:95]
    v_mfma_f32_16x16x32_bf16 v[96:99], v[64:67], v[48:51], v[96:99]
    s_waitcnt lgkmcnt(0)
    v_mfma_f32_16x16x32_bf16 v[68:71], v[52:55], v[20:23], v[68:71]
    v_mfma_f32_16x16x32_bf16 v[72:75], v[56:59], v[20:23], v[72:75]
    v_mfma_f32_16x16x32_bf16 v[76:79], v[52:55], v[24:27], v[76:79]
    v_mfma_f32_16x16x32_bf16 v[80:83], v[56:59], v[24:27], v[80:83]
    s_waitcnt vmcnt(6)
    s_barrier
    v_add_u32 v16, s37, v13
    v_add_u32 v17, s37, v14
    v_add_u32 v18, s37, v15
    s_add_u32 s37, s37, 24576
    s_cmp_ge_u32 s37, 147456
    s_cselect_b32 s37, 0, s37
    ds_read_b128 v[36:39], v16 offset:0
    ds_read_b128 v[40:43], v16 offset:2048
    ds_read_b128 v[44:47], v16 offset:4096
    ds_read_b128 v[48:51], v16 offset:6144
    ds_read_b64_tr_b16 v[60:61], v17 offset:0
    ds_read_b64_tr_b16 v[62:63], v17 offset:512
    ds_read_b64_tr_b16 v[64:65], v18 offset:0
    ds_read_b64_tr_b16 v[66:67], v18 offset:512
    v_mfma_f32_16x16x32_bf16 v[84:87], v[52:55], v[28:31], v[84:87]
    v_mfma_f32_16x16x32_bf16 v[88:91], v[56:59], v[28:31], v[88:91]
    v_mfma_f32_16x16x32_bf16 v[92:95], v[52:55], v[32:35], v[92:95]
    v_mfma_f32_16x16x32_bf16 v[96:99], v[56:59], v[32:35], v[96:99]
    s_waitcnt lgkmcnt(0)
    v_mfma_f32_16x16x32_bf16 v[68:71], v[60:63], v[36:39], v[68:71]
    v_mfma_f32_16x16x32_bf16 v[72:75], v[64:67], v[36:39], v[72:75]
    v_mfma_f32_16x16x32_bf16 v[76:79], v[60:63], v[40:43], v[76:79]
    v_mfma_f32_16x16x32_bf16 v[80:83], v[64:67], v[40:43], v[80:83]
    s_waitcnt vmcnt(3)
    s_barrier
    v_add_u32 v16, s37, v13
    v_add_u32 v17, s37, v14
    v_add_u32 v18, s37, v15
    s_add_u32 s37, s37, 24576
    s_cmp_ge_u32 s37, 147456
    s_cselect_b32 s37, 0, s37
    ds_read_b128 v[20:23], v16 offset:0
    ds_read_b128 v[24:27], v16 offset:2048
    ds_read_b128 v[28:31], v16 offset:4096
    ds_read_b128 v[32:35], v16 offset:6144
    ds_read_b64_tr_b16 v[52:53], v17 offset:0
    ds_read_b64_tr_b16 v[54:55], v17 offset:512
    ds_read_b64_tr_b16 v[56:57], v18 offset:0
    ds_read_b64_tr_b16 v[58:59], v18 offset:512
    v_mfma_f32_16x16x32_bf16 v[84:87], v[60:63], v[44:47], v[84:87]
    v_mfma_f32_16x16x32_bf16 v[88:91], v[64:67], v[44:47], v[88:91]
    v_mfma_f32_16x16x32_bf16 v[92:95], v[60:63], v[48:51], v[92:95]
    v_mfma_f32_16x16x32_bf16 v[96:99], v[64:67], v[48:51], v[96:99]
    s_waitcnt lgkmcnt(0)
    v_mfma_f32_16x16x32_bf16 v[68:71], v[52:55], v[20:23], v[68:71]
    v_mfma_f32_16x16x32_bf16 v[72:75], v[56:59], v[20:23], v[72:75]
    v_mfma_f32_16x16x32_bf16 v[76:79], v[52:55], v[24:27], v[76:79]
    v_mfma_f32_16x16x32_bf16 v[80:83], v[56:59], v[24:27], v[80:83]
    s_waitcnt vmcnt(0)
    s_barrier
    v_add_u32 v16, s37, v13
    v_add_u32 v17, s37, v14
    v_add_u32 v18, s37, v15
    s_add_u32 s37, s37, 24576
    s_cmp_ge_u32 s37, 147456
    s_cselect_b32 s37, 0, s37
    ds_read_b128 v[36:39], v16 offset:0
    ds_read_b128 v[40:43], v16 offset:2048
    ds_read_b128 v[44:47], v16 offset:4096
    ds_read_b128 v[48:51], v16 offset:6144
    ds_read_b64_tr_b16 v[60:61], v17 offset:0
    ds_read_b64_tr_b16 v[62:63], v17 offset:512
    ds_read_b64_tr_b16 v[64:65], v18 offset:0
    ds_read_b64_tr_b16 v[66:67], v18 offset:512
    v_mfma_f32_16x16x32_bf16 v[84:87], v[52:55], v[28:31], v[84:87]
    v_mfma_f32_16x16x32_bf16 v[88:91], v[56:59], v[28:31], v[88:91]
    v_mfma_f32_16x16x32_bf16 v[92:95], v[52:55], v[32:35], v[92:95]
    v_mfma_f32_16x16x32_bf16 v[96:99], v[56:59], v[32:35], v[96:99]
    s_waitcnt lgkmcnt(0)
    v_mfma_f32_16x16x32_bf16 v[68:71], v[60:63], v[36:39], v[68:71]
    v_mfma_f32_16x16x32_bf16 v[72:75], v[64:67], v[36:39], v[72:75]
    v_mfma_f32_16x16x32_bf16 v[76:79], v[60:63], v[40:43], v[76:79]
    v_mfma_f32_16x16x32_bf16 v[80:83], v[64:67], v[40:43], v[80:83]
    v_mfma_f32_16x16x32_bf16 v[84:87], v[60:63], v[44:47], v[84:87]
    v_mfma_f32_16x16x32_bf16 v[88:91], v[64:67], v[44:47], v[88:91]
    v_mfma_f32_16x16x32_bf16 v[92:95], v[60:63], v[48:51], v[92:95]
    v_mfma_f32_16x16x32_bf16 v[96:99], v[64:67], v[48:51], v[96:99]
    s_waitcnt vmcnt(0) lgkmcnt(0)
    s_barrier
    s_xor_b32 s38, s26, 4
    s_mul_i32 s38, s38, 4096
    v_lshlrev_b32 v2, 4, v1
    v_add_u32 v2, s38, v2
    s_nop 7
    s_cmp_eq_u32 s27, 0
    s_cbranch_scc0 L_give1_mlp2_1_kernel
    ds_write_b128 v2, v[84:87] offset:0
    ds_write_b128 v2, v[88:91] offset:1024
    ds_write_b128 v2, v[92:95] offset:2048
    ds_write_b128 v2, v[96:99] offset:3072
    s_branch L_give_done_mlp2_1_kernel
L_give1_mlp2_1_kernel:
    ds_write_b128 v2, v[68:71] offset:0
    ds_write_b128 v2, v[72:75] offset:1024
    ds_write_b128 v2, v[76:79] offset:2048
    ds_write_b128 v2, v[80:83] offset:3072
L_give_done_mlp2_1_kernel:
    s_waitcnt lgkmcnt(0)
    s_barrier
    s_mul_i32 s38, s26, 4096
    v_lshlrev_b32 v2, 4, v1
    v_add_u32 v2, s38, v2
    s_mul_i32 s38, s27, 16
    s_cmp_eq_u32 s27, 0
    s_cbranch_scc0 L_keep1_mlp2_1_kernel
    ds_read_b128 v[20:23], v2 offset:0
    ds_read_b128 v[24:27], v2 offset:1024
    ds_read_b128 v[28:31], v2 offset:2048
    ds_read_b128 v[32:35], v2 offset:3072
    s_waitcnt lgkmcnt(0)
    v_add_f32 v20, v68, v20
    v_add_f32 v21, v69, v21
    v_add_f32 v22, v70, v22
    v_add_f32 v23, v71, v23
    v_add_f32 v24, v72, v24
    v_add_f32 v25, v73, v25
    v_add_f32 v26, v74, v26
    v_add_f32 v27, v75, v27
    v_add_f32 v28, v76, v28
    v_add_f32 v29, v77, v29
    v_add_f32 v30, v78, v30
    v_add_f32 v31, v79, v31
    v_add_f32 v32, v80, v32
    v_add_f32 v33, v81, v33
    v_add_f32 v34, v82, v34
    v_add_f32 v35, v83, v35
    s_branch L_keep_done_mlp2_1_kernel
L_keep1_mlp2_1_kernel:
    ds_read_b128 v[20:23], v2 offset:0
    ds_read_b128 v[24:27], v2 offset:1024
    ds_read_b128 v[28:31], v2 offset:2048
    ds_read_b128 v[32:35], v2 offset:3072
    s_waitcnt lgkmcnt(0)
    v_add_f32 v20, v84, v20
    v_add_f32 v21, v85, v21
    v_add_f32 v22, v86, v22
    v_add_f32 v23, v87, v23
    v_add_f32 v24, v88, v24
    v_add_f32 v25, v89, v25
    v_add_f32 v26, v90, v26
    v_add_f32 v27, v91, v27
    v_add_f32 v28, v92, v28
    v_add_f32 v29, v93, v29
    v_add_f32 v30, v94, v30
    v_add_f32 v31, v95, v31
    v_add_f32 v32, v96, v32
    v_add_f32 v33, v97, v33
    v_add_f32 v34, v98, v34
    v_add_f32 v35, v99, v35
L_keep_done_mlp2_1_kernel:
    s_mov_b32 s12, s52
    s_mov_b32 s13, s53
    s_mov_b32 s14, 4194304
    s_mov_b32 s15, 0x00020000
    s_add_u32 s16, s50, 20971520
    s_addc_u32 s17, s51, 0
    s_mov_b32 s18, 4194304
    s_mov_b32 s19, 0x00020000
    v_and_b32 v2, 15, v1
    s_lshl_b32 s38, s24, 7
    s_lshl_b32 s39, s28, 6
    s_add_u32 s38, s38, s39
    s_lshl_b32 s39, s27, 5
    s_add_u32 s38, s38, s39
    v_add_u32 v2, s38, v2
    s_mov_b32 s38, 2048
    v_mul_lo_u32 v2, v2, s38
    v_lshrrev_b32 v3, 4, v1
    v_lshlrev_b32 v3, 3, v3
    s_lshl_b32 s38, s29, 6
    s_mul_i32 s39, s25, 128
    s_add_u32 s38, s38, s39
    v_add3_u32 v2, v2, v3, s38
    s_mov_b32 s20, s56
    s_mov_b32 s21, s57
    s_mov_b32 s22, 2048
    s_mov_b32 s23, 0x00020000
    v_lshrrev_b32 v3, 4, v1
    v_lshlrev_b32 v3, 3, v3
    s_lshl_b32 s38, s29, 6
    s_mul_i32 s39, s25, 128
    s_add_u32 s38, s38, s39
    v_add_u32 v3, s38, v3
    buffer_load_dwordx2 v[52:53], v3, s[20:23], 0 offen offset:0
    buffer_load_dwordx2 v[54:55], v3, s[20:23], 0 offen offset:32
    s_mov_b32 s39, 0
    buffer_load_dwordx2 v[36:37], v2, s[16:19], s39 offen offset:0
    s_mov_b32 s39, 0
    buffer_load_dwordx2 v[38:39], v2, s[16:19], s39 offen offset:32
    s_mov_b32 s39, 32768
    buffer_load_dwordx2 v[40:41], v2, s[16:19], s39 offen offset:0
    s_mov_b32 s39, 32768
    buffer_load_dwordx2 v[42:43], v2, s[16:19], s39 offen offset:32
    s_waitcnt vmcnt(0)
    v_cvt_pk_bf16_f32 v4, v20, v21
    v_lshlrev_b32 v20, 16, v4
    v_and_b32 v21, 0xffff0000, v4
    v_cvt_pk_bf16_f32 v4, v22, v23
    v_lshlrev_b32 v22, 16, v4
    v_and_b32 v23, 0xffff0000, v4
    v_lshlrev_b32 v4, 16, v52
    v_add_f32 v20, v4, v20
    v_and_b32 v4, 0xffff0000, v52
    v_add_f32 v21, v4, v21
    v_lshlrev_b32 v4, 16, v53
    v_add_f32 v22, v4, v22
    v_and_b32 v4, 0xffff0000, v53
    v_add_f32 v23, v4, v23
    v_cvt_pk_bf16_f32 v4, v20, v21
    v_lshlrev_b32 v20, 16, v4
    v_and_b32 v21, 0xffff0000, v4
    v_cvt_pk_bf16_f32 v4, v22, v23
    v_lshlrev_b32 v22, 16, v4
    v_and_b32 v23, 0xffff0000, v4
    v_lshlrev_b32 v4, 16, v36
    v_add_f32 v20, v4, v20
    v_and_b32 v4, 0xffff0000, v36
    v_add_f32 v21, v4, v21
    v_lshlrev_b32 v4, 16, v37
    v_add_f32 v22, v4, v22
    v_and_b32 v4, 0xffff0000, v37
    v_add_f32 v23, v4, v23
    v_cvt_pk_bf16_f32 v4, v20, v21
    v_cvt_pk_bf16_f32 v5, v22, v23
    s_mov_b32 s39, 0
    buffer_store_dwordx2 v[4:5], v2, s[12:15], s39 offen offset:0
    v_cvt_pk_bf16_f32 v4, v24, v25
    v_lshlrev_b32 v24, 16, v4
    v_and_b32 v25, 0xffff0000, v4
    v_cvt_pk_bf16_f32 v4, v26, v27
    v_lshlrev_b32 v26, 16, v4
    v_and_b32 v27, 0xffff0000, v4
    v_lshlrev_b32 v4, 16, v54
    v_add_f32 v24, v4, v24
    v_and_b32 v4, 0xffff0000, v54
    v_add_f32 v25, v4, v25
    v_lshlrev_b32 v4, 16, v55
    v_add_f32 v26, v4, v26
    v_and_b32 v4, 0xffff0000, v55
    v_add_f32 v27, v4, v27
    v_cvt_pk_bf16_f32 v4, v24, v25
    v_lshlrev_b32 v24, 16, v4
    v_and_b32 v25, 0xffff0000, v4
    v_cvt_pk_bf16_f32 v4, v26, v27
    v_lshlrev_b32 v26, 16, v4
    v_and_b32 v27, 0xffff0000, v4
    v_lshlrev_b32 v4, 16, v38
    v_add_f32 v24, v4, v24
    v_and_b32 v4, 0xffff0000, v38
    v_add_f32 v25, v4, v25
    v_lshlrev_b32 v4, 16, v39
    v_add_f32 v26, v4, v26
    v_and_b32 v4, 0xffff0000, v39
    v_add_f32 v27, v4, v27
    v_cvt_pk_bf16_f32 v4, v24, v25
    v_cvt_pk_bf16_f32 v5, v26, v27
    s_mov_b32 s39, 0
    buffer_store_dwordx2 v[4:5], v2, s[12:15], s39 offen offset:32
    v_cvt_pk_bf16_f32 v4, v28, v29
    v_lshlrev_b32 v28, 16, v4
    v_and_b32 v29, 0xffff0000, v4
    v_cvt_pk_bf16_f32 v4, v30, v31
    v_lshlrev_b32 v30, 16, v4
    v_and_b32 v31, 0xffff0000, v4
    v_lshlrev_b32 v4, 16, v52
    v_add_f32 v28, v4, v28
    v_and_b32 v4, 0xffff0000, v52
    v_add_f32 v29, v4, v29
    v_lshlrev_b32 v4, 16, v53
    v_add_f32 v30, v4, v30
    v_and_b32 v4, 0xffff0000, v53
    v_add_f32 v31, v4, v31
    v_cvt_pk_bf16_f32 v4, v28, v29
    v_lshlrev_b32 v28, 16, v4
    v_and_b32 v29, 0xffff0000, v4
    v_cvt_pk_bf16_f32 v4, v30, v31
    v_lshlrev_b32 v30, 16, v4
    v_and_b32 v31, 0xffff0000, v4
    v_lshlrev_b32 v4, 16, v40
    v_add_f32 v28, v4, v28
    v_and_b32 v4, 0xffff0000, v40
    v_add_f32 v29, v4, v29
    v_lshlrev_b32 v4, 16, v41
    v_add_f32 v30, v4, v30
    v_and_b32 v4, 0xffff0000, v41
    v_add_f32 v31, v4, v31
    v_cvt_pk_bf16_f32 v4, v28, v29
    v_cvt_pk_bf16_f32 v5, v30, v31
    s_mov_b32 s39, 32768
    buffer_store_dwordx2 v[4:5], v2, s[12:15], s39 offen offset:0
    v_cvt_pk_bf16_f32 v4, v32, v33
    v_lshlrev_b32 v32, 16, v4
    v_and_b32 v33, 0xffff0000, v4
    v_cvt_pk_bf16_f32 v4, v34, v35
    v_lshlrev_b32 v34, 16, v4
    v_and_b32 v35, 0xffff0000, v4
    v_lshlrev_b32 v4, 16, v54
    v_add_f32 v32, v4, v32
    v_and_b32 v4, 0xffff0000, v54
    v_add_f32 v33, v4, v33
    v_lshlrev_b32 v4, 16, v55
    v_add_f32 v34, v4, v34
    v_and_b32 v4, 0xffff0000, v55
    v_add_f32 v35, v4, v35
    v_cvt_pk_bf16_f32 v4, v32, v33
    v_lshlrev_b32 v32, 16, v4
    v_and_b32 v33, 0xffff0000, v4
    v_cvt_pk_bf16_f32 v4, v34, v35
    v_lshlrev_b32 v34, 16, v4
    v_and_b32 v35, 0xffff0000, v4
    v_lshlrev_b32 v4, 16, v42
    v_add_f32 v32, v4, v32
    v_and_b32 v4, 0xffff0000, v42
    v_add_f32 v33, v4, v33
    v_lshlrev_b32 v4, 16, v43
    v_add_f32 v34, v4, v34
    v_and_b32 v4, 0xffff0000, v43
    v_add_f32 v35, v4, v35
    v_cvt_pk_bf16_f32 v4, v32, v33
    v_cvt_pk_bf16_f32 v5, v34, v35
    s_mov_b32 s39, 32768
    buffer_store_dwordx2 v[4:5], v2, s[12:15], s39 offen offset:32
    s_waitcnt vmcnt(0)
    s_waitcnt vmcnt(0)
L_end_mlp2_1_kernel:
    s_endpgm
.section .rodata,"a"
.p2align 6
.amdhsa_kernel ln1_0_kernel
  .amdhsa_next_free_vgpr 64
  .amdhsa_next_free_sgpr 48
  .amdhsa_accum_offset 64
  .amdhsa_group_segment_fixed_size 0
  .amdhsa_kernarg_size 88
  .amdhsa_user_sgpr_count 2
  .amdhsa_user_sgpr_kernarg_segment_ptr 1
  .amdhsa_system_sgpr_workgroup_id_x 1
.end_amdhsa_kernel
.p2align 6
.amdhsa_kernel qkv_0_kernel
  .amdhsa_next_free_vgpr 196
  .amdhsa_next_free_sgpr 102
  .amdhsa_accum_offset 196
  .amdhsa_group_segment_fixed_size 0
  .amdhsa_kernarg_size 88
  .amdhsa_user_sgpr_count 2
  .amdhsa_user_sgpr_kernarg_segment_ptr 1
  .amdhsa_system_sgpr_workgroup_id_x 1
.end_amdhsa_kernel
.p2align 6
.amdhsa_kernel o_0_kernel
  .amdhsa_next_free_vgpr 128
  .amdhsa_next_free_sgpr 48
  .amdhsa_accum_offset 80
  .amdhsa_group_segment_fixed_size 0
  .amdhsa_kernarg_size 88
  .amdhsa_user_sgpr_count 2
  .amdhsa_user_sgpr_kernarg_segment_ptr 1
  .amdhsa_system_sgpr_workgroup_id_x 1
.end_amdhsa_kernel
.p2align 6
.amdhsa_kernel proj_0_kernel
  .amdhsa_next_free_vgpr 128
  .amdhsa_next_free_sgpr 102
  .amdhsa_accum_offset 128
  .amdhsa_group_segment_fixed_size 0
  .amdhsa_kernarg_size 88
  .amdhsa_user_sgpr_count 2
  .amdhsa_user_sgpr_kernarg_segment_ptr 1
  .amdhsa_system_sgpr_workgroup_id_x 1
.end_amdhsa_kernel
.p2align 6
.amdhsa_kernel ln2_0_kernel
  .amdhsa_next_free_vgpr 64
  .amdhsa_next_free_sgpr 48
  .amdhsa_accum_offset 64
  .amdhsa_group_segment_fixed_size 0
  .amdhsa_kernarg_size 88
  .amdhsa_user_sgpr_count 2
  .amdhsa_user_sgpr_kernarg_segment_ptr 1
  .amdhsa_system_sgpr_workgroup_id_x 1
.end_amdhsa_kernel
.p2align 6
.amdhsa_kernel mlp1_0_kernel
  .amdhsa_next_free_vgpr 244
  .amdhsa_next_free_sgpr 102
  .amdhsa_accum_offset 244
  .amdhsa_group_segment_fixed_size 0
  .amdhsa_kernarg_size 88
  .amdhsa_user_sgpr_count 2
  .amdhsa_user_sgpr_kernarg_segment_ptr 1
  .amdhsa_system_sgpr_workgroup_id_x 1
.end_amdhsa_kernel
.p2align 6
.amdhsa_kernel mlp2_0_kernel
  .amdhsa_next_free_vgpr 128
  .amdhsa_next_free_sgpr 102
  .amdhsa_accum_offset 128
  .amdhsa_group_segment_fixed_size 0
  .amdhsa_kernarg_size 88
  .amdhsa_user_sgpr_count 2
  .amdhsa_user_sgpr_kernarg_segment_ptr 1
  .amdhsa_system_sgpr_workgroup_id_x 1
.end_amdhsa_kernel
.p2align 6
.amdhsa_kernel ln1_1_kernel
  .amdhsa_next_free_vgpr 64
  .amdhsa_next_free_sgpr 48
  .amdhsa_accum_offset 64
  .amdhsa_group_segment_fixed_size 0
  .amdhsa_kernarg_size 88
  .amdhsa_user_sgpr_count 2
  .amdhsa_user_sgpr_kernarg_segment_ptr 1
  .amdhsa_system_sgpr_workgroup_id_x 1
.end_amdhsa_kernel
.p2align 6
.amdhsa_kernel qkv_1_kernel
  .amdhsa_next_free_vgpr 196
  .amdhsa_next_free_sgpr 102
  .amdhsa_accum_offset 196
  .amdhsa_group_segment_fixed_size 0
  .amdhsa_kernarg_size 88
  .amdhsa_user_sgpr_count 2
  .amdhsa_user_sgpr_kernarg_segment_ptr 1
  .amdhsa_system_sgpr_workgroup_id_x 1
.end_amdhsa_kernel
.p2align 6
.amdhsa_kernel o_1_kernel
  .amdhsa_next_free_vgpr 128
  .amdhsa_next_free_sgpr 48
  .amdhsa_accum_offset 80
  .amdhsa_group_segment_fixed_size 0
  .amdhsa_kernarg_size 88
  .amdhsa_user_sgpr_count 2
  .amdhsa_user_sgpr_kernarg_segment_ptr 1
  .amdhsa_system_sgpr_workgroup_id_x 1
.end_amdhsa_kernel
.p2align 6
.amdhsa_kernel proj_1_kernel
  .amdhsa_next_free_vgpr 128
  .amdhsa_next_free_sgpr 102
  .amdhsa_accum_offset 128
  .amdhsa_group_segment_fixed_size 0
  .amdhsa_kernarg_size 88
  .amdhsa_user_sgpr_count 2
  .amdhsa_user_sgpr_kernarg_segment_ptr 1
  .amdhsa_system_sgpr_workgroup_id_x 1
.end_amdhsa_kernel
.p2align 6
.amdhsa_kernel ln2_1_kernel
  .amdhsa_next_free_vgpr 64
  .amdhsa_next_free_sgpr 48
  .amdhsa_accum_offset 64
  .amdhsa_group_segment_fixed_size 0
  .amdhsa_kernarg_size 88
  .amdhsa_user_sgpr_count 2
  .amdhsa_user_sgpr_kernarg_segment_ptr 1
  .amdhsa_system_sgpr_workgroup_id_x 1
.end_amdhsa_kernel
.p2align 6
.amdhsa_kernel mlp1_1_kernel
  .amdhsa_next_free_vgpr 244
  .amdhsa_next_free_sgpr 102
  .amdhsa_accum_offset 244
  .amdhsa_group_segment_fixed_size 0
  .amdhsa_kernarg_size 88
  .amdhsa_user_sgpr_count 2
  .amdhsa_user_sgpr_kernarg_segment_ptr 1
  .amdhsa_system_sgpr_workgroup_id_x 1
.end_amdhsa_kernel
.p2align 6
.amdhsa_kernel mlp2_1_kernel
  .amdhsa_next_free_vgpr 128
  .amdhsa_next_free_sgpr 102
  .amdhsa_accum_offset 128
  .amdhsa_group_segment_fixed_size 0
  .amdhsa_kernarg_size 88
  .amdhsa_user_sgpr_count 2
  .amdhsa_user_sgpr_kernarg_segment_ptr 1
  .amdhsa_system_sgpr_workgroup_id_x 1
.end_amdhsa_kernel
```
